```python
import torch

def _softmax(x, axis=-1):
    return torch.softmax(x, dim=axis)
def _gelu(x):
    return torch.nn.functional.gelu(x, approximate="tanh")
def _silu(x):
    return torch.nn.functional.silu(x)
def _sigmoid(x):
    return torch.sigmoid(x)
def _layernorm(x, axis=-1, eps=1e-5):
    m = x.mean(dim=axis, keepdim=True)
    v = x.var(dim=axis, keepdim=True, unbiased=False)
    return (x - m) / torch.sqrt(v + eps)
def _scatter_add(tgt, idx, src, axis=0):
    return tgt.clone().index_add_(axis, idx, src)
def _segment_sum(src, seg, n):
    out = torch.zeros((n,) + src.shape[1:], dtype=src.dtype)
    return out.index_add_(0, seg, src)
def _pad(x, pw):
    flat = tuple(v for pair in reversed(pw) for v in pair)
    return torch.nn.functional.pad(x, flat)

kernel_name = 'interleave_layers__sliding_block__glu_gated_swiglu__prompt'

def setup_inputs():

    _w = (lambda a: (lambda t: t.to(torch.bfloat16) if t.is_floating_point() else t)(torch.as_tensor(a)))
    def _A_setup():
        B, S, D = 1, 2048, 640
        return {
            "x": _w((lambda *s: torch.randn(*s, dtype=torch.bfloat16) * 0.05)(B, S, D)),
            "wqkv": _w((lambda *s: torch.randn(*s, dtype=torch.bfloat16) * 0.05)(D, 3 * D)),
            "wo": _w((lambda *s: torch.randn(*s, dtype=torch.bfloat16) * 0.05)(D, D)),
        }
    _A_in = _A_setup()

    def _B_setup():
        B, S, D, F = 1, 2048, 640, 1728
        return {
            "x": _w((lambda *s: torch.randn(*s, dtype=torch.bfloat16) * 0.05)(B, S, D)),
            "w1": _w((lambda *s: torch.randn(*s, dtype=torch.bfloat16) * 0.8)(D, F) * (2.0 / D) ** 0.5),
            "w3": _w((lambda *s: torch.randn(*s, dtype=torch.bfloat16) * 0.8)(D, F) * (2.0 / D) ** 0.5),
            "w2": _w((lambda *s: torch.randn(*s, dtype=torch.bfloat16) * 0.8)(F, D) * (2.0 / F) ** 0.5),
        }
    _B_in = _B_setup()

    return {
        "A_x": _A_in["x"],
        "A_wqkv": _A_in["wqkv"],
        "A_wo": _A_in["wo"],
        "B_x": _B_in["x"],
        "B_w1": _B_in["w1"],
        "B_w3": _B_in["w3"],
        "B_w2": _B_in["w2"],
    }

def reference(A_x, A_wqkv, A_wo, B_x, B_w1, B_w3, B_w2):
    def _A_ref(x, wqkv, wo):
        B, S, D = x.shape
        H = 32; Dh = D // H; W = 256
        qkv = (lambda x, *d: x.permute(*d))((x @ wqkv).reshape(B, S, 3, H, Dh), 2, 0, 3, 1, 4)
        q, k, v = qkv[0], qkv[1], qkv[2]
        scores = torch.einsum("bhqd,bhkd->bhqk", q, k) * (Dh ** -0.5)
        idx = torch.arange(S)
        mask = (idx[:, None] - idx[None, :] >= 0) & (idx[:, None] - idx[None, :] < W)
        scores = torch.where(mask[None, None], scores, -1e9)
        p = _softmax(scores, axis=-1)
        o = torch.einsum("bhqk,bhkd->bhqd", p, v)
        return (lambda x, *d: x.permute(*d))(o, 0, 2, 1, 3).reshape(B, S, D) @ wo

    def _B_ref(x, w1, w3, w2):
        gate = torch.einsum("bsd,df->bsf", x, w1)
        up = torch.einsum("bsd,df->bsf", x, w3)
        h = _silu(gate) * up
        out = torch.einsum("bsf,fd->bsd", h, w2)
        return out

    x = A_x
    x = x + _A_ref(_layernorm(x, axis=-1), A_wqkv, A_wo)
    x = x + _B_ref(_layernorm(x, axis=-1), B_w1, B_w3, B_w2)
    x = x + _A_ref(_layernorm(x, axis=-1), A_wqkv, A_wo)
    x = x + _B_ref(_layernorm(x, axis=-1), B_w1, B_w3, B_w2)
    return x
```

```asm
; @launch grid=(256,1,1) block=(512,1,1) lds=163840
.amdgcn_target "amdgcn-amd-amdhsa--gfx950"
.text
.globl interleave_layers__sliding_block__glu_gated_swiglu__prompt_kernel
.p2align 8
.type interleave_layers__sliding_block__glu_gated_swiglu__prompt_kernel,@function
interleave_layers__sliding_block__glu_gated_swiglu__prompt_kernel:
    s_cmp_ge_u32 s2, 256
    s_cbranch_scc1 L_end
    s_load_dwordx16 s[64:79], s[0:1], 0
    s_load_dwordx4 s[80:83], s[0:1], 64
    v_lshrrev_b32 v1, 6, v0
    v_and_b32 v0, 63, v0
    v_readfirstlane_b32 s46, v1
    s_and_b32 s52, s2, 7
    s_lshr_b32 s53, s2, 3
    s_lshr_b32 s44, s53, 4
    s_lshl_b32 s52, s52, 1
    s_add_u32 s44, s44, s52
    s_and_b32 s45, s53, 15
    s_mov_b32 s47, 0x0
    s_mov_b32 s49, 0x0
    s_mov_b32 s48, 0x61a80
    s_waitcnt lgkmcnt(0)
    s_load_dword s50, s[82:83], 0x10000
    s_mov_b32 s8, s64
    s_and_b32 s9, s65, 0xffff
    s_mov_b32 s10, 0x280000
    s_mov_b32 s11, 0x20000
    s_mov_b32 s12, s66
    s_and_b32 s13, s67, 0xffff
    s_mov_b32 s14, 0x258000
    s_mov_b32 s15, 0x20000
    s_mov_b32 s16, s68
    s_and_b32 s17, s69, 0xffff
    s_mov_b32 s18, 0xc8000
    s_mov_b32 s19, 0x20000
    s_mov_b32 s20, s72
    s_and_b32 s21, s73, 0xffff
    s_mov_b32 s22, 0x21c000
    s_mov_b32 s23, 0x20000
    s_mov_b32 s24, s74
    s_and_b32 s25, s75, 0xffff
    s_mov_b32 s26, 0x21c000
    s_mov_b32 s27, 0x20000
    s_mov_b32 s28, s76
    s_and_b32 s29, s77, 0xffff
    s_mov_b32 s30, 0x21c000
    s_mov_b32 s31, 0x20000
    s_mov_b32 s32, s78
    s_and_b32 s33, s79, 0xffff
    s_mov_b32 s34, 0x280000
    s_mov_b32 s35, 0x20000
    s_mov_b32 s36, s80
    s_and_b32 s37, s81, 0xffff
    s_mov_b32 s38, 0x100
    s_mov_b32 s39, 0x20000
    s_mov_b32 s4, s82
    s_and_b32 s5, s83, 0xffff
    s_mov_b32 s6, 0x10000000
    s_mov_b32 s7, 0x20000
    s_mov_b32 s40, s4
    s_mov_b32 s41, s5
    s_mov_b32 s42, s6
    s_mov_b32 s43, s7
    s_mov_b32 s99, 0x0
    s_mov_b32 s100, 0x0
    s_mov_b32 s97, 0x0
    s_cmp_ge_u32 s46, 6
    s_cbranch_scc1 L_winit
    s_cmp_ge_u32 s46, 4
    s_cbranch_scc1 L_a
    s_lshr_b32 s52, s45, 3
    s_lshl_b32 s52, s52, 6
    s_and_b32 s60, s46, 1
    s_lshl_b32 s60, s60, 5
    s_add_u32 s52, s52, s60
    s_lshr_b32 s60, s46, 1
    s_lshl_b32 s60, s60, 4
    s_add_u32 s52, s52, s60
    s_lshl_b32 s53, s44, 7
    s_add_u32 s52, s52, s53
    s_mul_i32 s52, s52, 1280
    s_and_b32 s53, s45, 7
    s_mul_i32 s53, s53, 160
    s_add_u32 s52, s52, s53
    v_and_b32 v30, 15, v0
    v_mul_u32_u24 v30, 1280, v30
    v_lshrrev_b32 v31, 4, v0
    v_lshl_add_u32 v30, v31, 3, v30
    buffer_load_dwordx2 v[72:73], v30, s[8:11], s52 offen offset:0
    buffer_load_dwordx2 v[74:75], v30, s[8:11], s52 offen offset:32
    buffer_load_dwordx2 v[76:77], v30, s[8:11], s52 offen offset:64
    buffer_load_dwordx2 v[78:79], v30, s[8:11], s52 offen offset:96
    buffer_load_dwordx2 v[80:81], v30, s[8:11], s52 offen offset:128
    s_cmp_lg_u32 s46, 3
    s_cbranch_scc1 L_p0
    v_lshrrev_b32 v232, 4, v0
    v_mul_u32_u24 v232, 3840, v232
    v_and_b32 v233, 15, v0
    v_lshl_add_u32 v232, v233, 4, v232
    s_mul_i32 s96, s44, 153600
    s_mul_i32 s52, s45, 256
    s_add_u32 s96, s96, s52
    buffer_load_dwordx4 v[192:195], v232, s[12:15], s96 offen
    s_add_u32 s96, s96, 15360
    buffer_load_dwordx4 v[196:199], v232, s[12:15], s96 offen
    s_add_u32 s96, s96, 15360
    buffer_load_dwordx4 v[200:203], v232, s[12:15], s96 offen
    s_add_u32 s96, s96, 15360
    buffer_load_dwordx4 v[204:207], v232, s[12:15], s96 offen
    s_add_u32 s96, s96, 15360
    buffer_load_dwordx4 v[208:211], v232, s[12:15], s96 offen
    s_add_u32 s96, s96, 15360
    buffer_load_dwordx4 v[212:215], v232, s[12:15], s96 offen
    s_add_u32 s96, s96, 15360
    buffer_load_dwordx4 v[216:219], v232, s[12:15], s96 offen
    s_add_u32 s96, s96, 15360
    buffer_load_dwordx4 v[220:223], v232, s[12:15], s96 offen
    s_add_u32 s96, s96, 15360
    buffer_load_dwordx4 v[224:227], v232, s[12:15], s96 offen
    s_add_u32 s96, s96, 15360
    buffer_load_dwordx4 v[228:231], v232, s[12:15], s96 offen
    s_add_u32 s96, s96, 15360
L_p0:
    s_and_b32 s52, s44, 7
    s_lshl_b32 s52, s52, 2
    s_add_u32 s52, s52, s46
    s_mul_i32 s52, s52, 25600
    s_and_b32 s53, s45, 7
    s_mul_i32 s53, s53, 160
    s_add_u32 s52, s52, s53
    v_mul_u32_u24 v88, 86, v0
    v_lshrrev_b32 v88, 8, v88
    v_mul_u32_u24 v89, 3, v88
    v_sub_u32 v89, v0, v89
    v_mul_u32_u24 v88, 1280, v88
    v_mul_u32_u24 v89, 78, v89
    v_and_b32 v89, 0xfc, v89
    v_add3_u32 v88, v88, v89, s52
    buffer_load_dword v22, v88, s[16:19], 0 offen
    v_mov_b32 v2, 0
    v_mov_b32 v3, 0
    v_mov_b32 v4, 0
    v_mov_b32 v5, 0
    v_mov_b32 v6, 0
    v_mov_b32 v7, 0
    v_mov_b32 v8, 0
    v_mov_b32 v9, 0
    v_mov_b32 v10, 0
    v_mov_b32 v11, 0
    v_mov_b32 v12, 0
    v_mov_b32 v13, 0
    v_mov_b32 v14, 0
    v_mov_b32 v15, 0
    v_mov_b32 v16, 0
    v_mov_b32 v17, 0
    s_mov_b32 s96, 0x0
    s_mov_b32 s97, 0x0
    s_mov_b32 s98, 0x0
L_c:
    s_cmp_lg_u32 s45, 15
    s_cbranch_scc1 L_c0
    s_cmp_lg_u32 s47, 0
    s_cbranch_scc1 .ip1
    v_and_b32 v88, 15, v0
    v_and_b32 v89, 1, v0
    v_lshlrev_b32 v89, 4, v89
    v_mov_b32 v90, 0x3f80
    v_lshlrev_b32 v89, v89, v90
    v_lshrrev_b32 v90, 1, v88
    v_cmp_eq_u32 vcc, 0, v90
    s_nop 1
    v_cndmask_b32 v244, 0, v89, vcc
    v_cmp_eq_u32 vcc, 1, v90
    s_nop 1
    v_cndmask_b32 v245, 0, v89, vcc
    v_cmp_eq_u32 vcc, 2, v90
    s_nop 1
    v_cndmask_b32 v246, 0, v89, vcc
    v_cmp_eq_u32 vcc, 3, v90
    s_nop 1
    v_cndmask_b32 v247, 0, v89, vcc
    v_bfe_u32 v89, v0, 4, 1
    v_lshlrev_b32 v89, 4, v89
    v_lshl_add_u32 v89, v88, 5, v89
    v_lshrrev_b32 v90, 5, v0
    v_lshl_add_u32 v242, v90, 29, v89
    s_lshr_b32 s52, s45, 3
    s_lshl_b32 s52, s52, 6
    s_and_b32 s60, s46, 1
    s_lshl_b32 s60, s60, 5
    s_add_u32 s52, s52, s60
    s_lshr_b32 s60, s46, 1
    s_lshl_b32 s60, s60, 4
    s_add_u32 s52, s52, s60
    s_lshl_b32 s52, s52, 3
    s_lshl_b32 s53, s44, 13
    s_add_u32 s52, s52, s53
    s_and_b32 s53, s45, 7
    s_lshl_b32 s53, s53, 10
    s_add_u32 s52, s52, s53
    s_lshl_b32 s53, s47, 18
    s_add_u32 s52, s52, s53
    s_add_u32 s99, s52, 0x20000
    v_and_b32 v96, 15, v0
    v_lshrrev_b32 v97, 5, v0
    v_lshlrev_b32 v96, 3, v96
    v_lshl_add_u32 v96, v97, 2, v96
    s_waitcnt vmcnt(0)
    s_cmp_lg_u32 s46, 3
    s_cbranch_scc1 .ip3
    v_mfma_f32_16x16x32_bf16 v[248:251], v[244:247], v[192:195], 0
    v_mfma_f32_16x16x32_bf16 v[248:251], v[244:247], v[196:199], v[248:251]
    v_mfma_f32_16x16x32_bf16 v[248:251], v[244:247], v[200:203], v[248:251]
    v_mfma_f32_16x16x32_bf16 v[248:251], v[244:247], v[204:207], v[248:251]
    v_mfma_f32_16x16x32_bf16 v[248:251], v[244:247], v[208:211], v[248:251]
    v_mfma_f32_16x16x32_bf16 v[248:251], v[244:247], v[212:215], v[248:251]
    v_mfma_f32_16x16x32_bf16 v[248:251], v[244:247], v[216:219], v[248:251]
    v_mfma_f32_16x16x32_bf16 v[248:251], v[244:247], v[220:223], v[248:251]
    v_mfma_f32_16x16x32_bf16 v[248:251], v[244:247], v[224:227], v[248:251]
    v_mfma_f32_16x16x32_bf16 v[248:251], v[244:247], v[228:231], v[248:251]
    s_mul_i32 s97, s45, 3
    s_add_u32 s97, s97, 0
    s_lshl_b32 s97, s97, 4
    s_add_u32 s97, s97, s44
    s_lshl_b32 s97, s97, 9
    s_add_u32 s97, s97, 0x4000000
    s_nop 4
    buffer_store_dwordx4 v[248:251], v242, s[4:7], s97 offen sc1
.ip3:
    v_lshlrev_b32 v2, 16, v72
    v_and_b32 v3, 0xffff0000, v72
    v_lshlrev_b32 v4, 16, v73
    v_and_b32 v5, 0xffff0000, v73
    v_lshlrev_b32 v6, 16, v74
    v_and_b32 v7, 0xffff0000, v74
    v_lshlrev_b32 v8, 16, v75
    v_and_b32 v9, 0xffff0000, v75
    v_lshlrev_b32 v10, 16, v76
    v_and_b32 v11, 0xffff0000, v76
    v_lshlrev_b32 v12, 16, v77
    v_and_b32 v13, 0xffff0000, v77
    v_lshlrev_b32 v14, 16, v78
    v_and_b32 v15, 0xffff0000, v78
    v_lshlrev_b32 v16, 16, v79
    v_and_b32 v17, 0xffff0000, v79
    v_lshlrev_b32 v18, 16, v80
    v_and_b32 v19, 0xffff0000, v80
    v_lshlrev_b32 v20, 16, v81
    v_and_b32 v21, 0xffff0000, v81
    v_pk_add_f32 v[84:85], v[2:3], v[4:5]
    v_pk_mul_f32 v[86:87], v[2:3], v[2:3]
    v_pk_fma_f32 v[86:87], v[4:5], v[4:5], v[86:87]
    v_pk_add_f32 v[84:85], v[84:85], v[6:7]
    v_pk_fma_f32 v[86:87], v[6:7], v[6:7], v[86:87]
    v_pk_add_f32 v[84:85], v[84:85], v[8:9]
    v_pk_fma_f32 v[86:87], v[8:9], v[8:9], v[86:87]
    v_pk_add_f32 v[84:85], v[84:85], v[10:11]
    v_pk_fma_f32 v[86:87], v[10:11], v[10:11], v[86:87]
    v_pk_add_f32 v[84:85], v[84:85], v[12:13]
    v_pk_fma_f32 v[86:87], v[12:13], v[12:13], v[86:87]
    v_pk_add_f32 v[84:85], v[84:85], v[14:15]
    v_pk_fma_f32 v[86:87], v[14:15], v[14:15], v[86:87]
    v_pk_add_f32 v[84:85], v[84:85], v[16:17]
    v_pk_fma_f32 v[86:87], v[16:17], v[16:17], v[86:87]
    v_pk_add_f32 v[84:85], v[84:85], v[18:19]
    v_pk_fma_f32 v[86:87], v[18:19], v[18:19], v[86:87]
    v_pk_add_f32 v[84:85], v[84:85], v[20:21]
    v_pk_fma_f32 v[86:87], v[20:21], v[20:21], v[86:87]
    v_add_f32 v84, v84, v85
    v_add_f32 v86, v86, v87
    s_nop 1
    v_permlane32_swap_b32 v84, v86
    s_nop 1
    v_add_f32 v84, v84, v86
    v_mov_b32 v86, v84
    s_nop 1
    v_permlane16_swap_b32 v84, v86
    s_nop 1
    v_add_f32 v84, v84, v86
    buffer_store_dword v84, v96, s[4:7], s99 offen sc1
    s_waitcnt lgkmcnt(0)
.ip1:
    s_waitcnt vmcnt(0)
    s_barrier
    s_or_b32 s52, s46, s47
    s_cbranch_scc1 .np4
    s_mul_i32 s52, s44, 512
    s_add_u32 s52, s52, s45
    s_lshl_b32 s52, s52, 2
    s_add_u32 s52, s52, 0x5000000
    s_add_u32 s53, s50, 0x9e3779b0
    v_mul_u32_u24 v94, 128, v0
    v_mov_b32 v95, s53
    s_mov_b64 exec, 0xffff
    buffer_store_dword v95, v94, s[4:7], s52 offen sc1
    s_mov_b64 exec, -1
.np4:
    s_waitcnt vmcnt(0)
    s_barrier
    s_branch L_c1
L_c0:
    v_bfe_u32 v100, v0, 2, 2
    v_and_b32 v101, 3, v0
    v_bfe_u32 v102, v0, 4, 1
    v_lshrrev_b32 v103, 5, v0
    v_and_b32 v104, 1, v101
    v_lshlrev_b32 v104, 4, v104
    v_lshrrev_b32 v105, 1, v101
    v_lshl_add_u32 v104, v105, 3, v104
    v_lshl_add_u32 v105, v103, 3, v100
    v_lshl_add_u32 v104, v105, 8, v104
    v_lshl_add_u32 v104, v102, 5, v104
    v_xor_b32 v105, 0, v100
    v_lshl_add_u32 v28, v105, 6, v104
    v_xor_b32 v105, 1, v100
    v_lshl_add_u32 v29, v105, 6, v104
    v_xor_b32 v105, 2, v100
    v_lshl_add_u32 v30, v105, 6, v104
    v_xor_b32 v105, 3, v100
    v_lshl_add_u32 v31, v105, 6, v104
    v_and_b32 v100, 31, v0
    v_lshrrev_b32 v101, 5, v0
    s_lshl_b32 s52, s46, 5
    v_add_u32 v102, s52, v100
    v_bfe_u32 v103, v100, 1, 3
    s_cmp_eq_u32 s47, 0
    s_cselect_b64 vcc, -1, 0
    v_add_u32 v104, 0, v101
    v_lshlrev_b32 v24, 11, v104
    v_lshl_add_u32 v24, v102, 4, v24
    v_xor_b32 v104, v104, v103
    v_lshlrev_b32 v104, 4, v104
    v_lshl_add_u32 v104, v102, 7, v104
    v_cndmask_b32 v24, v24, v104, vcc
    v_add_u32 v24, 0x17000, v24
    v_add_u32 v104, 2, v101
    v_lshlrev_b32 v25, 11, v104
    v_lshl_add_u32 v25, v102, 4, v25
    v_xor_b32 v104, v104, v103
    v_lshlrev_b32 v104, 4, v104
    v_lshl_add_u32 v104, v102, 7, v104
    v_cndmask_b32 v25, v25, v104, vcc
    v_add_u32 v25, 0x17000, v25
    v_add_u32 v104, 4, v101
    v_lshlrev_b32 v26, 11, v104
    v_lshl_add_u32 v26, v102, 4, v26
    v_xor_b32 v104, v104, v103
    v_lshlrev_b32 v104, 4, v104
    v_lshl_add_u32 v104, v102, 7, v104
    v_cndmask_b32 v26, v26, v104, vcc
    v_add_u32 v26, 0x17000, v26
    v_add_u32 v104, 6, v101
    v_lshlrev_b32 v27, 11, v104
    v_lshl_add_u32 v27, v102, 4, v27
    v_xor_b32 v104, v104, v103
    v_lshlrev_b32 v104, 4, v104
    v_lshl_add_u32 v104, v102, 7, v104
    v_cndmask_b32 v27, v27, v104, vcc
    v_add_u32 v27, 0x17000, v27
    v_add_u32 v108, 0x10000, v28
    v_add_u32 v109, 0x10000, v29
    v_add_u32 v110, 0x10000, v30
    v_add_u32 v111, 0x10000, v31
    v_lshlrev_b32 v121, 12, v101
    v_lshl_add_u32 v121, v102, 3, v121
    s_lshl_b32 s101, s47, 18
    s_lshl_b32 s52, s44, 13
    s_add_u32 s101, s101, s52
    s_add_u32 s101, s101, 0x20000
    s_waitcnt lgkmcnt(0)
    s_barrier
    ds_read_b128 v[32:35], v24 offset:0
    ds_read_b64_tr_b16 v[36:37], v28 offset:0
    ds_read_b64_tr_b16 v[38:39], v28 offset:1024
    ds_read_b64_tr_b16 v[40:41], v29 offset:0
    ds_read_b64_tr_b16 v[42:43], v29 offset:1024
    ds_read_b64_tr_b16 v[44:45], v30 offset:0
    ds_read_b64_tr_b16 v[46:47], v30 offset:1024
    ds_read_b64_tr_b16 v[48:49], v31 offset:0
    ds_read_b64_tr_b16 v[50:51], v31 offset:1024
    s_cmp_lg_u32 s47, 0
    s_cbranch_scc1 .ip5
    v_and_b32 v88, 15, v0
    v_and_b32 v89, 1, v0
    v_lshlrev_b32 v89, 4, v89
    v_mov_b32 v90, 0x3f80
    v_lshlrev_b32 v89, v89, v90
    v_lshrrev_b32 v90, 1, v88
    v_cmp_eq_u32 vcc, 0, v90
    s_nop 1
    v_cndmask_b32 v244, 0, v89, vcc
    v_cmp_eq_u32 vcc, 1, v90
    s_nop 1
    v_cndmask_b32 v245, 0, v89, vcc
    v_cmp_eq_u32 vcc, 2, v90
    s_nop 1
    v_cndmask_b32 v246, 0, v89, vcc
    v_cmp_eq_u32 vcc, 3, v90
    s_nop 1
    v_cndmask_b32 v247, 0, v89, vcc
    v_bfe_u32 v89, v0, 4, 1
    v_lshlrev_b32 v89, 4, v89
    v_lshl_add_u32 v89, v88, 5, v89
    v_lshrrev_b32 v90, 5, v0
    v_lshl_add_u32 v242, v90, 29, v89
    s_lshr_b32 s52, s45, 3
    s_lshl_b32 s52, s52, 6
    s_and_b32 s60, s46, 1
    s_lshl_b32 s60, s60, 5
    s_add_u32 s52, s52, s60
    s_lshr_b32 s60, s46, 1
    s_lshl_b32 s60, s60, 4
    s_add_u32 s52, s52, s60
    s_lshl_b32 s52, s52, 3
    s_lshl_b32 s53, s44, 13
    s_add_u32 s52, s52, s53
    s_and_b32 s53, s45, 7
    s_lshl_b32 s53, s53, 10
    s_add_u32 s52, s52, s53
    s_lshl_b32 s53, s47, 18
    s_add_u32 s52, s52, s53
    s_add_u32 s99, s52, 0x20000
    v_and_b32 v96, 15, v0
    v_lshrrev_b32 v97, 5, v0
    v_lshlrev_b32 v96, 3, v96
    v_lshl_add_u32 v96, v97, 2, v96
    s_waitcnt vmcnt(0)
    s_cmp_lg_u32 s46, 3
    s_cbranch_scc1 .ip7
    v_mfma_f32_16x16x32_bf16 v[248:251], v[244:247], v[192:195], 0
    v_mfma_f32_16x16x32_bf16 v[248:251], v[244:247], v[196:199], v[248:251]
    v_mfma_f32_16x16x32_bf16 v[248:251], v[244:247], v[200:203], v[248:251]
    v_mfma_f32_16x16x32_bf16 v[248:251], v[244:247], v[204:207], v[248:251]
    v_mfma_f32_16x16x32_bf16 v[248:251], v[244:247], v[208:211], v[248:251]
    v_mfma_f32_16x16x32_bf16 v[248:251], v[244:247], v[212:215], v[248:251]
    v_mfma_f32_16x16x32_bf16 v[248:251], v[244:247], v[216:219], v[248:251]
    v_mfma_f32_16x16x32_bf16 v[248:251], v[244:247], v[220:223], v[248:251]
    v_mfma_f32_16x16x32_bf16 v[248:251], v[244:247], v[224:227], v[248:251]
    v_mfma_f32_16x16x32_bf16 v[248:251], v[244:247], v[228:231], v[248:251]
    s_mul_i32 s97, s45, 3
    s_add_u32 s97, s97, 0
    s_lshl_b32 s97, s97, 4
    s_add_u32 s97, s97, s44
    s_lshl_b32 s97, s97, 9
    s_add_u32 s97, s97, 0x4000000
    s_nop 4
    buffer_store_dwordx4 v[248:251], v242, s[4:7], s97 offen sc1
.ip7:
    v_lshlrev_b32 v2, 16, v72
    v_and_b32 v3, 0xffff0000, v72
    v_lshlrev_b32 v4, 16, v73
    v_and_b32 v5, 0xffff0000, v73
    v_lshlrev_b32 v6, 16, v74
    v_and_b32 v7, 0xffff0000, v74
    v_lshlrev_b32 v8, 16, v75
    v_and_b32 v9, 0xffff0000, v75
    v_lshlrev_b32 v10, 16, v76
    v_and_b32 v11, 0xffff0000, v76
    v_lshlrev_b32 v12, 16, v77
    v_and_b32 v13, 0xffff0000, v77
    v_lshlrev_b32 v14, 16, v78
    v_and_b32 v15, 0xffff0000, v78
    v_lshlrev_b32 v16, 16, v79
    v_and_b32 v17, 0xffff0000, v79
    v_lshlrev_b32 v18, 16, v80
    v_and_b32 v19, 0xffff0000, v80
    v_lshlrev_b32 v20, 16, v81
    v_and_b32 v21, 0xffff0000, v81
    v_pk_add_f32 v[84:85], v[2:3], v[4:5]
    v_pk_mul_f32 v[86:87], v[2:3], v[2:3]
    v_pk_fma_f32 v[86:87], v[4:5], v[4:5], v[86:87]
    v_pk_add_f32 v[84:85], v[84:85], v[6:7]
    v_pk_fma_f32 v[86:87], v[6:7], v[6:7], v[86:87]
    v_pk_add_f32 v[84:85], v[84:85], v[8:9]
    v_pk_fma_f32 v[86:87], v[8:9], v[8:9], v[86:87]
    v_pk_add_f32 v[84:85], v[84:85], v[10:11]
    v_pk_fma_f32 v[86:87], v[10:11], v[10:11], v[86:87]
    v_pk_add_f32 v[84:85], v[84:85], v[12:13]
    v_pk_fma_f32 v[86:87], v[12:13], v[12:13], v[86:87]
    v_pk_add_f32 v[84:85], v[84:85], v[14:15]
    v_pk_fma_f32 v[86:87], v[14:15], v[14:15], v[86:87]
    v_pk_add_f32 v[84:85], v[84:85], v[16:17]
    v_pk_fma_f32 v[86:87], v[16:17], v[16:17], v[86:87]
    v_pk_add_f32 v[84:85], v[84:85], v[18:19]
    v_pk_fma_f32 v[86:87], v[18:19], v[18:19], v[86:87]
    v_pk_add_f32 v[84:85], v[84:85], v[20:21]
    v_pk_fma_f32 v[86:87], v[20:21], v[20:21], v[86:87]
    v_add_f32 v84, v84, v85
    v_add_f32 v86, v86, v87
    s_nop 1
    v_permlane32_swap_b32 v84, v86
    s_nop 1
    v_add_f32 v84, v84, v86
    v_mov_b32 v86, v84
    s_nop 1
    v_permlane16_swap_b32 v84, v86
    s_nop 1
    v_add_f32 v84, v84, v86
    buffer_store_dword v84, v96, s[4:7], s99 offen sc1
    s_waitcnt lgkmcnt(0)
.ip5:
    s_waitcnt lgkmcnt(6)
    v_mfma_f32_32x32x16_bf16 v[128:143], v[36:39], v[32:35], 0
    ds_read_b128 v[52:55], v25 offset:0
    ds_read_b64_tr_b16 v[56:57], v28 offset:4096
    ds_read_b64_tr_b16 v[58:59], v28 offset:5120
    s_waitcnt lgkmcnt(7)
    v_mfma_f32_32x32x16_bf16 v[144:159], v[40:43], v[32:35], 0
    ds_read_b64_tr_b16 v[60:61], v29 offset:4096
    ds_read_b64_tr_b16 v[62:63], v29 offset:5120
    s_waitcnt lgkmcnt(7)
    v_mfma_f32_32x32x16_bf16 v[160:175], v[44:47], v[32:35], 0
    ds_read_b64_tr_b16 v[64:65], v30 offset:4096
    ds_read_b64_tr_b16 v[66:67], v30 offset:5120
    s_waitcnt lgkmcnt(7)
    v_mfma_f32_32x32x16_bf16 v[176:191], v[48:51], v[32:35], 0
    ds_read_b64_tr_b16 v[68:69], v31 offset:4096
    ds_read_b64_tr_b16 v[70:71], v31 offset:5120
    s_waitcnt lgkmcnt(6)
    v_mfma_f32_32x32x16_bf16 v[128:143], v[56:59], v[52:55], v[128:143]
    ds_read_b128 v[32:35], v26 offset:0
    ds_read_b64_tr_b16 v[36:37], v28 offset:8192
    ds_read_b64_tr_b16 v[38:39], v28 offset:9216
    s_waitcnt lgkmcnt(7)
    v_mfma_f32_32x32x16_bf16 v[144:159], v[60:63], v[52:55], v[144:159]
    ds_read_b64_tr_b16 v[40:41], v29 offset:8192
    ds_read_b64_tr_b16 v[42:43], v29 offset:9216
    s_waitcnt lgkmcnt(7)
    v_mfma_f32_32x32x16_bf16 v[160:175], v[64:67], v[52:55], v[160:175]
    ds_read_b64_tr_b16 v[44:45], v30 offset:8192
    ds_read_b64_tr_b16 v[46:47], v30 offset:9216
    s_waitcnt lgkmcnt(7)
    v_mfma_f32_32x32x16_bf16 v[176:191], v[68:71], v[52:55], v[176:191]
    ds_read_b64_tr_b16 v[48:49], v31 offset:8192
    ds_read_b64_tr_b16 v[50:51], v31 offset:9216
    s_waitcnt lgkmcnt(6)
    v_mfma_f32_32x32x16_bf16 v[128:143], v[36:39], v[32:35], v[128:143]
    ds_read_b128 v[52:55], v27 offset:0
    ds_read_b64_tr_b16 v[56:57], v28 offset:12288
    ds_read_b64_tr_b16 v[58:59], v28 offset:13312
    s_waitcnt lgkmcnt(7)
    v_mfma_f32_32x32x16_bf16 v[144:159], v[40:43], v[32:35], v[144:159]
    ds_read_b64_tr_b16 v[60:61], v29 offset:12288
    ds_read_b64_tr_b16 v[62:63], v29 offset:13312
    s_waitcnt lgkmcnt(7)
    v_mfma_f32_32x32x16_bf16 v[160:175], v[44:47], v[32:35], v[160:175]
    ds_read_b64_tr_b16 v[64:65], v30 offset:12288
    ds_read_b64_tr_b16 v[66:67], v30 offset:13312
    s_waitcnt lgkmcnt(7)
    v_mfma_f32_32x32x16_bf16 v[176:191], v[48:51], v[32:35], v[176:191]
    ds_read_b64_tr_b16 v[68:69], v31 offset:12288
    ds_read_b64_tr_b16 v[70:71], v31 offset:13312
    s_waitcnt lgkmcnt(6)
    v_mfma_f32_32x32x16_bf16 v[128:143], v[56:59], v[52:55], v[128:143]
    s_waitcnt lgkmcnt(0)
    s_barrier
    ds_read_b128 v[32:35], v24 offset:16384
    ds_read_b64_tr_b16 v[36:37], v28 offset:16384
    ds_read_b64_tr_b16 v[38:39], v28 offset:17408
    v_mfma_f32_32x32x16_bf16 v[144:159], v[60:63], v[52:55], v[144:159]
    ds_read_b64_tr_b16 v[40:41], v29 offset:16384
    ds_read_b64_tr_b16 v[42:43], v29 offset:17408
    v_mfma_f32_32x32x16_bf16 v[160:175], v[64:67], v[52:55], v[160:175]
    ds_read_b64_tr_b16 v[44:45], v30 offset:16384
    ds_read_b64_tr_b16 v[46:47], v30 offset:17408
    v_mfma_f32_32x32x16_bf16 v[176:191], v[68:71], v[52:55], v[176:191]
    ds_read_b64_tr_b16 v[48:49], v31 offset:16384
    ds_read_b64_tr_b16 v[50:51], v31 offset:17408
    s_waitcnt lgkmcnt(6)
    v_mfma_f32_32x32x16_bf16 v[128:143], v[36:39], v[32:35], v[128:143]
    ds_read_b128 v[52:55], v25 offset:16384
    ds_read_b64_tr_b16 v[56:57], v28 offset:20480
    ds_read_b64_tr_b16 v[58:59], v28 offset:21504
    s_waitcnt lgkmcnt(7)
    v_mfma_f32_32x32x16_bf16 v[144:159], v[40:43], v[32:35], v[144:159]
    ds_read_b64_tr_b16 v[60:61], v29 offset:20480
    ds_read_b64_tr_b16 v[62:63], v29 offset:21504
    s_waitcnt lgkmcnt(7)
    v_mfma_f32_32x32x16_bf16 v[160:175], v[44:47], v[32:35], v[160:175]
    ds_read_b64_tr_b16 v[64:65], v30 offset:20480
    ds_read_b64_tr_b16 v[66:67], v30 offset:21504
    s_waitcnt lgkmcnt(7)
    v_mfma_f32_32x32x16_bf16 v[176:191], v[48:51], v[32:35], v[176:191]
    ds_read_b64_tr_b16 v[68:69], v31 offset:20480
    ds_read_b64_tr_b16 v[70:71], v31 offset:21504
    s_cmp_eq_u32 s47, 0
    s_cbranch_scc1 .sl8
    buffer_load_dwordx2 v[112:113], v121, s[4:7], s101 offen offset:0 sc1
    buffer_load_dwordx2 v[114:115], v121, s[4:7], s101 offen offset:1024 sc1
    buffer_load_dwordx2 v[116:117], v121, s[4:7], s101 offen offset:2048 sc1
    buffer_load_dwordx2 v[118:119], v121, s[4:7], s101 offen offset:3072 sc1
.sl8:
    s_waitcnt lgkmcnt(6)
    v_mfma_f32_32x32x16_bf16 v[128:143], v[56:59], v[52:55], v[128:143]
    ds_read_b128 v[32:35], v26 offset:16384
    ds_read_b64_tr_b16 v[36:37], v28 offset:24576
    ds_read_b64_tr_b16 v[38:39], v28 offset:25600
    s_waitcnt lgkmcnt(7)
    v_mfma_f32_32x32x16_bf16 v[144:159], v[60:63], v[52:55], v[144:159]
    ds_read_b64_tr_b16 v[40:41], v29 offset:24576
    ds_read_b64_tr_b16 v[42:43], v29 offset:25600
    s_waitcnt lgkmcnt(7)
    v_mfma_f32_32x32x16_bf16 v[160:175], v[64:67], v[52:55], v[160:175]
    ds_read_b64_tr_b16 v[44:45], v30 offset:24576
    ds_read_b64_tr_b16 v[46:47], v30 offset:25600
    s_waitcnt lgkmcnt(7)
    v_mfma_f32_32x32x16_bf16 v[176:191], v[68:71], v[52:55], v[176:191]
    ds_read_b64_tr_b16 v[48:49], v31 offset:24576
    ds_read_b64_tr_b16 v[50:51], v31 offset:25600
    s_waitcnt lgkmcnt(6)
    v_mfma_f32_32x32x16_bf16 v[128:143], v[36:39], v[32:35], v[128:143]
    ds_read_b128 v[52:55], v27 offset:16384
    ds_read_b64_tr_b16 v[56:57], v28 offset:28672
    ds_read_b64_tr_b16 v[58:59], v28 offset:29696
    s_waitcnt lgkmcnt(7)
    v_mfma_f32_32x32x16_bf16 v[144:159], v[40:43], v[32:35], v[144:159]
    ds_read_b64_tr_b16 v[60:61], v29 offset:28672
    ds_read_b64_tr_b16 v[62:63], v29 offset:29696
    s_waitcnt lgkmcnt(7)
    v_mfma_f32_32x32x16_bf16 v[160:175], v[44:47], v[32:35], v[160:175]
    ds_read_b64_tr_b16 v[64:65], v30 offset:28672
    ds_read_b64_tr_b16 v[66:67], v30 offset:29696
    s_waitcnt lgkmcnt(7)
    v_mfma_f32_32x32x16_bf16 v[176:191], v[48:51], v[32:35], v[176:191]
    ds_read_b64_tr_b16 v[68:69], v31 offset:28672
    ds_read_b64_tr_b16 v[70:71], v31 offset:29696
    s_waitcnt lgkmcnt(6)
    v_mfma_f32_32x32x16_bf16 v[128:143], v[56:59], v[52:55], v[128:143]
    s_waitcnt vmcnt(0)
    s_waitcnt lgkmcnt(0)
    s_barrier
    ds_read_b128 v[32:35], v24 offset:32768
    ds_read_b64_tr_b16 v[36:37], v28 offset:32768
    ds_read_b64_tr_b16 v[38:39], v28 offset:33792
    v_mfma_f32_32x32x16_bf16 v[144:159], v[60:63], v[52:55], v[144:159]
    ds_read_b64_tr_b16 v[40:41], v29 offset:32768
    ds_read_b64_tr_b16 v[42:43], v29 offset:33792
    v_mfma_f32_32x32x16_bf16 v[160:175], v[64:67], v[52:55], v[160:175]
    ds_read_b64_tr_b16 v[44:45], v30 offset:32768
    ds_read_b64_tr_b16 v[46:47], v30 offset:33792
    v_mfma_f32_32x32x16_bf16 v[176:191], v[68:71], v[52:55], v[176:191]
    ds_read_b64_tr_b16 v[48:49], v31 offset:32768
    ds_read_b64_tr_b16 v[50:51], v31 offset:33792
    s_waitcnt lgkmcnt(6)
    v_mfma_f32_32x32x16_bf16 v[128:143], v[36:39], v[32:35], v[128:143]
    ds_read_b128 v[52:55], v25 offset:32768
    ds_read_b64_tr_b16 v[56:57], v28 offset:36864
    ds_read_b64_tr_b16 v[58:59], v28 offset:37888
    s_waitcnt lgkmcnt(7)
    v_mfma_f32_32x32x16_bf16 v[144:159], v[40:43], v[32:35], v[144:159]
    ds_read_b64_tr_b16 v[60:61], v29 offset:36864
    ds_read_b64_tr_b16 v[62:63], v29 offset:37888
    s_waitcnt lgkmcnt(7)
    v_mfma_f32_32x32x16_bf16 v[160:175], v[44:47], v[32:35], v[160:175]
    ds_read_b64_tr_b16 v[64:65], v30 offset:36864
    ds_read_b64_tr_b16 v[66:67], v30 offset:37888
    s_waitcnt lgkmcnt(7)
    v_mfma_f32_32x32x16_bf16 v[176:191], v[48:51], v[32:35], v[176:191]
    ds_read_b64_tr_b16 v[68:69], v31 offset:36864
    ds_read_b64_tr_b16 v[70:71], v31 offset:37888
    s_or_b32 s52, s46, s47
    s_cbranch_scc1 .np9
    s_mul_i32 s52, s44, 512
    s_add_u32 s52, s52, s45
    s_lshl_b32 s52, s52, 2
    s_add_u32 s52, s52, 0x5000000
    s_add_u32 s53, s50, 0x9e3779b0
    v_mul_u32_u24 v94, 128, v0
    v_mov_b32 v95, s53
    s_mov_b64 exec, 0xffff
    buffer_store_dword v95, v94, s[4:7], s52 offen sc1
    s_mov_b64 exec, -1
.np9:
    s_waitcnt lgkmcnt(6)
    v_mfma_f32_32x32x16_bf16 v[128:143], v[56:59], v[52:55], v[128:143]
    ds_read_b128 v[32:35], v26 offset:32768
    ds_read_b64_tr_b16 v[36:37], v28 offset:40960
    ds_read_b64_tr_b16 v[38:39], v28 offset:41984
    s_waitcnt lgkmcnt(7)
    v_mfma_f32_32x32x16_bf16 v[144:159], v[60:63], v[52:55], v[144:159]
    ds_read_b64_tr_b16 v[40:41], v29 offset:40960
    ds_read_b64_tr_b16 v[42:43], v29 offset:41984
    s_waitcnt lgkmcnt(7)
    v_mfma_f32_32x32x16_bf16 v[160:175], v[64:67], v[52:55], v[160:175]
    ds_read_b64_tr_b16 v[44:45], v30 offset:40960
    ds_read_b64_tr_b16 v[46:47], v30 offset:41984
    s_waitcnt lgkmcnt(7)
    v_mfma_f32_32x32x16_bf16 v[176:191], v[68:71], v[52:55], v[176:191]
    ds_read_b64_tr_b16 v[48:49], v31 offset:40960
    ds_read_b64_tr_b16 v[50:51], v31 offset:41984
    s_waitcnt lgkmcnt(6)
    v_mfma_f32_32x32x16_bf16 v[128:143], v[36:39], v[32:35], v[128:143]
    ds_read_b128 v[52:55], v27 offset:32768
    ds_read_b64_tr_b16 v[56:57], v28 offset:45056
    ds_read_b64_tr_b16 v[58:59], v28 offset:46080
    s_waitcnt lgkmcnt(7)
    v_mfma_f32_32x32x16_bf16 v[144:159], v[40:43], v[32:35], v[144:159]
    ds_read_b64_tr_b16 v[60:61], v29 offset:45056
    ds_read_b64_tr_b16 v[62:63], v29 offset:46080
    s_waitcnt lgkmcnt(7)
    v_mfma_f32_32x32x16_bf16 v[160:175], v[44:47], v[32:35], v[160:175]
    ds_read_b64_tr_b16 v[64:65], v30 offset:45056
    ds_read_b64_tr_b16 v[66:67], v30 offset:46080
    s_waitcnt lgkmcnt(7)
    v_mfma_f32_32x32x16_bf16 v[176:191], v[48:51], v[32:35], v[176:191]
    ds_read_b64_tr_b16 v[68:69], v31 offset:45056
    ds_read_b64_tr_b16 v[70:71], v31 offset:46080
    s_waitcnt lgkmcnt(6)
    v_mfma_f32_32x32x16_bf16 v[128:143], v[56:59], v[52:55], v[128:143]
    s_waitcnt lgkmcnt(0)
    s_barrier
    ds_read_b128 v[32:35], v24 offset:49152
    ds_read_b64_tr_b16 v[36:37], v28 offset:49152
    ds_read_b64_tr_b16 v[38:39], v28 offset:50176
    v_mfma_f32_32x32x16_bf16 v[144:159], v[60:63], v[52:55], v[144:159]
    ds_read_b64_tr_b16 v[40:41], v29 offset:49152
    ds_read_b64_tr_b16 v[42:43], v29 offset:50176
    v_mfma_f32_32x32x16_bf16 v[160:175], v[64:67], v[52:55], v[160:175]
    ds_read_b64_tr_b16 v[44:45], v30 offset:49152
    ds_read_b64_tr_b16 v[46:47], v30 offset:50176
    v_mfma_f32_32x32x16_bf16 v[176:191], v[68:71], v[52:55], v[176:191]
    ds_read_b64_tr_b16 v[48:49], v31 offset:49152
    ds_read_b64_tr_b16 v[50:51], v31 offset:50176
    s_waitcnt lgkmcnt(6)
    v_mfma_f32_32x32x16_bf16 v[128:143], v[36:39], v[32:35], v[128:143]
    ds_read_b128 v[52:55], v25 offset:49152
    ds_read_b64_tr_b16 v[56:57], v28 offset:53248
    ds_read_b64_tr_b16 v[58:59], v28 offset:54272
    s_waitcnt lgkmcnt(7)
    v_mfma_f32_32x32x16_bf16 v[144:159], v[40:43], v[32:35], v[144:159]
    ds_read_b64_tr_b16 v[60:61], v29 offset:53248
    ds_read_b64_tr_b16 v[62:63], v29 offset:54272
    s_waitcnt lgkmcnt(7)
    v_mfma_f32_32x32x16_bf16 v[160:175], v[44:47], v[32:35], v[160:175]
    ds_read_b64_tr_b16 v[64:65], v30 offset:53248
    ds_read_b64_tr_b16 v[66:67], v30 offset:54272
    s_waitcnt lgkmcnt(7)
    v_mfma_f32_32x32x16_bf16 v[176:191], v[48:51], v[32:35], v[176:191]
    ds_read_b64_tr_b16 v[68:69], v31 offset:53248
    ds_read_b64_tr_b16 v[70:71], v31 offset:54272
    s_waitcnt lgkmcnt(6)
    v_mfma_f32_32x32x16_bf16 v[128:143], v[56:59], v[52:55], v[128:143]
    ds_read_b128 v[32:35], v26 offset:49152
    ds_read_b64_tr_b16 v[36:37], v28 offset:57344
    ds_read_b64_tr_b16 v[38:39], v28 offset:58368
    s_waitcnt lgkmcnt(7)
    v_mfma_f32_32x32x16_bf16 v[144:159], v[60:63], v[52:55], v[144:159]
    ds_read_b64_tr_b16 v[40:41], v29 offset:57344
    ds_read_b64_tr_b16 v[42:43], v29 offset:58368
    s_waitcnt lgkmcnt(7)
    v_mfma_f32_32x32x16_bf16 v[160:175], v[64:67], v[52:55], v[160:175]
    ds_read_b64_tr_b16 v[44:45], v30 offset:57344
    ds_read_b64_tr_b16 v[46:47], v30 offset:58368
    s_waitcnt lgkmcnt(7)
    v_mfma_f32_32x32x16_bf16 v[176:191], v[68:71], v[52:55], v[176:191]
    ds_read_b64_tr_b16 v[48:49], v31 offset:57344
    ds_read_b64_tr_b16 v[50:51], v31 offset:58368
    s_waitcnt lgkmcnt(6)
    v_mfma_f32_32x32x16_bf16 v[128:143], v[36:39], v[32:35], v[128:143]
    ds_read_b128 v[52:55], v27 offset:49152
    ds_read_b64_tr_b16 v[56:57], v28 offset:61440
    ds_read_b64_tr_b16 v[58:59], v28 offset:62464
    s_waitcnt lgkmcnt(7)
    v_mfma_f32_32x32x16_bf16 v[144:159], v[40:43], v[32:35], v[144:159]
    ds_read_b64_tr_b16 v[60:61], v29 offset:61440
    ds_read_b64_tr_b16 v[62:63], v29 offset:62464
    s_waitcnt lgkmcnt(7)
    v_mfma_f32_32x32x16_bf16 v[160:175], v[44:47], v[32:35], v[160:175]
    ds_read_b64_tr_b16 v[64:65], v30 offset:61440
    ds_read_b64_tr_b16 v[66:67], v30 offset:62464
    s_waitcnt lgkmcnt(7)
    v_mfma_f32_32x32x16_bf16 v[176:191], v[48:51], v[32:35], v[176:191]
    ds_read_b64_tr_b16 v[68:69], v31 offset:61440
    ds_read_b64_tr_b16 v[70:71], v31 offset:62464
    s_waitcnt lgkmcnt(6)
    v_mfma_f32_32x32x16_bf16 v[128:143], v[56:59], v[52:55], v[128:143]
    s_waitcnt lgkmcnt(0)
    s_barrier
    ds_read_b128 v[32:35], v24 offset:0
    ds_read_b64_tr_b16 v[36:37], v108 offset:0
    ds_read_b64_tr_b16 v[38:39], v108 offset:1024
    v_mfma_f32_32x32x16_bf16 v[144:159], v[60:63], v[52:55], v[144:159]
    ds_read_b64_tr_b16 v[40:41], v109 offset:0
    ds_read_b64_tr_b16 v[42:43], v109 offset:1024
    v_mfma_f32_32x32x16_bf16 v[160:175], v[64:67], v[52:55], v[160:175]
    ds_read_b64_tr_b16 v[44:45], v110 offset:0
    ds_read_b64_tr_b16 v[46:47], v110 offset:1024
    v_mfma_f32_32x32x16_bf16 v[176:191], v[68:71], v[52:55], v[176:191]
    ds_read_b64_tr_b16 v[48:49], v111 offset:0
    ds_read_b64_tr_b16 v[50:51], v111 offset:1024
    s_waitcnt lgkmcnt(6)
    v_mfma_f32_32x32x16_bf16 v[128:143], v[36:39], v[32:35], v[128:143]
    ds_read_b128 v[52:55], v25 offset:0
    ds_read_b64_tr_b16 v[56:57], v108 offset:4096
    ds_read_b64_tr_b16 v[58:59], v108 offset:5120
    s_waitcnt lgkmcnt(7)
    v_mfma_f32_32x32x16_bf16 v[144:159], v[40:43], v[32:35], v[144:159]
    ds_read_b64_tr_b16 v[60:61], v109 offset:4096
    ds_read_b64_tr_b16 v[62:63], v109 offset:5120
    s_waitcnt lgkmcnt(7)
    v_mfma_f32_32x32x16_bf16 v[160:175], v[44:47], v[32:35], v[160:175]
    ds_read_b64_tr_b16 v[64:65], v110 offset:4096
    ds_read_b64_tr_b16 v[66:67], v110 offset:5120
    s_waitcnt lgkmcnt(7)
    v_mfma_f32_32x32x16_bf16 v[176:191], v[48:51], v[32:35], v[176:191]
    ds_read_b64_tr_b16 v[68:69], v111 offset:4096
    ds_read_b64_tr_b16 v[70:71], v111 offset:5120
    s_waitcnt lgkmcnt(6)
    v_mfma_f32_32x32x16_bf16 v[128:143], v[56:59], v[52:55], v[128:143]
    ds_read_b128 v[32:35], v26 offset:0
    ds_read_b64_tr_b16 v[36:37], v108 offset:8192
    ds_read_b64_tr_b16 v[38:39], v108 offset:9216
    s_waitcnt lgkmcnt(7)
    v_mfma_f32_32x32x16_bf16 v[144:159], v[60:63], v[52:55], v[144:159]
    ds_read_b64_tr_b16 v[40:41], v109 offset:8192
    ds_read_b64_tr_b16 v[42:43], v109 offset:9216
    s_waitcnt lgkmcnt(7)
    v_mfma_f32_32x32x16_bf16 v[160:175], v[64:67], v[52:55], v[160:175]
    ds_read_b64_tr_b16 v[44:45], v110 offset:8192
    ds_read_b64_tr_b16 v[46:47], v110 offset:9216
    s_waitcnt lgkmcnt(7)
    v_mfma_f32_32x32x16_bf16 v[176:191], v[68:71], v[52:55], v[176:191]
    ds_read_b64_tr_b16 v[48:49], v111 offset:8192
    ds_read_b64_tr_b16 v[50:51], v111 offset:9216
    s_waitcnt lgkmcnt(6)
    v_mfma_f32_32x32x16_bf16 v[128:143], v[36:39], v[32:35], v[128:143]
    ds_read_b128 v[52:55], v27 offset:0
    ds_read_b64_tr_b16 v[56:57], v108 offset:12288
    ds_read_b64_tr_b16 v[58:59], v108 offset:13312
    s_waitcnt lgkmcnt(7)
    v_mfma_f32_32x32x16_bf16 v[144:159], v[40:43], v[32:35], v[144:159]
    ds_read_b64_tr_b16 v[60:61], v109 offset:12288
    ds_read_b64_tr_b16 v[62:63], v109 offset:13312
    s_waitcnt lgkmcnt(7)
    v_mfma_f32_32x32x16_bf16 v[160:175], v[44:47], v[32:35], v[160:175]
    ds_read_b64_tr_b16 v[64:65], v110 offset:12288
    ds_read_b64_tr_b16 v[66:67], v110 offset:13312
    s_waitcnt lgkmcnt(7)
    v_mfma_f32_32x32x16_bf16 v[176:191], v[48:51], v[32:35], v[176:191]
    ds_read_b64_tr_b16 v[68:69], v111 offset:12288
    ds_read_b64_tr_b16 v[70:71], v111 offset:13312
    s_waitcnt lgkmcnt(6)
    v_mfma_f32_32x32x16_bf16 v[128:143], v[56:59], v[52:55], v[128:143]
    s_waitcnt lgkmcnt(0)
    s_barrier
    ds_read_b128 v[32:35], v24 offset:16384
    ds_read_b64_tr_b16 v[36:37], v28 offset:0
    ds_read_b64_tr_b16 v[38:39], v28 offset:1024
    v_mfma_f32_32x32x16_bf16 v[144:159], v[60:63], v[52:55], v[144:159]
    ds_read_b64_tr_b16 v[40:41], v29 offset:0
    ds_read_b64_tr_b16 v[42:43], v29 offset:1024
    v_mfma_f32_32x32x16_bf16 v[160:175], v[64:67], v[52:55], v[160:175]
    ds_read_b64_tr_b16 v[44:45], v30 offset:0
    ds_read_b64_tr_b16 v[46:47], v30 offset:1024
    v_mfma_f32_32x32x16_bf16 v[176:191], v[68:71], v[52:55], v[176:191]
    ds_read_b64_tr_b16 v[48:49], v31 offset:0
    ds_read_b64_tr_b16 v[50:51], v31 offset:1024
    s_waitcnt lgkmcnt(6)
    v_mfma_f32_32x32x16_bf16 v[128:143], v[36:39], v[32:35], v[128:143]
    ds_read_b128 v[52:55], v25 offset:16384
    ds_read_b64_tr_b16 v[56:57], v28 offset:4096
    ds_read_b64_tr_b16 v[58:59], v28 offset:5120
    s_waitcnt lgkmcnt(7)
    v_mfma_f32_32x32x16_bf16 v[144:159], v[40:43], v[32:35], v[144:159]
    ds_read_b64_tr_b16 v[60:61], v29 offset:4096
    ds_read_b64_tr_b16 v[62:63], v29 offset:5120
    s_waitcnt lgkmcnt(7)
    v_mfma_f32_32x32x16_bf16 v[160:175], v[44:47], v[32:35], v[160:175]
    ds_read_b64_tr_b16 v[64:65], v30 offset:4096
    ds_read_b64_tr_b16 v[66:67], v30 offset:5120
    s_waitcnt lgkmcnt(7)
    v_mfma_f32_32x32x16_bf16 v[176:191], v[48:51], v[32:35], v[176:191]
    ds_read_b64_tr_b16 v[68:69], v31 offset:4096
    ds_read_b64_tr_b16 v[70:71], v31 offset:5120
    s_waitcnt lgkmcnt(6)
    v_mfma_f32_32x32x16_bf16 v[128:143], v[56:59], v[52:55], v[128:143]
    ds_read_b128 v[32:35], v26 offset:16384
    ds_read_b64_tr_b16 v[36:37], v28 offset:8192
    ds_read_b64_tr_b16 v[38:39], v28 offset:9216
    s_waitcnt lgkmcnt(7)
    v_mfma_f32_32x32x16_bf16 v[144:159], v[60:63], v[52:55], v[144:159]
    ds_read_b64_tr_b16 v[40:41], v29 offset:8192
    ds_read_b64_tr_b16 v[42:43], v29 offset:9216
    s_waitcnt lgkmcnt(7)
    v_mfma_f32_32x32x16_bf16 v[160:175], v[64:67], v[52:55], v[160:175]
    ds_read_b64_tr_b16 v[44:45], v30 offset:8192
    ds_read_b64_tr_b16 v[46:47], v30 offset:9216
    s_waitcnt lgkmcnt(7)
    v_mfma_f32_32x32x16_bf16 v[176:191], v[68:71], v[52:55], v[176:191]
    ds_read_b64_tr_b16 v[48:49], v31 offset:8192
    ds_read_b64_tr_b16 v[50:51], v31 offset:9216
    s_waitcnt lgkmcnt(6)
    v_mfma_f32_32x32x16_bf16 v[128:143], v[36:39], v[32:35], v[128:143]
    ds_read_b128 v[52:55], v27 offset:16384
    ds_read_b64_tr_b16 v[56:57], v28 offset:12288
    ds_read_b64_tr_b16 v[58:59], v28 offset:13312
    s_waitcnt lgkmcnt(7)
    v_mfma_f32_32x32x16_bf16 v[144:159], v[40:43], v[32:35], v[144:159]
    ds_read_b64_tr_b16 v[60:61], v29 offset:12288
    ds_read_b64_tr_b16 v[62:63], v29 offset:13312
    s_waitcnt lgkmcnt(7)
    v_mfma_f32_32x32x16_bf16 v[160:175], v[44:47], v[32:35], v[160:175]
    ds_read_b64_tr_b16 v[64:65], v30 offset:12288
    ds_read_b64_tr_b16 v[66:67], v30 offset:13312
    s_waitcnt lgkmcnt(7)
    v_mfma_f32_32x32x16_bf16 v[176:191], v[48:51], v[32:35], v[176:191]
    ds_read_b64_tr_b16 v[68:69], v31 offset:12288
    ds_read_b64_tr_b16 v[70:71], v31 offset:13312
    s_waitcnt lgkmcnt(6)
    v_mfma_f32_32x32x16_bf16 v[128:143], v[56:59], v[52:55], v[128:143]
    s_waitcnt lgkmcnt(0)
    s_barrier
    ds_read_b128 v[32:35], v24 offset:32768
    ds_read_b64_tr_b16 v[36:37], v28 offset:16384
    ds_read_b64_tr_b16 v[38:39], v28 offset:17408
    v_mfma_f32_32x32x16_bf16 v[144:159], v[60:63], v[52:55], v[144:159]
    ds_read_b64_tr_b16 v[40:41], v29 offset:16384
    ds_read_b64_tr_b16 v[42:43], v29 offset:17408
    v_mfma_f32_32x32x16_bf16 v[160:175], v[64:67], v[52:55], v[160:175]
    ds_read_b64_tr_b16 v[44:45], v30 offset:16384
    ds_read_b64_tr_b16 v[46:47], v30 offset:17408
    v_mfma_f32_32x32x16_bf16 v[176:191], v[68:71], v[52:55], v[176:191]
    ds_read_b64_tr_b16 v[48:49], v31 offset:16384
    ds_read_b64_tr_b16 v[50:51], v31 offset:17408
    s_waitcnt lgkmcnt(6)
    v_mfma_f32_32x32x16_bf16 v[128:143], v[36:39], v[32:35], v[128:143]
    ds_read_b128 v[52:55], v25 offset:32768
    ds_read_b64_tr_b16 v[56:57], v28 offset:20480
    ds_read_b64_tr_b16 v[58:59], v28 offset:21504
    s_waitcnt lgkmcnt(7)
    v_mfma_f32_32x32x16_bf16 v[144:159], v[40:43], v[32:35], v[144:159]
    ds_read_b64_tr_b16 v[60:61], v29 offset:20480
    ds_read_b64_tr_b16 v[62:63], v29 offset:21504
    s_waitcnt lgkmcnt(7)
    v_mfma_f32_32x32x16_bf16 v[160:175], v[44:47], v[32:35], v[160:175]
    ds_read_b64_tr_b16 v[64:65], v30 offset:20480
    ds_read_b64_tr_b16 v[66:67], v30 offset:21504
    s_waitcnt lgkmcnt(7)
    v_mfma_f32_32x32x16_bf16 v[176:191], v[48:51], v[32:35], v[176:191]
    ds_read_b64_tr_b16 v[68:69], v31 offset:20480
    ds_read_b64_tr_b16 v[70:71], v31 offset:21504
    s_waitcnt lgkmcnt(6)
    v_mfma_f32_32x32x16_bf16 v[128:143], v[56:59], v[52:55], v[128:143]
    ds_read_b128 v[32:35], v26 offset:32768
    ds_read_b64_tr_b16 v[36:37], v28 offset:24576
    ds_read_b64_tr_b16 v[38:39], v28 offset:25600
    s_waitcnt lgkmcnt(7)
    v_mfma_f32_32x32x16_bf16 v[144:159], v[60:63], v[52:55], v[144:159]
    ds_read_b64_tr_b16 v[40:41], v29 offset:24576
    ds_read_b64_tr_b16 v[42:43], v29 offset:25600
    s_waitcnt lgkmcnt(7)
    v_mfma_f32_32x32x16_bf16 v[160:175], v[64:67], v[52:55], v[160:175]
    ds_read_b64_tr_b16 v[44:45], v30 offset:24576
    ds_read_b64_tr_b16 v[46:47], v30 offset:25600
    s_waitcnt lgkmcnt(7)
    v_mfma_f32_32x32x16_bf16 v[176:191], v[68:71], v[52:55], v[176:191]
    ds_read_b64_tr_b16 v[48:49], v31 offset:24576
    ds_read_b64_tr_b16 v[50:51], v31 offset:25600
    s_waitcnt lgkmcnt(6)
    v_mfma_f32_32x32x16_bf16 v[128:143], v[36:39], v[32:35], v[128:143]
    ds_read_b128 v[52:55], v27 offset:32768
    ds_read_b64_tr_b16 v[56:57], v28 offset:28672
    ds_read_b64_tr_b16 v[58:59], v28 offset:29696
    s_waitcnt lgkmcnt(7)
    v_mfma_f32_32x32x16_bf16 v[144:159], v[40:43], v[32:35], v[144:159]
    ds_read_b64_tr_b16 v[60:61], v29 offset:28672
    ds_read_b64_tr_b16 v[62:63], v29 offset:29696
    s_waitcnt lgkmcnt(7)
    v_mfma_f32_32x32x16_bf16 v[160:175], v[44:47], v[32:35], v[160:175]
    ds_read_b64_tr_b16 v[64:65], v30 offset:28672
    ds_read_b64_tr_b16 v[66:67], v30 offset:29696
    s_waitcnt lgkmcnt(7)
    v_mfma_f32_32x32x16_bf16 v[176:191], v[48:51], v[32:35], v[176:191]
    ds_read_b64_tr_b16 v[68:69], v31 offset:28672
    ds_read_b64_tr_b16 v[70:71], v31 offset:29696
    s_waitcnt lgkmcnt(6)
    v_mfma_f32_32x32x16_bf16 v[128:143], v[56:59], v[52:55], v[128:143]
    s_waitcnt lgkmcnt(0)
    s_barrier
    ds_read_b128 v[32:35], v24 offset:49152
    ds_read_b64_tr_b16 v[36:37], v28 offset:32768
    ds_read_b64_tr_b16 v[38:39], v28 offset:33792
    v_mfma_f32_32x32x16_bf16 v[144:159], v[60:63], v[52:55], v[144:159]
    ds_read_b64_tr_b16 v[40:41], v29 offset:32768
    ds_read_b64_tr_b16 v[42:43], v29 offset:33792
    v_mfma_f32_32x32x16_bf16 v[160:175], v[64:67], v[52:55], v[160:175]
    ds_read_b64_tr_b16 v[44:45], v30 offset:32768
    ds_read_b64_tr_b16 v[46:47], v30 offset:33792
    v_mfma_f32_32x32x16_bf16 v[176:191], v[68:71], v[52:55], v[176:191]
    ds_read_b64_tr_b16 v[48:49], v31 offset:32768
    ds_read_b64_tr_b16 v[50:51], v31 offset:33792
    s_waitcnt lgkmcnt(6)
    v_mfma_f32_32x32x16_bf16 v[128:143], v[36:39], v[32:35], v[128:143]
    ds_read_b128 v[52:55], v25 offset:49152
    ds_read_b64_tr_b16 v[56:57], v28 offset:36864
    ds_read_b64_tr_b16 v[58:59], v28 offset:37888
    s_waitcnt lgkmcnt(7)
    v_mfma_f32_32x32x16_bf16 v[144:159], v[40:43], v[32:35], v[144:159]
    ds_read_b64_tr_b16 v[60:61], v29 offset:36864
    ds_read_b64_tr_b16 v[62:63], v29 offset:37888
    s_waitcnt lgkmcnt(7)
    v_mfma_f32_32x32x16_bf16 v[160:175], v[44:47], v[32:35], v[160:175]
    ds_read_b64_tr_b16 v[64:65], v30 offset:36864
    ds_read_b64_tr_b16 v[66:67], v30 offset:37888
    s_waitcnt lgkmcnt(7)
    v_mfma_f32_32x32x16_bf16 v[176:191], v[48:51], v[32:35], v[176:191]
    ds_read_b64_tr_b16 v[68:69], v31 offset:36864
    ds_read_b64_tr_b16 v[70:71], v31 offset:37888
    s_waitcnt lgkmcnt(6)
    v_mfma_f32_32x32x16_bf16 v[128:143], v[56:59], v[52:55], v[128:143]
    ds_read_b128 v[32:35], v26 offset:49152
    ds_read_b64_tr_b16 v[36:37], v28 offset:40960
    ds_read_b64_tr_b16 v[38:39], v28 offset:41984
    s_waitcnt lgkmcnt(7)
    v_mfma_f32_32x32x16_bf16 v[144:159], v[60:63], v[52:55], v[144:159]
    ds_read_b64_tr_b16 v[40:41], v29 offset:40960
    ds_read_b64_tr_b16 v[42:43], v29 offset:41984
    s_waitcnt lgkmcnt(7)
    v_mfma_f32_32x32x16_bf16 v[160:175], v[64:67], v[52:55], v[160:175]
    ds_read_b64_tr_b16 v[44:45], v30 offset:40960
    ds_read_b64_tr_b16 v[46:47], v30 offset:41984
    s_waitcnt lgkmcnt(7)
    v_mfma_f32_32x32x16_bf16 v[176:191], v[68:71], v[52:55], v[176:191]
    ds_read_b64_tr_b16 v[48:49], v31 offset:40960
    ds_read_b64_tr_b16 v[50:51], v31 offset:41984
    s_waitcnt lgkmcnt(6)
    v_mfma_f32_32x32x16_bf16 v[128:143], v[36:39], v[32:35], v[128:143]
    ds_read_b128 v[52:55], v27 offset:49152
    ds_read_b64_tr_b16 v[56:57], v28 offset:45056
    ds_read_b64_tr_b16 v[58:59], v28 offset:46080
    s_waitcnt lgkmcnt(7)
    v_mfma_f32_32x32x16_bf16 v[144:159], v[40:43], v[32:35], v[144:159]
    ds_read_b64_tr_b16 v[60:61], v29 offset:45056
    ds_read_b64_tr_b16 v[62:63], v29 offset:46080
    s_waitcnt lgkmcnt(7)
    v_mfma_f32_32x32x16_bf16 v[160:175], v[44:47], v[32:35], v[160:175]
    ds_read_b64_tr_b16 v[64:65], v30 offset:45056
    ds_read_b64_tr_b16 v[66:67], v30 offset:46080
    s_waitcnt lgkmcnt(7)
    v_mfma_f32_32x32x16_bf16 v[176:191], v[48:51], v[32:35], v[176:191]
    ds_read_b64_tr_b16 v[68:69], v31 offset:45056
    ds_read_b64_tr_b16 v[70:71], v31 offset:46080
    s_waitcnt lgkmcnt(6)
    v_mfma_f32_32x32x16_bf16 v[128:143], v[56:59], v[52:55], v[128:143]
    s_waitcnt lgkmcnt(0)
    s_barrier
    ds_read_b128 v[32:35], v24 offset:0
    ds_read_b64_tr_b16 v[36:37], v28 offset:49152
    ds_read_b64_tr_b16 v[38:39], v28 offset:50176
    v_mfma_f32_32x32x16_bf16 v[144:159], v[60:63], v[52:55], v[144:159]
    ds_read_b64_tr_b16 v[40:41], v29 offset:49152
    ds_read_b64_tr_b16 v[42:43], v29 offset:50176
    v_mfma_f32_32x32x16_bf16 v[160:175], v[64:67], v[52:55], v[160:175]
    ds_read_b64_tr_b16 v[44:45], v30 offset:49152
    ds_read_b64_tr_b16 v[46:47], v30 offset:50176
    v_mfma_f32_32x32x16_bf16 v[176:191], v[68:71], v[52:55], v[176:191]
    ds_read_b64_tr_b16 v[48:49], v31 offset:49152
    ds_read_b64_tr_b16 v[50:51], v31 offset:50176
    s_waitcnt lgkmcnt(6)
    v_mfma_f32_32x32x16_bf16 v[128:143], v[36:39], v[32:35], v[128:143]
    ds_read_b128 v[52:55], v25 offset:0
    ds_read_b64_tr_b16 v[56:57], v28 offset:53248
    ds_read_b64_tr_b16 v[58:59], v28 offset:54272
    s_waitcnt lgkmcnt(7)
    v_mfma_f32_32x32x16_bf16 v[144:159], v[40:43], v[32:35], v[144:159]
    ds_read_b64_tr_b16 v[60:61], v29 offset:53248
    ds_read_b64_tr_b16 v[62:63], v29 offset:54272
    s_waitcnt lgkmcnt(7)
    v_mfma_f32_32x32x16_bf16 v[160:175], v[44:47], v[32:35], v[160:175]
    ds_read_b64_tr_b16 v[64:65], v30 offset:53248
    ds_read_b64_tr_b16 v[66:67], v30 offset:54272
    s_waitcnt lgkmcnt(7)
    v_mfma_f32_32x32x16_bf16 v[176:191], v[48:51], v[32:35], v[176:191]
    ds_read_b64_tr_b16 v[68:69], v31 offset:53248
    ds_read_b64_tr_b16 v[70:71], v31 offset:54272
    s_cmp_eq_u32 s47, 1
    s_cbranch_scc1 .sl10
    buffer_load_dwordx2 v[112:113], v121, s[4:7], s101 offen offset:0 sc1
    buffer_load_dwordx2 v[114:115], v121, s[4:7], s101 offen offset:1024 sc1
    buffer_load_dwordx2 v[116:117], v121, s[4:7], s101 offen offset:2048 sc1
    buffer_load_dwordx2 v[118:119], v121, s[4:7], s101 offen offset:3072 sc1
.sl10:
    s_waitcnt lgkmcnt(6)
    v_mfma_f32_32x32x16_bf16 v[128:143], v[56:59], v[52:55], v[128:143]
    ds_read_b128 v[32:35], v26 offset:0
    ds_read_b64_tr_b16 v[36:37], v28 offset:57344
    ds_read_b64_tr_b16 v[38:39], v28 offset:58368
    s_waitcnt lgkmcnt(7)
    v_mfma_f32_32x32x16_bf16 v[144:159], v[60:63], v[52:55], v[144:159]
    ds_read_b64_tr_b16 v[40:41], v29 offset:57344
    ds_read_b64_tr_b16 v[42:43], v29 offset:58368
    s_waitcnt lgkmcnt(7)
    v_mfma_f32_32x32x16_bf16 v[160:175], v[64:67], v[52:55], v[160:175]
    ds_read_b64_tr_b16 v[44:45], v30 offset:57344
    ds_read_b64_tr_b16 v[46:47], v30 offset:58368
    s_waitcnt lgkmcnt(7)
    v_mfma_f32_32x32x16_bf16 v[176:191], v[68:71], v[52:55], v[176:191]
    ds_read_b64_tr_b16 v[48:49], v31 offset:57344
    ds_read_b64_tr_b16 v[50:51], v31 offset:58368
    s_waitcnt lgkmcnt(6)
    v_mfma_f32_32x32x16_bf16 v[128:143], v[36:39], v[32:35], v[128:143]
    ds_read_b128 v[52:55], v27 offset:0
    ds_read_b64_tr_b16 v[56:57], v28 offset:61440
    ds_read_b64_tr_b16 v[58:59], v28 offset:62464
    s_waitcnt lgkmcnt(7)
    v_mfma_f32_32x32x16_bf16 v[144:159], v[40:43], v[32:35], v[144:159]
    ds_read_b64_tr_b16 v[60:61], v29 offset:61440
    ds_read_b64_tr_b16 v[62:63], v29 offset:62464
    s_waitcnt lgkmcnt(7)
    v_mfma_f32_32x32x16_bf16 v[160:175], v[44:47], v[32:35], v[160:175]
    ds_read_b64_tr_b16 v[64:65], v30 offset:61440
    ds_read_b64_tr_b16 v[66:67], v30 offset:62464
    s_waitcnt lgkmcnt(7)
    v_mfma_f32_32x32x16_bf16 v[176:191], v[48:51], v[32:35], v[176:191]
    ds_read_b64_tr_b16 v[68:69], v31 offset:61440
    ds_read_b64_tr_b16 v[70:71], v31 offset:62464
    s_waitcnt lgkmcnt(6)
    v_mfma_f32_32x32x16_bf16 v[128:143], v[56:59], v[52:55], v[128:143]
    s_waitcnt lgkmcnt(0)
    s_barrier
    ds_read_b128 v[32:35], v24 offset:16384
    ds_read_b64_tr_b16 v[36:37], v108 offset:0
    ds_read_b64_tr_b16 v[38:39], v108 offset:1024
    v_mfma_f32_32x32x16_bf16 v[144:159], v[60:63], v[52:55], v[144:159]
    ds_read_b64_tr_b16 v[40:41], v109 offset:0
    ds_read_b64_tr_b16 v[42:43], v109 offset:1024
    v_mfma_f32_32x32x16_bf16 v[160:175], v[64:67], v[52:55], v[160:175]
    ds_read_b64_tr_b16 v[44:45], v110 offset:0
    ds_read_b64_tr_b16 v[46:47], v110 offset:1024
    v_mfma_f32_32x32x16_bf16 v[176:191], v[68:71], v[52:55], v[176:191]
    ds_read_b64_tr_b16 v[48:49], v111 offset:0
    ds_read_b64_tr_b16 v[50:51], v111 offset:1024
    s_waitcnt lgkmcnt(6)
    v_mfma_f32_32x32x16_bf16 v[128:143], v[36:39], v[32:35], v[128:143]
    ds_read_b128 v[52:55], v25 offset:16384
    ds_read_b64_tr_b16 v[56:57], v108 offset:4096
    ds_read_b64_tr_b16 v[58:59], v108 offset:5120
    s_waitcnt lgkmcnt(7)
    v_mfma_f32_32x32x16_bf16 v[144:159], v[40:43], v[32:35], v[144:159]
    ds_read_b64_tr_b16 v[60:61], v109 offset:4096
    ds_read_b64_tr_b16 v[62:63], v109 offset:5120
    s_waitcnt lgkmcnt(7)
    v_mfma_f32_32x32x16_bf16 v[160:175], v[44:47], v[32:35], v[160:175]
    ds_read_b64_tr_b16 v[64:65], v110 offset:4096
    ds_read_b64_tr_b16 v[66:67], v110 offset:5120
    s_waitcnt lgkmcnt(7)
    v_mfma_f32_32x32x16_bf16 v[176:191], v[48:51], v[32:35], v[176:191]
    ds_read_b64_tr_b16 v[68:69], v111 offset:4096
    ds_read_b64_tr_b16 v[70:71], v111 offset:5120
    s_waitcnt lgkmcnt(6)
    v_mfma_f32_32x32x16_bf16 v[128:143], v[56:59], v[52:55], v[128:143]
    ds_read_b128 v[32:35], v26 offset:16384
    ds_read_b64_tr_b16 v[36:37], v108 offset:8192
    ds_read_b64_tr_b16 v[38:39], v108 offset:9216
    s_waitcnt lgkmcnt(7)
    v_mfma_f32_32x32x16_bf16 v[144:159], v[60:63], v[52:55], v[144:159]
    ds_read_b64_tr_b16 v[40:41], v109 offset:8192
    ds_read_b64_tr_b16 v[42:43], v109 offset:9216
    s_waitcnt lgkmcnt(7)
    v_mfma_f32_32x32x16_bf16 v[160:175], v[64:67], v[52:55], v[160:175]
    ds_read_b64_tr_b16 v[44:45], v110 offset:8192
    ds_read_b64_tr_b16 v[46:47], v110 offset:9216
    s_waitcnt lgkmcnt(7)
    v_mfma_f32_32x32x16_bf16 v[176:191], v[68:71], v[52:55], v[176:191]
    ds_read_b64_tr_b16 v[48:49], v111 offset:8192
    ds_read_b64_tr_b16 v[50:51], v111 offset:9216
    s_waitcnt lgkmcnt(6)
    v_mfma_f32_32x32x16_bf16 v[128:143], v[36:39], v[32:35], v[128:143]
    ds_read_b128 v[52:55], v27 offset:16384
    ds_read_b64_tr_b16 v[56:57], v108 offset:12288
    ds_read_b64_tr_b16 v[58:59], v108 offset:13312
    s_waitcnt lgkmcnt(7)
    v_mfma_f32_32x32x16_bf16 v[144:159], v[40:43], v[32:35], v[144:159]
    ds_read_b64_tr_b16 v[60:61], v109 offset:12288
    ds_read_b64_tr_b16 v[62:63], v109 offset:13312
    s_waitcnt lgkmcnt(7)
    v_mfma_f32_32x32x16_bf16 v[160:175], v[44:47], v[32:35], v[160:175]
    ds_read_b64_tr_b16 v[64:65], v110 offset:12288
    ds_read_b64_tr_b16 v[66:67], v110 offset:13312
    s_waitcnt lgkmcnt(7)
    v_mfma_f32_32x32x16_bf16 v[176:191], v[48:51], v[32:35], v[176:191]
    ds_read_b64_tr_b16 v[68:69], v111 offset:12288
    ds_read_b64_tr_b16 v[70:71], v111 offset:13312
    s_waitcnt lgkmcnt(6)
    v_mfma_f32_32x32x16_bf16 v[128:143], v[56:59], v[52:55], v[128:143]
    s_waitcnt lgkmcnt(0)
    s_barrier
    v_mfma_f32_32x32x16_bf16 v[144:159], v[60:63], v[52:55], v[144:159]
    v_mfma_f32_32x32x16_bf16 v[160:175], v[64:67], v[52:55], v[160:175]
    v_mfma_f32_32x32x16_bf16 v[176:191], v[68:71], v[52:55], v[176:191]
    v_lshlrev_b32 v29, 5, v101
    v_add_u32 v29, 0x27000, v29
    ds_read_b128 v[32:35], v29 offset:0
    ds_read_b128 v[36:39], v29 offset:16
    ds_read_b128 v[40:43], v29 offset:64
    ds_read_b128 v[44:47], v29 offset:80
    v_lshlrev_b32 v28, 11, v101
    v_lshl_add_u32 v28, v102, 4, v28
    s_mul_i32 s52, s44, 491520
    s_lshl_b32 s53, s45, 15
    s_add_u32 s52, s52, 0x100000
    s_cmp_lt_u32 s45, 5
    s_cselect_b32 s54, 0x3ea52b5c, 1.0
    s_add_u32 s52, s52, s53
    s_add_u32 s52, s52, s49
    s_waitcnt vmcnt(0)
    v_pk_add_f32 v[112:113], v[112:113], v[114:115]
    v_pk_add_f32 v[116:117], v[116:117], v[118:119]
    v_pk_add_f32 v[112:113], v[112:113], v[116:117]
    v_mov_b32 v114, v112
    v_mov_b32 v115, v113
    s_nop 1
    v_permlane32_swap_b32 v112, v114
    v_permlane32_swap_b32 v113, v115
    s_nop 1
    v_pk_add_f32 v[112:113], v[112:113], v[114:115]
    v_mul_f32 v96, 0xbacccccd, v112
    v_mul_f32 v97, 0x3acccccd, v113
    v_fma_f32 v97, -v96, v96, v97
    v_max_f32 v97, 0, v97
    v_add_f32 v97, 0x3727c5ac, v97
    v_rsq_f32 v97, v97
    v_mov_b32 v24, v96
    v_mov_b32 v25, v96
    v_mul_f32 v26, s54, v97
    v_mul_f32 v27, s54, v97
    s_nop 4
    ds_read_b128 v[48:51], v29 offset:128
    ds_read_b128 v[52:55], v29 offset:144
    ds_read_b128 v[56:59], v29 offset:192
    ds_read_b128 v[60:63], v29 offset:208
    s_waitcnt lgkmcnt(4)
    v_pk_fma_f32 v[128:129], v[24:25], v[32:33], v[128:129]
    v_pk_fma_f32 v[130:131], v[24:25], v[34:35], v[130:131]
    v_pk_fma_f32 v[132:133], v[24:25], v[36:37], v[132:133]
    v_pk_fma_f32 v[134:135], v[24:25], v[38:39], v[134:135]
    v_pk_fma_f32 v[136:137], v[24:25], v[40:41], v[136:137]
    v_pk_fma_f32 v[138:139], v[24:25], v[42:43], v[138:139]
    v_pk_fma_f32 v[140:141], v[24:25], v[44:45], v[140:141]
    v_pk_fma_f32 v[142:143], v[24:25], v[46:47], v[142:143]
    v_pk_mul_f32 v[128:129], v[128:129], v[26:27]
    v_pk_mul_f32 v[130:131], v[130:131], v[26:27]
    v_pk_mul_f32 v[132:133], v[132:133], v[26:27]
    v_pk_mul_f32 v[134:135], v[134:135], v[26:27]
    v_pk_mul_f32 v[136:137], v[136:137], v[26:27]
    v_pk_mul_f32 v[138:139], v[138:139], v[26:27]
    v_pk_mul_f32 v[140:141], v[140:141], v[26:27]
    v_pk_mul_f32 v[142:143], v[142:143], v[26:27]
    v_cvt_pk_bf16_f32 v64, v128, v129
    v_cvt_pk_bf16_f32 v65, v130, v131
    v_cvt_pk_bf16_f32 v66, v132, v133
    v_cvt_pk_bf16_f32 v67, v134, v135
    v_cvt_pk_bf16_f32 v68, v136, v137
    v_cvt_pk_bf16_f32 v69, v138, v139
    v_cvt_pk_bf16_f32 v70, v140, v141
    v_cvt_pk_bf16_f32 v71, v142, v143
    buffer_store_dwordx4 v[64:67], v28, s[4:7], s52 offen sc1
    s_add_u32 s52, s52, 4096
    buffer_store_dwordx4 v[68:71], v28, s[4:7], s52 offen sc1
    s_add_u32 s52, s52, 4096
    ds_read_b128 v[32:35], v29 offset:256
    ds_read_b128 v[36:39], v29 offset:272
    ds_read_b128 v[40:43], v29 offset:320
    ds_read_b128 v[44:47], v29 offset:336
    s_waitcnt lgkmcnt(4)
    v_pk_fma_f32 v[144:145], v[24:25], v[48:49], v[144:145]
    v_pk_fma_f32 v[146:147], v[24:25], v[50:51], v[146:147]
    v_pk_fma_f32 v[148:149], v[24:25], v[52:53], v[148:149]
    v_pk_fma_f32 v[150:151], v[24:25], v[54:55], v[150:151]
    v_pk_fma_f32 v[152:153], v[24:25], v[56:57], v[152:153]
    v_pk_fma_f32 v[154:155], v[24:25], v[58:59], v[154:155]
    v_pk_fma_f32 v[156:157], v[24:25], v[60:61], v[156:157]
    v_pk_fma_f32 v[158:159], v[24:25], v[62:63], v[158:159]
    v_pk_mul_f32 v[144:145], v[144:145], v[26:27]
    v_pk_mul_f32 v[146:147], v[146:147], v[26:27]
    v_pk_mul_f32 v[148:149], v[148:149], v[26:27]
    v_pk_mul_f32 v[150:151], v[150:151], v[26:27]
    v_pk_mul_f32 v[152:153], v[152:153], v[26:27]
    v_pk_mul_f32 v[154:155], v[154:155], v[26:27]
    v_pk_mul_f32 v[156:157], v[156:157], v[26:27]
    v_pk_mul_f32 v[158:159], v[158:159], v[26:27]
    v_cvt_pk_bf16_f32 v72, v144, v145
    v_cvt_pk_bf16_f32 v73, v146, v147
    v_cvt_pk_bf16_f32 v74, v148, v149
    v_cvt_pk_bf16_f32 v75, v150, v151
    v_cvt_pk_bf16_f32 v76, v152, v153
    v_cvt_pk_bf16_f32 v77, v154, v155
    v_cvt_pk_bf16_f32 v78, v156, v157
    v_cvt_pk_bf16_f32 v79, v158, v159
    buffer_store_dwordx4 v[72:75], v28, s[4:7], s52 offen sc1
    s_add_u32 s52, s52, 4096
    buffer_store_dwordx4 v[76:79], v28, s[4:7], s52 offen sc1
    s_add_u32 s52, s52, 4096
    ds_read_b128 v[48:51], v29 offset:384
    ds_read_b128 v[52:55], v29 offset:400
    ds_read_b128 v[56:59], v29 offset:448
    ds_read_b128 v[60:63], v29 offset:464
    s_waitcnt lgkmcnt(4)
    v_pk_fma_f32 v[160:161], v[24:25], v[32:33], v[160:161]
    v_pk_fma_f32 v[162:163], v[24:25], v[34:35], v[162:163]
    v_pk_fma_f32 v[164:165], v[24:25], v[36:37], v[164:165]
    v_pk_fma_f32 v[166:167], v[24:25], v[38:39], v[166:167]
    v_pk_fma_f32 v[168:169], v[24:25], v[40:41], v[168:169]
    v_pk_fma_f32 v[170:171], v[24:25], v[42:43], v[170:171]
    v_pk_fma_f32 v[172:173], v[24:25], v[44:45], v[172:173]
    v_pk_fma_f32 v[174:175], v[24:25], v[46:47], v[174:175]
    v_pk_mul_f32 v[160:161], v[160:161], v[26:27]
    v_pk_mul_f32 v[162:163], v[162:163], v[26:27]
    v_pk_mul_f32 v[164:165], v[164:165], v[26:27]
    v_pk_mul_f32 v[166:167], v[166:167], v[26:27]
    v_pk_mul_f32 v[168:169], v[168:169], v[26:27]
    v_pk_mul_f32 v[170:171], v[170:171], v[26:27]
    v_pk_mul_f32 v[172:173], v[172:173], v[26:27]
    v_pk_mul_f32 v[174:175], v[174:175], v[26:27]
    v_cvt_pk_bf16_f32 v64, v160, v161
    v_cvt_pk_bf16_f32 v65, v162, v163
    v_cvt_pk_bf16_f32 v66, v164, v165
    v_cvt_pk_bf16_f32 v67, v166, v167
    v_cvt_pk_bf16_f32 v68, v168, v169
    v_cvt_pk_bf16_f32 v69, v170, v171
    v_cvt_pk_bf16_f32 v70, v172, v173
    v_cvt_pk_bf16_f32 v71, v174, v175
    buffer_store_dwordx4 v[64:67], v28, s[4:7], s52 offen sc1
    s_add_u32 s52, s52, 4096
    buffer_store_dwordx4 v[68:71], v28, s[4:7], s52 offen sc1
    s_add_u32 s52, s52, 4096
    s_waitcnt lgkmcnt(0)
    v_pk_fma_f32 v[176:177], v[24:25], v[48:49], v[176:177]
    v_pk_fma_f32 v[178:179], v[24:25], v[50:51], v[178:179]
    v_pk_fma_f32 v[180:181], v[24:25], v[52:53], v[180:181]
    v_pk_fma_f32 v[182:183], v[24:25], v[54:55], v[182:183]
    v_pk_fma_f32 v[184:185], v[24:25], v[56:57], v[184:185]
    v_pk_fma_f32 v[186:187], v[24:25], v[58:59], v[186:187]
    v_pk_fma_f32 v[188:189], v[24:25], v[60:61], v[188:189]
    v_pk_fma_f32 v[190:191], v[24:25], v[62:63], v[190:191]
    v_pk_mul_f32 v[176:177], v[176:177], v[26:27]
    v_pk_mul_f32 v[178:179], v[178:179], v[26:27]
    v_pk_mul_f32 v[180:181], v[180:181], v[26:27]
    v_pk_mul_f32 v[182:183], v[182:183], v[26:27]
    v_pk_mul_f32 v[184:185], v[184:185], v[26:27]
    v_pk_mul_f32 v[186:187], v[186:187], v[26:27]
    v_pk_mul_f32 v[188:189], v[188:189], v[26:27]
    v_pk_mul_f32 v[190:191], v[190:191], v[26:27]
    v_cvt_pk_bf16_f32 v72, v176, v177
    v_cvt_pk_bf16_f32 v73, v178, v179
    v_cvt_pk_bf16_f32 v74, v180, v181
    v_cvt_pk_bf16_f32 v75, v182, v183
    v_cvt_pk_bf16_f32 v76, v184, v185
    v_cvt_pk_bf16_f32 v77, v186, v187
    v_cvt_pk_bf16_f32 v78, v188, v189
    v_cvt_pk_bf16_f32 v79, v190, v191
    buffer_store_dwordx4 v[72:75], v28, s[4:7], s52 offen sc1
    s_add_u32 s52, s52, 4096
    buffer_store_dwordx4 v[76:79], v28, s[4:7], s52 offen sc1
    s_add_u32 s52, s52, 4096
.ed11:
    s_waitcnt vmcnt(0) lgkmcnt(0)
    s_barrier
L_c1:
    v_and_b32 v30, 31, v0
    v_lshrrev_b32 v31, 5, v0
    v_lshlrev_b32 v31, 2, v31
    v_sub_u32 v30, v30, v31
    v_cmp_gt_i32 s[64:65], 0, v30
    v_cmp_gt_i32 s[66:67], 1, v30
    v_cmp_gt_i32 s[68:69], 2, v30
    v_cmp_gt_i32 s[70:71], 3, v30
    v_cmp_gt_i32 s[72:73], 8, v30
    v_cmp_gt_i32 s[74:75], 9, v30
    v_cmp_gt_i32 s[76:77], 10, v30
    v_cmp_gt_i32 s[78:79], 11, v30
    v_cmp_gt_i32 s[80:81], 16, v30
    v_cmp_gt_i32 s[82:83], 17, v30
    v_cmp_gt_i32 s[84:85], 18, v30
    v_cmp_gt_i32 s[86:87], 19, v30
    v_cmp_gt_i32 s[88:89], 24, v30
    v_cmp_gt_i32 s[90:91], 25, v30
    v_cmp_gt_i32 s[92:93], 26, v30
    v_cmp_gt_i32 s[94:95], 27, v30
L_att:
    s_setprio 0
    s_lshr_b32 s54, s46, 2
    s_and_b32 s55, s46, 3
    s_mul_i32 s56, s54, 3
    v_and_b32 v38, 31, v0
    s_lshl_b32 s52, s55, 9
    v_lshl_add_u32 v38, v38, 4, s52
    v_lshrrev_b32 v39, 5, v0
    v_add_u32 v36, s56, v39
    v_mul_u32_u24 v30, 6208, v36
    v_add_u32 v30, v30, v38
    v_add_u32 v30, 0x15580, v30
    s_lshl_b32 s53, s54, 3
    s_add_u32 s52, s53, 0x18600
    v_add_u32 v31, s52, v38
    v_lshl_add_u32 v34, v36, 11, v38
    s_add_u32 s52, s53, 4096
    v_add_u32 v35, s52, v38
    v_add_u32 v36, 0x24800, v34
    v_add_u32 v37, 0x24800, v35
    v_lshl_add_u32 v35, v39, 29, v35
    v_bfe_u32 v40, v0, 2, 2
    v_and_b32 v41, 3, v0
    v_bfe_u32 v42, v0, 4, 1
    v_lshrrev_b32 v43, 5, v0
    v_lshl_add_u32 v40, v43, 2, v40
    v_lshlrev_b32 v40, 4, v40
    v_and_b32 v44, 1, v41
    v_add_u32 v44, s56, v44
    v_mul_u32_u24 v44, 6208, v44
    v_lshrrev_b32 v45, 1, v41
    v_lshl_add_u32 v44, v45, 3, v44
    s_add_u32 s52, s53, 12416
    v_mov_b32 v45, s52
    v_cmp_eq_u32 vcc, 1, v42
    s_nop 1
    v_cndmask_b32 v44, v44, v45, vcc
    s_lshl_b32 s52, s55, 9
    s_add_u32 s52, s52, 0x1cec0
    v_add_u32 v44, s52, v44
    v_mul_u32_u24 v45, v42, v41
    v_cmp_ne_u32 vcc, 0, v45
    v_mov_b32 v45, 0x27800
    v_mov_b32 v46, 512
    v_cndmask_b32 v44, v44, v45, vcc
    v_cndmask_b32 v33, v46, 0, vcc
    v_add_u32 v32, v44, v40
    s_lshl_b32 s57, s44, 2
    s_add_u32 s57, s57, s55
    s_sub_i32 s57, 8, s57
    s_mul_i32 s58, s44, 163840
    s_mul_i32 s52, s45, 10240
    s_add_u32 s58, s58, s52
    s_add_u32 s58, s58, s49
    s_add_u32 s58, s58, 0x900000
    v_mov_b32 v94, 0xffff
    v_mov_b32 v95, 0xffff0000
    v_cndmask_b32 v96, 0, v94, s[64:65]
    v_cndmask_b32 v104, 0, v95, s[66:67]
    v_or_b32 v96, v96, v104
    v_cndmask_b32 v97, 0, v94, s[68:69]
    v_cndmask_b32 v104, 0, v95, s[70:71]
    v_or_b32 v97, v97, v104
    v_cndmask_b32 v98, 0, v94, s[72:73]
    v_cndmask_b32 v104, 0, v95, s[74:75]
    v_or_b32 v98, v98, v104
    v_cndmask_b32 v99, 0, v94, s[76:77]
    v_cndmask_b32 v104, 0, v95, s[78:79]
    v_or_b32 v99, v99, v104
    v_cndmask_b32 v100, 0, v94, s[80:81]
    v_cndmask_b32 v104, 0, v95, s[82:83]
    v_or_b32 v100, v100, v104
    v_cndmask_b32 v101, 0, v94, s[84:85]
    v_cndmask_b32 v104, 0, v95, s[86:87]
    v_or_b32 v101, v101, v104
    v_cndmask_b32 v102, 0, v94, s[88:89]
    v_cndmask_b32 v104, 0, v95, s[90:91]
    v_or_b32 v102, v102, v104
    v_cndmask_b32 v103, 0, v94, s[92:93]
    v_cndmask_b32 v104, 0, v95, s[94:95]
    v_or_b32 v103, v103, v104
    v_cmp_eq_u32 vcc, 0, v39
    v_mov_b32 v94, 0x3f803f80
    s_nop 1
    v_cndmask_b32 v94, 0, v94, vcc
    v_mov_b32 v95, v94
    s_waitcnt vmcnt(10)
    s_barrier
    ds_read_b128 v[24:27], v36
    ds_read_b64 v[28:29], v37
    ds_read_b128 v[44:47], v30 offset:512
    ds_read_b64 v[78:79], v31 offset:512
    ds_read_b128 v[48:51], v30 offset:1024
    ds_read_b64 v[80:81], v31 offset:1024
    ds_read_b128 v[52:55], v30 offset:1536
    ds_read_b64 v[82:83], v31 offset:1536
    ds_read_b128 v[56:59], v30 offset:2048
    ds_read_b128 v[60:63], v30 offset:2560
    ds_read_b128 v[64:67], v30 offset:3072
    ds_read_b128 v[68:71], v30 offset:3584
    ds_read_b128 v[40:43], v30 offset:0
    ds_read_b128 v[72:75], v30 offset:4096
    s_waitcnt lgkmcnt(11)
    v_mfma_f32_32x32x16_bf16 v[128:143], v[44:47], v[24:27], 0
    ds_read_b64 v[84:85], v31 offset:2048
    v_cndmask_b32 v28, 0, v28, vcc
    v_cndmask_b32 v29, 0, v29, vcc
    s_waitcnt lgkmcnt(10)
    v_mfma_f32_32x32x16_bf16 v[144:159], v[48:51], v[24:27], 0
    ds_read_b64 v[86:87], v31 offset:2560
    s_waitcnt lgkmcnt(9)
    v_mfma_f32_32x32x16_bf16 v[160:175], v[52:55], v[24:27], 0
    ds_read_b64 v[88:89], v31 offset:3072
    v_mfma_f32_32x32x8_bf16 v[128:143], v[78:79], v[28:29], v[128:143]
    s_waitcnt lgkmcnt(8)
    v_mfma_f32_32x32x16_bf16 v[176:191], v[56:59], v[24:27], 0
    ds_read_b64 v[90:91], v31 offset:3584
    v_mfma_f32_32x32x8_bf16 v[144:159], v[80:81], v[28:29], v[144:159]
    s_waitcnt lgkmcnt(8)
    v_mfma_f32_32x32x16_bf16 v[192:207], v[60:63], v[24:27], 0
    ds_read_b64 v[76:77], v31 offset:0
    v_mfma_f32_32x32x8_bf16 v[160:175], v[82:83], v[28:29], v[160:175]
    s_nop 7
    v_max_f32 v36, v128, v129
    v_max_f32 v37, v130, v131
    v_max3_f32 v36, v132, v133, v36
    v_max3_f32 v37, v134, v135, v37
    v_max3_f32 v36, v136, v137, v36
    v_max3_f32 v37, v138, v139, v37
    v_max3_f32 v36, v140, v141, v36
    v_max3_f32 v37, v142, v143, v37
    s_waitcnt lgkmcnt(8)
    v_mfma_f32_32x32x16_bf16 v[208:223], v[64:67], v[24:27], 0
    ds_read_b64 v[92:93], v31 offset:4096
    s_waitcnt lgkmcnt(5)
    v_mfma_f32_32x32x8_bf16 v[176:191], v[84:85], v[28:29], v[176:191]
    v_max3_f32 v36, v144, v145, v36
    v_max3_f32 v37, v146, v147, v37
    v_max3_f32 v36, v148, v149, v36
    v_max3_f32 v37, v150, v151, v37
    v_max3_f32 v36, v152, v153, v36
    v_max3_f32 v37, v154, v155, v37
    v_max3_f32 v36, v156, v157, v36
    v_max3_f32 v37, v158, v159, v37
    v_mfma_f32_32x32x16_bf16 v[224:239], v[68:71], v[24:27], 0
    s_waitcnt lgkmcnt(4)
    v_mfma_f32_32x32x8_bf16 v[192:207], v[86:87], v[28:29], v[192:207]
    v_max3_f32 v36, v160, v161, v36
    v_max3_f32 v37, v162, v163, v37
    v_max3_f32 v36, v164, v165, v36
    v_max3_f32 v37, v166, v167, v37
    v_max3_f32 v36, v168, v169, v36
    v_max3_f32 v37, v170, v171, v37
    v_max3_f32 v36, v172, v173, v36
    v_max3_f32 v37, v174, v175, v37
    v_mfma_f32_32x32x16_bf16 v[112:127], v[40:43], v[24:27], 0
    s_waitcnt lgkmcnt(3)
    v_mfma_f32_32x32x8_bf16 v[208:223], v[88:89], v[28:29], v[208:223]
    v_max3_f32 v36, v176, v177, v36
    v_max3_f32 v37, v178, v179, v37
    v_max3_f32 v36, v180, v181, v36
    v_max3_f32 v37, v182, v183, v37
    v_max3_f32 v36, v184, v185, v36
    v_max3_f32 v37, v186, v187, v37
    v_max3_f32 v36, v188, v189, v36
    v_max3_f32 v37, v190, v191, v37
    v_mfma_f32_32x32x16_bf16 v[240:255], v[72:75], v[24:27], 0
    s_waitcnt lgkmcnt(2)
    v_mfma_f32_32x32x8_bf16 v[224:239], v[90:91], v[28:29], v[224:239]
    v_max3_f32 v36, v192, v193, v36
    v_max3_f32 v37, v194, v195, v37
    v_max3_f32 v36, v196, v197, v36
    v_max3_f32 v37, v198, v199, v37
    v_max3_f32 v36, v200, v201, v36
    v_max3_f32 v37, v202, v203, v37
    v_max3_f32 v36, v204, v205, v36
    v_max3_f32 v37, v206, v207, v37
    s_waitcnt lgkmcnt(1)
    v_mfma_f32_32x32x8_bf16 v[112:127], v[76:77], v[28:29], v[112:127]
    v_max3_f32 v36, v208, v209, v36
    v_max3_f32 v37, v210, v211, v37
    v_max3_f32 v36, v212, v213, v36
    v_max3_f32 v37, v214, v215, v37
    v_max3_f32 v36, v216, v217, v36
    v_max3_f32 v37, v218, v219, v37
    v_max3_f32 v36, v220, v221, v36
    v_max3_f32 v37, v222, v223, v37
    s_waitcnt lgkmcnt(0)
    v_mfma_f32_32x32x8_bf16 v[240:255], v[92:93], v[28:29], v[240:255]
    v_max3_f32 v36, v224, v225, v36
    v_max3_f32 v37, v226, v227, v37
    v_max3_f32 v36, v228, v229, v36
    v_max3_f32 v37, v230, v231, v37
    v_max3_f32 v36, v232, v233, v36
    v_max3_f32 v37, v234, v235, v37
    v_max3_f32 v36, v236, v237, v36
    v_max3_f32 v37, v238, v239, v37
    s_cmp_lt_i32 s57, 1
    s_cbranch_scc1 .tv12
    s_nop 7
    v_mov_b32 v112, 0xf149f2ca
    v_mov_b32 v113, 0xf149f2ca
    v_mov_b32 v114, 0xf149f2ca
    v_mov_b32 v115, 0xf149f2ca
    v_mov_b32 v116, 0xf149f2ca
    v_mov_b32 v117, 0xf149f2ca
    v_mov_b32 v118, 0xf149f2ca
    v_mov_b32 v119, 0xf149f2ca
    v_mov_b32 v120, 0xf149f2ca
    v_mov_b32 v121, 0xf149f2ca
    v_mov_b32 v122, 0xf149f2ca
    v_mov_b32 v123, 0xf149f2ca
    v_mov_b32 v124, 0xf149f2ca
    v_mov_b32 v125, 0xf149f2ca
    v_mov_b32 v126, 0xf149f2ca
    v_mov_b32 v127, 0xf149f2ca
    s_cmp_lt_i32 s57, 2
    s_cbranch_scc1 .tw13
    v_mov_b32 v128, 0xf149f2ca
    v_mov_b32 v129, 0xf149f2ca
    v_mov_b32 v130, 0xf149f2ca
    v_mov_b32 v131, 0xf149f2ca
    v_mov_b32 v132, 0xf149f2ca
    v_mov_b32 v133, 0xf149f2ca
    v_mov_b32 v134, 0xf149f2ca
    v_mov_b32 v135, 0xf149f2ca
    v_mov_b32 v136, 0xf149f2ca
    v_mov_b32 v137, 0xf149f2ca
    v_mov_b32 v138, 0xf149f2ca
    v_mov_b32 v139, 0xf149f2ca
    v_mov_b32 v140, 0xf149f2ca
    v_mov_b32 v141, 0xf149f2ca
    v_mov_b32 v142, 0xf149f2ca
    v_mov_b32 v143, 0xf149f2ca
    s_cmp_lt_i32 s57, 3
    s_cbranch_scc1 .tw13
    v_mov_b32 v144, 0xf149f2ca
    v_mov_b32 v145, 0xf149f2ca
    v_mov_b32 v146, 0xf149f2ca
    v_mov_b32 v147, 0xf149f2ca
    v_mov_b32 v148, 0xf149f2ca
    v_mov_b32 v149, 0xf149f2ca
    v_mov_b32 v150, 0xf149f2ca
    v_mov_b32 v151, 0xf149f2ca
    v_mov_b32 v152, 0xf149f2ca
    v_mov_b32 v153, 0xf149f2ca
    v_mov_b32 v154, 0xf149f2ca
    v_mov_b32 v155, 0xf149f2ca
    v_mov_b32 v156, 0xf149f2ca
    v_mov_b32 v157, 0xf149f2ca
    v_mov_b32 v158, 0xf149f2ca
    v_mov_b32 v159, 0xf149f2ca
    s_cmp_lt_i32 s57, 4
    s_cbranch_scc1 .tw13
    v_mov_b32 v160, 0xf149f2ca
    v_mov_b32 v161, 0xf149f2ca
    v_mov_b32 v162, 0xf149f2ca
    v_mov_b32 v163, 0xf149f2ca
    v_mov_b32 v164, 0xf149f2ca
    v_mov_b32 v165, 0xf149f2ca
    v_mov_b32 v166, 0xf149f2ca
    v_mov_b32 v167, 0xf149f2ca
    v_mov_b32 v168, 0xf149f2ca
    v_mov_b32 v169, 0xf149f2ca
    v_mov_b32 v170, 0xf149f2ca
    v_mov_b32 v171, 0xf149f2ca
    v_mov_b32 v172, 0xf149f2ca
    v_mov_b32 v173, 0xf149f2ca
    v_mov_b32 v174, 0xf149f2ca
    v_mov_b32 v175, 0xf149f2ca
    s_cmp_lt_i32 s57, 5
    s_cbranch_scc1 .tw13
    v_mov_b32 v176, 0xf149f2ca
    v_mov_b32 v177, 0xf149f2ca
    v_mov_b32 v178, 0xf149f2ca
    v_mov_b32 v179, 0xf149f2ca
    v_mov_b32 v180, 0xf149f2ca
    v_mov_b32 v181, 0xf149f2ca
    v_mov_b32 v182, 0xf149f2ca
    v_mov_b32 v183, 0xf149f2ca
    v_mov_b32 v184, 0xf149f2ca
    v_mov_b32 v185, 0xf149f2ca
    v_mov_b32 v186, 0xf149f2ca
    v_mov_b32 v187, 0xf149f2ca
    v_mov_b32 v188, 0xf149f2ca
    v_mov_b32 v189, 0xf149f2ca
    v_mov_b32 v190, 0xf149f2ca
    v_mov_b32 v191, 0xf149f2ca
    s_cmp_lt_i32 s57, 6
    s_cbranch_scc1 .tw13
    v_mov_b32 v192, 0xf149f2ca
    v_mov_b32 v193, 0xf149f2ca
    v_mov_b32 v194, 0xf149f2ca
    v_mov_b32 v195, 0xf149f2ca
    v_mov_b32 v196, 0xf149f2ca
    v_mov_b32 v197, 0xf149f2ca
    v_mov_b32 v198, 0xf149f2ca
    v_mov_b32 v199, 0xf149f2ca
    v_mov_b32 v200, 0xf149f2ca
    v_mov_b32 v201, 0xf149f2ca
    v_mov_b32 v202, 0xf149f2ca
    v_mov_b32 v203, 0xf149f2ca
    v_mov_b32 v204, 0xf149f2ca
    v_mov_b32 v205, 0xf149f2ca
    v_mov_b32 v206, 0xf149f2ca
    v_mov_b32 v207, 0xf149f2ca
    s_cmp_lt_i32 s57, 7
    s_cbranch_scc1 .tw13
    v_mov_b32 v208, 0xf149f2ca
    v_mov_b32 v209, 0xf149f2ca
    v_mov_b32 v210, 0xf149f2ca
    v_mov_b32 v211, 0xf149f2ca
    v_mov_b32 v212, 0xf149f2ca
    v_mov_b32 v213, 0xf149f2ca
    v_mov_b32 v214, 0xf149f2ca
    v_mov_b32 v215, 0xf149f2ca
    v_mov_b32 v216, 0xf149f2ca
    v_mov_b32 v217, 0xf149f2ca
    v_mov_b32 v218, 0xf149f2ca
    v_mov_b32 v219, 0xf149f2ca
    v_mov_b32 v220, 0xf149f2ca
    v_mov_b32 v221, 0xf149f2ca
    v_mov_b32 v222, 0xf149f2ca
    v_mov_b32 v223, 0xf149f2ca
    s_cmp_lt_i32 s57, 8
    s_cbranch_scc1 .tw13
    v_mov_b32 v224, 0xf149f2ca
    v_mov_b32 v225, 0xf149f2ca
    v_mov_b32 v226, 0xf149f2ca
    v_mov_b32 v227, 0xf149f2ca
    v_mov_b32 v228, 0xf149f2ca
    v_mov_b32 v229, 0xf149f2ca
    v_mov_b32 v230, 0xf149f2ca
    v_mov_b32 v231, 0xf149f2ca
    v_mov_b32 v232, 0xf149f2ca
    v_mov_b32 v233, 0xf149f2ca
    v_mov_b32 v234, 0xf149f2ca
    v_mov_b32 v235, 0xf149f2ca
    v_mov_b32 v236, 0xf149f2ca
    v_mov_b32 v237, 0xf149f2ca
    v_mov_b32 v238, 0xf149f2ca
    v_mov_b32 v239, 0xf149f2ca
.tw13:
    v_max_f32 v36, v128, v129
    v_max_f32 v37, v130, v131
    v_max3_f32 v36, v132, v133, v36
    v_max3_f32 v37, v134, v135, v37
    v_max3_f32 v36, v136, v137, v36
    v_max3_f32 v37, v138, v139, v37
    v_max3_f32 v36, v140, v141, v36
    v_max3_f32 v37, v142, v143, v37
    v_max3_f32 v36, v144, v145, v36
    v_max3_f32 v37, v146, v147, v37
    v_max3_f32 v36, v148, v149, v36
    v_max3_f32 v37, v150, v151, v37
    v_max3_f32 v36, v152, v153, v36
    v_max3_f32 v37, v154, v155, v37
    v_max3_f32 v36, v156, v157, v36
    v_max3_f32 v37, v158, v159, v37
    v_max3_f32 v36, v160, v161, v36
    v_max3_f32 v37, v162, v163, v37
    v_max3_f32 v36, v164, v165, v36
    v_max3_f32 v37, v166, v167, v37
    v_max3_f32 v36, v168, v169, v36
    v_max3_f32 v37, v170, v171, v37
    v_max3_f32 v36, v172, v173, v36
    v_max3_f32 v37, v174, v175, v37
    v_max3_f32 v36, v176, v177, v36
    v_max3_f32 v37, v178, v179, v37
    v_max3_f32 v36, v180, v181, v36
    v_max3_f32 v37, v182, v183, v37
    v_max3_f32 v36, v184, v185, v36
    v_max3_f32 v37, v186, v187, v37
    v_max3_f32 v36, v188, v189, v36
    v_max3_f32 v37, v190, v191, v37
    v_max3_f32 v36, v192, v193, v36
    v_max3_f32 v37, v194, v195, v37
    v_max3_f32 v36, v196, v197, v36
    v_max3_f32 v37, v198, v199, v37
    v_max3_f32 v36, v200, v201, v36
    v_max3_f32 v37, v202, v203, v37
    v_max3_f32 v36, v204, v205, v36
    v_max3_f32 v37, v206, v207, v37
    v_max3_f32 v36, v208, v209, v36
    v_max3_f32 v37, v210, v211, v37
    v_max3_f32 v36, v212, v213, v36
    v_max3_f32 v37, v214, v215, v37
    v_max3_f32 v36, v216, v217, v36
    v_max3_f32 v37, v218, v219, v37
    v_max3_f32 v36, v220, v221, v36
    v_max3_f32 v37, v222, v223, v37
    v_max3_f32 v36, v224, v225, v36
    v_max3_f32 v37, v226, v227, v37
    v_max3_f32 v36, v228, v229, v36
    v_max3_f32 v37, v230, v231, v37
    v_max3_f32 v36, v232, v233, v36
    v_max3_f32 v37, v234, v235, v37
    v_max3_f32 v36, v236, v237, v36
    v_max3_f32 v37, v238, v239, v37
.tv12:
    s_waitcnt vmcnt(0)
    s_barrier
    ds_read_b64_tr_b16 v[40:41], v32 offset:0
    ds_read_b64_tr_b16 v[42:43], v32 offset:128
    ds_read_b64_tr_b16 v[44:45], v32 offset:256
    ds_read_b64_tr_b16 v[46:47], v32 offset:384
    v_add_u32 v32, v32, v33
    ds_read_b64_tr_b16 v[48:49], v32 offset:0
    ds_read_b64_tr_b16 v[50:51], v32 offset:128
    ds_read_b64_tr_b16 v[52:53], v32 offset:256
    ds_read_b64_tr_b16 v[54:55], v32 offset:384
    v_add_u32 v32, v32, v33
    ds_read_b64_tr_b16 v[56:57], v32 offset:0
    ds_read_b64_tr_b16 v[58:59], v32 offset:128
    ds_read_b64_tr_b16 v[60:61], v32 offset:256
    ds_read_b64_tr_b16 v[62:63], v32 offset:384
    v_add_u32 v32, v32, v33
    s_cmp_lg_u32 s47, 0
    s_cbranch_scc1 .tq15
    s_cmp_ge_u32 s46, 4
    s_cbranch_scc1 .tp14
    s_cmp_lt_u32 s46, 2
    s_cselect_b32 s40, s20, s24
    s_cselect_b32 s41, s21, s25
    s_cselect_b32 s42, s22, s26
    s_cselect_b32 s43, s23, s27
    s_and_b32 s52, s46, 1
    s_lshl_b32 s53, s44, 1
    s_add_u32 s52, s52, s53
    s_mul_i32 s52, s52, 69120
    s_mul_i32 s53, s45, 224
    s_add_u32 s52, s52, s53
    v_mul_u32_u24 v108, 86, v0
    v_lshrrev_b32 v108, 8, v108
    v_mul_u32_u24 v109, 3, v108
    v_sub_u32 v109, v0, v109
    v_mul_u32_u24 v108, 3456, v108
    v_mul_u32_u24 v109, 110, v109
    v_and_b32 v109, 0xfc, v109
    v_add3_u32 v108, v108, v109, s52
    buffer_load_dword v22, v108, s[40:43], 0 offen
    s_branch .tq15
.tp14:
    s_lshl_b32 s52, s44, 1
    s_lshr_b32 s53, s45, 3
    s_add_u32 s52, s52, s53
    s_mul_i32 s52, s52, 54
    s_and_b32 s52, s52, 0xfff0
    s_and_b32 s53, s46, 3
    s_mul_i32 s53, s53, 20
    s_add_u32 s52, s52, s53
    s_mul_i32 s52, s52, 1280
    s_and_b32 s53, s45, 7
    s_mul_i32 s53, s53, 160
    s_add_u32 s52, s52, s53
    v_mul_u32_u24 v108, 86, v0
    v_lshrrev_b32 v108, 8, v108
    v_mul_u32_u24 v109, 3, v108
    v_sub_u32 v109, v0, v109
    v_mul_u32_u24 v108, 1280, v108
    v_mul_u32_u24 v109, 78, v109
    v_and_b32 v109, 0xfc, v109
    v_add3_u32 v108, v108, v109, s52
    buffer_load_dword v22, v108, s[28:31], 0 offen
.tq15:
    v_cndmask_b32 v112, v240, v112, s[64:65]
    v_cndmask_b32 v113, v241, v113, s[66:67]
    v_cndmask_b32 v114, v242, v114, s[68:69]
    v_cndmask_b32 v115, v243, v115, s[70:71]
    v_cndmask_b32 v116, v244, v116, s[72:73]
    v_cndmask_b32 v117, v245, v117, s[74:75]
    v_cndmask_b32 v118, v246, v118, s[76:77]
    v_cndmask_b32 v119, v247, v119, s[78:79]
    v_cndmask_b32 v120, v248, v120, s[80:81]
    v_cndmask_b32 v121, v249, v121, s[82:83]
    v_cndmask_b32 v122, v250, v122, s[84:85]
    v_cndmask_b32 v123, v251, v123, s[86:87]
    v_cndmask_b32 v124, v252, v124, s[88:89]
    v_cndmask_b32 v125, v253, v125, s[90:91]
    v_cndmask_b32 v126, v254, v126, s[92:93]
    v_cndmask_b32 v127, v255, v127, s[94:95]
    v_max3_f32 v36, v112, v113, v36
    v_max3_f32 v37, v114, v115, v37
    v_max3_f32 v36, v116, v117, v36
    v_max3_f32 v37, v118, v119, v37
    v_max3_f32 v36, v120, v121, v36
    v_max3_f32 v37, v122, v123, v37
    v_max3_f32 v36, v124, v125, v36
    v_max3_f32 v37, v126, v127, v37
    v_max_f32 v36, v36, v37
    v_mov_b32 v37, v36
    s_nop 1
    v_permlane32_swap_b32 v36, v37
    s_nop 1
    v_max_f32 v36, v36, v37
    v_and_b32 v37, 0xffff0000, v36
    v_sub_f32 v36, v36, v37
    v_and_b32 v240, 0xffff0000, v36
    v_sub_f32 v36, v36, v240
    v_cvt_pk_bf16_f32 v37, -v37, -v240
    v_cvt_pk_bf16_f32 v36, -v36, 0
    s_nop 1
    v_mfma_f32_32x32x8_bf16 v[112:127], v[94:95], v[36:37], v[112:127]
    v_mfma_f32_32x32x8_bf16 v[128:143], v[94:95], v[36:37], v[128:143]
    v_mfma_f32_32x32x8_bf16 v[144:159], v[94:95], v[36:37], v[144:159]
    v_mfma_f32_32x32x8_bf16 v[160:175], v[94:95], v[36:37], v[160:175]
    v_mfma_f32_32x32x8_bf16 v[176:191], v[94:95], v[36:37], v[176:191]
    v_mfma_f32_32x32x8_bf16 v[192:207], v[94:95], v[36:37], v[192:207]
    v_mfma_f32_32x32x8_bf16 v[208:223], v[94:95], v[36:37], v[208:223]
    v_mfma_f32_32x32x8_bf16 v[224:239], v[94:95], v[36:37], v[224:239]
    s_nop 7
    v_exp_f32 v112, v112
    v_exp_f32 v113, v113
    v_exp_f32 v114, v114
    v_exp_f32 v115, v115
    v_exp_f32 v116, v116
    v_exp_f32 v117, v117
    v_exp_f32 v118, v118
    v_exp_f32 v119, v119
    v_exp_f32 v120, v120
    v_exp_f32 v121, v121
    v_exp_f32 v122, v122
    v_exp_f32 v123, v123
    v_exp_f32 v124, v124
    v_exp_f32 v125, v125
    v_exp_f32 v126, v126
    v_exp_f32 v127, v127
    v_cvt_pk_bf16_f32 v240, v112, v113
    v_cvt_pk_bf16_f32 v241, v114, v115
    v_cvt_pk_bf16_f32 v242, v116, v117
    v_cvt_pk_bf16_f32 v243, v118, v119
    v_cvt_pk_bf16_f32 v244, v120, v121
    v_cvt_pk_bf16_f32 v245, v122, v123
    v_cvt_pk_bf16_f32 v246, v124, v125
    v_cvt_pk_bf16_f32 v247, v126, v127
    v_and_b32 v72, v96, v240
    v_and_b32 v73, v97, v241
    v_and_b32 v74, v98, v242
    v_and_b32 v75, v99, v243
    v_and_b32 v76, v100, v244
    v_and_b32 v77, v101, v245
    v_and_b32 v78, v102, v246
    v_and_b32 v79, v103, v247
    v_xor_b32 v240, v72, v240
    v_xor_b32 v241, v73, v241
    v_xor_b32 v242, v74, v242
    v_xor_b32 v243, v75, v243
    v_xor_b32 v244, v76, v244
    v_xor_b32 v245, v77, v245
    v_xor_b32 v246, v78, v246
    v_xor_b32 v247, v79, v247
    v_exp_f32 v128, v128
    v_exp_f32 v129, v129
    v_exp_f32 v130, v130
    v_exp_f32 v131, v131
    s_waitcnt lgkmcnt(8)
    v_mfma_f32_32x32x16_bf16 v[96:111], v[40:43], v[72:75], 0
    v_mfma_f32_32x32x16_bf16 v[96:111], v[44:47], v[76:79], v[96:111]
    ds_read_b64_tr_b16 v[64:65], v32 offset:0
    ds_read_b64_tr_b16 v[66:67], v32 offset:128
    ds_read_b64_tr_b16 v[68:69], v32 offset:256
    ds_read_b64_tr_b16 v[70:71], v32 offset:384
    v_add_u32 v32, v32, v33
    v_exp_f32 v132, v132
    v_exp_f32 v133, v133
    v_exp_f32 v134, v134
    v_exp_f32 v135, v135
    v_exp_f32 v136, v136
    v_exp_f32 v137, v137
    v_exp_f32 v138, v138
    v_exp_f32 v139, v139
    v_exp_f32 v140, v140
    v_exp_f32 v141, v141
    v_exp_f32 v142, v142
    v_exp_f32 v143, v143
    v_cvt_pk_bf16_f32 v80, v128, v129
    v_cvt_pk_bf16_f32 v81, v130, v131
    v_cvt_pk_bf16_f32 v82, v132, v133
    v_cvt_pk_bf16_f32 v83, v134, v135
    v_cvt_pk_bf16_f32 v84, v136, v137
    v_cvt_pk_bf16_f32 v85, v138, v139
    v_cvt_pk_bf16_f32 v86, v140, v141
    v_cvt_pk_bf16_f32 v87, v142, v143
    v_exp_f32 v144, v144
    v_exp_f32 v145, v145
    v_exp_f32 v146, v146
    v_exp_f32 v147, v147
    s_waitcnt lgkmcnt(8)
    v_mfma_f32_32x32x16_bf16 v[96:111], v[48:51], v[80:83], v[96:111]
    v_mfma_f32_32x32x16_bf16 v[96:111], v[52:55], v[84:87], v[96:111]
    ds_read_b64_tr_b16 v[40:41], v32 offset:0
    ds_read_b64_tr_b16 v[42:43], v32 offset:128
    ds_read_b64_tr_b16 v[44:45], v32 offset:256
    ds_read_b64_tr_b16 v[46:47], v32 offset:384
    v_add_u32 v32, v32, v33
    v_exp_f32 v148, v148
    v_exp_f32 v149, v149
    v_exp_f32 v150, v150
    v_exp_f32 v151, v151
    v_exp_f32 v152, v152
    v_exp_f32 v153, v153
    v_exp_f32 v154, v154
    v_exp_f32 v155, v155
    v_exp_f32 v156, v156
    v_exp_f32 v157, v157
    v_exp_f32 v158, v158
    v_exp_f32 v159, v159
    v_cvt_pk_bf16_f32 v72, v144, v145
    v_cvt_pk_bf16_f32 v73, v146, v147
    v_cvt_pk_bf16_f32 v74, v148, v149
    v_cvt_pk_bf16_f32 v75, v150, v151
    v_cvt_pk_bf16_f32 v76, v152, v153
    v_cvt_pk_bf16_f32 v77, v154, v155
    v_cvt_pk_bf16_f32 v78, v156, v157
    v_cvt_pk_bf16_f32 v79, v158, v159
    v_exp_f32 v160, v160
    v_exp_f32 v161, v161
    v_exp_f32 v162, v162
    v_exp_f32 v163, v163
    s_waitcnt lgkmcnt(8)
    v_mfma_f32_32x32x16_bf16 v[96:111], v[56:59], v[72:75], v[96:111]
    v_mfma_f32_32x32x16_bf16 v[96:111], v[60:63], v[76:79], v[96:111]
    ds_read_b64_tr_b16 v[48:49], v32 offset:0
    ds_read_b64_tr_b16 v[50:51], v32 offset:128
    ds_read_b64_tr_b16 v[52:53], v32 offset:256
    ds_read_b64_tr_b16 v[54:55], v32 offset:384
    v_add_u32 v32, v32, v33
    v_exp_f32 v164, v164
    v_exp_f32 v165, v165
    v_exp_f32 v166, v166
    v_exp_f32 v167, v167
    v_exp_f32 v168, v168
    v_exp_f32 v169, v169
    v_exp_f32 v170, v170
    v_exp_f32 v171, v171
    v_exp_f32 v172, v172
    v_exp_f32 v173, v173
    v_exp_f32 v174, v174
    v_exp_f32 v175, v175
    v_cvt_pk_bf16_f32 v80, v160, v161
    v_cvt_pk_bf16_f32 v81, v162, v163
    v_cvt_pk_bf16_f32 v82, v164, v165
    v_cvt_pk_bf16_f32 v83, v166, v167
    v_cvt_pk_bf16_f32 v84, v168, v169
    v_cvt_pk_bf16_f32 v85, v170, v171
    v_cvt_pk_bf16_f32 v86, v172, v173
    v_cvt_pk_bf16_f32 v87, v174, v175
    v_exp_f32 v176, v176
    v_exp_f32 v177, v177
    v_exp_f32 v178, v178
    v_exp_f32 v179, v179
    s_waitcnt lgkmcnt(8)
    v_mfma_f32_32x32x16_bf16 v[96:111], v[64:67], v[80:83], v[96:111]
    v_mfma_f32_32x32x16_bf16 v[96:111], v[68:71], v[84:87], v[96:111]
    ds_read_b64_tr_b16 v[56:57], v32 offset:0
    ds_read_b64_tr_b16 v[58:59], v32 offset:128
    ds_read_b64_tr_b16 v[60:61], v32 offset:256
    ds_read_b64_tr_b16 v[62:63], v32 offset:384
    v_add_u32 v32, v32, v33
    v_exp_f32 v180, v180
    v_exp_f32 v181, v181
    v_exp_f32 v182, v182
    v_exp_f32 v183, v183
    v_exp_f32 v184, v184
    v_exp_f32 v185, v185
    v_exp_f32 v186, v186
    v_exp_f32 v187, v187
    v_exp_f32 v188, v188
    v_exp_f32 v189, v189
    v_exp_f32 v190, v190
    v_exp_f32 v191, v191
    v_cvt_pk_bf16_f32 v72, v176, v177
    v_cvt_pk_bf16_f32 v73, v178, v179
    v_cvt_pk_bf16_f32 v74, v180, v181
    v_cvt_pk_bf16_f32 v75, v182, v183
    v_cvt_pk_bf16_f32 v76, v184, v185
    v_cvt_pk_bf16_f32 v77, v186, v187
    v_cvt_pk_bf16_f32 v78, v188, v189
    v_cvt_pk_bf16_f32 v79, v190, v191
    v_exp_f32 v192, v192
    v_exp_f32 v193, v193
    v_exp_f32 v194, v194
    v_exp_f32 v195, v195
    s_waitcnt lgkmcnt(8)
    v_mfma_f32_32x32x16_bf16 v[96:111], v[40:43], v[72:75], v[96:111]
    v_mfma_f32_32x32x16_bf16 v[96:111], v[44:47], v[76:79], v[96:111]
    ds_read_b64_tr_b16 v[64:65], v32 offset:0
    ds_read_b64_tr_b16 v[66:67], v32 offset:128
    ds_read_b64_tr_b16 v[68:69], v32 offset:256
    ds_read_b64_tr_b16 v[70:71], v32 offset:384
    v_add_u32 v32, v32, v33
    v_exp_f32 v196, v196
    v_exp_f32 v197, v197
    v_exp_f32 v198, v198
    v_exp_f32 v199, v199
    v_exp_f32 v200, v200
    v_exp_f32 v201, v201
    v_exp_f32 v202, v202
    v_exp_f32 v203, v203
    v_exp_f32 v204, v204
    v_exp_f32 v205, v205
    v_exp_f32 v206, v206
    v_exp_f32 v207, v207
    v_cvt_pk_bf16_f32 v80, v192, v193
    v_cvt_pk_bf16_f32 v81, v194, v195
    v_cvt_pk_bf16_f32 v82, v196, v197
    v_cvt_pk_bf16_f32 v83, v198, v199
    v_cvt_pk_bf16_f32 v84, v200, v201
    v_cvt_pk_bf16_f32 v85, v202, v203
    v_cvt_pk_bf16_f32 v86, v204, v205
    v_cvt_pk_bf16_f32 v87, v206, v207
    v_exp_f32 v208, v208
    v_exp_f32 v209, v209
    v_exp_f32 v210, v210
    v_exp_f32 v211, v211
    s_waitcnt lgkmcnt(8)
    v_mfma_f32_32x32x16_bf16 v[96:111], v[48:51], v[80:83], v[96:111]
    v_mfma_f32_32x32x16_bf16 v[96:111], v[52:55], v[84:87], v[96:111]
    ds_read_b64_tr_b16 v[40:41], v32 offset:0
    ds_read_b64_tr_b16 v[42:43], v32 offset:128
    ds_read_b64_tr_b16 v[44:45], v32 offset:256
    ds_read_b64_tr_b16 v[46:47], v32 offset:384
    v_add_u32 v32, v32, v33
    v_exp_f32 v212, v212
    v_exp_f32 v213, v213
    v_exp_f32 v214, v214
    v_exp_f32 v215, v215
    v_exp_f32 v216, v216
    v_exp_f32 v217, v217
    v_exp_f32 v218, v218
    v_exp_f32 v219, v219
    v_exp_f32 v220, v220
    v_exp_f32 v221, v221
    v_exp_f32 v222, v222
    v_exp_f32 v223, v223
    v_cvt_pk_bf16_f32 v72, v208, v209
    v_cvt_pk_bf16_f32 v73, v210, v211
    v_cvt_pk_bf16_f32 v74, v212, v213
    v_cvt_pk_bf16_f32 v75, v214, v215
    v_cvt_pk_bf16_f32 v76, v216, v217
    v_cvt_pk_bf16_f32 v77, v218, v219
    v_cvt_pk_bf16_f32 v78, v220, v221
    v_cvt_pk_bf16_f32 v79, v222, v223
    v_exp_f32 v224, v224
    v_exp_f32 v225, v225
    v_exp_f32 v226, v226
    v_exp_f32 v227, v227
    s_waitcnt lgkmcnt(8)
    v_mfma_f32_32x32x16_bf16 v[96:111], v[56:59], v[72:75], v[96:111]
    v_mfma_f32_32x32x16_bf16 v[96:111], v[60:63], v[76:79], v[96:111]
    v_exp_f32 v228, v228
    v_exp_f32 v229, v229
    v_exp_f32 v230, v230
    v_exp_f32 v231, v231
    v_exp_f32 v232, v232
    v_exp_f32 v233, v233
    v_exp_f32 v234, v234
    v_exp_f32 v235, v235
    v_exp_f32 v236, v236
    v_exp_f32 v237, v237
    v_exp_f32 v238, v238
    v_exp_f32 v239, v239
    v_cvt_pk_bf16_f32 v80, v224, v225
    v_cvt_pk_bf16_f32 v81, v226, v227
    v_cvt_pk_bf16_f32 v82, v228, v229
    v_cvt_pk_bf16_f32 v83, v230, v231
    v_cvt_pk_bf16_f32 v84, v232, v233
    v_cvt_pk_bf16_f32 v85, v234, v235
    v_cvt_pk_bf16_f32 v86, v236, v237
    v_cvt_pk_bf16_f32 v87, v238, v239
    s_waitcnt lgkmcnt(0)
    v_mfma_f32_32x32x16_bf16 v[96:111], v[40:43], v[240:243], v[96:111]
    v_mfma_f32_32x32x16_bf16 v[96:111], v[44:47], v[244:247], v[96:111]
    v_mfma_f32_32x32x16_bf16 v[96:111], v[64:67], v[80:83], v[96:111]
    v_mfma_f32_32x32x16_bf16 v[96:111], v[68:71], v[84:87], v[96:111]
    s_nop 7
    s_nop 7
    v_rcp_f32 v36, v108
    s_nop 0
    v_mov_b32 v37, v36
    v_pk_mul_f32 v[96:97], v[96:97], v[36:37]
    v_pk_mul_f32 v[98:99], v[98:99], v[36:37]
    v_pk_mul_f32 v[100:101], v[100:101], v[36:37]
    v_pk_mul_f32 v[102:103], v[102:103], v[36:37]
    v_pk_mul_f32 v[104:105], v[104:105], v[36:37]
    v_pk_mul_f32 v[106:107], v[106:107], v[36:37]
    v_cvt_pk_bf16_f32 v72, v96, v97
    v_cvt_pk_bf16_f32 v73, v98, v99
    v_cvt_pk_bf16_f32 v74, v100, v101
    v_cvt_pk_bf16_f32 v75, v102, v103
    v_cvt_pk_bf16_f32 v76, v104, v105
    v_cvt_pk_bf16_f32 v77, v106, v107
    buffer_store_dwordx4 v[72:75], v34, s[4:7], s58 offen sc1
    buffer_store_dwordx2 v[76:77], v35, s[4:7], s58 offen sc1
    s_mul_i32 s52, s44, 512
    s_add_u32 s52, s52, s45
    s_lshl_b32 s52, s52, 2
    s_add_u32 s52, s52, 0x5000000
    s_add_u32 s53, s50, 0x9e3779b2
    v_mul_u32_u24 v30, 128, v0
    v_mov_b32 v31, s53
    s_waitcnt vmcnt(0)
    s_barrier
    s_cmp_ge_u32 s46, 6
    s_cbranch_scc1 L_w2
    s_cmp_ge_u32 s46, 4
    s_cbranch_scc1 L_a2
    s_cmp_lg_u32 s47, 0
    s_cbranch_scc1 .pq17
    v_mov_b32 v122, 0
    v_mov_b32 v123, 0
    v_mov_b32 v124, 0
    v_mov_b32 v125, 0
    v_mov_b32 v126, 0
    s_cmp_ge_u32 s46, 2
    s_cbranch_scc1 .pa18
    v_lshrrev_b32 v232, 4, v0
    v_mul_u32_u24 v232, 3456, v232
    v_and_b32 v233, 15, v0
    v_lshl_add_u32 v232, v233, 4, v232
    s_mul_i32 s96, s44, 138240
    s_mul_i32 s52, s45, 224
    s_add_u32 s96, s96, s52
    s_cmp_eq_u32 s46, 0
    s_cselect_b32 s40, s20, s24
    s_cselect_b32 s41, s21, s25
    s_cselect_b32 s42, s22, s26
    s_cselect_b32 s43, s23, s27
    v_add_u32 v233, 13824, v232
    v_add_u32 v234, 27648, v232
    v_add_u32 v235, 41472, v232
    v_add_u32 v236, 55296, v232
    v_add_u32 v237, 69120, v232
    v_add_u32 v238, 82944, v232
    v_add_u32 v239, 96768, v232
    v_add_u32 v240, 110592, v232
    v_add_u32 v241, 124416, v232
    s_branch .pb19
.pa18:
    s_mov_b32 s40, s28
    s_mov_b32 s41, s29
    s_mov_b32 s42, s30
    s_mov_b32 s43, s31
    v_mov_b32 v233, 0x20000000
    v_mov_b32 v235, 0x20000000
    v_mov_b32 v237, 0x20000000
    v_mov_b32 v239, 0x20000000
    v_mov_b32 v241, 0x20000000
    s_lshl_b32 s52, s44, 1
    s_lshr_b32 s53, s45, 3
    s_add_u32 s52, s52, s53
    s_and_b32 s53, s45, 7
    s_mul_i32 s96, s53, 160
    s_lshl_b32 s53, s53, 5
    s_add_u32 s98, s53, s52
    s_mul_i32 s98, s98, 8640
    s_add_u32 s98, s98, 0x4100000
    s_mul_i32 s52, s52, 54
    s_and_b32 s53, s46, 1
    s_mul_i32 s54, s53, 320
    v_add_u32 v88, s54, v0
    v_add_u32 v92, 484, v88
    v_lshrrev_b32 v92, 10, v92
    v_lshlrev_b32 v92, 29, v92
    v_lshl_add_u32 v122, v88, 4, v92
    v_mul_u32_u24 v89, 6554, v88
    v_lshrrev_b32 v89, 16, v89
    v_mul_u32_u24 v90, 10, v89
    v_sub_u32 v88, v88, v90
    v_add_u32 v89, s52, v89
    v_and_b32 v90, 0xfff3, v89
    v_bfe_u32 v91, v89, 2, 1
    v_lshl_add_u32 v90, v91, 3, v90
    v_bfe_u32 v91, v89, 3, 1
    v_lshl_add_u32 v90, v91, 2, v90
    v_mul_u32_u24 v90, 1280, v90
    v_lshl_add_u32 v90, v88, 4, v90
    v_add_u32 v232, v90, v92
    v_add_u32 v88, s54, v0
    v_add_u32 v88, 64, v88
    v_add_u32 v92, 484, v88
    v_lshrrev_b32 v92, 10, v92
    v_lshlrev_b32 v92, 29, v92
    v_lshl_add_u32 v123, v88, 4, v92
    v_mul_u32_u24 v89, 6554, v88
    v_lshrrev_b32 v89, 16, v89
    v_mul_u32_u24 v90, 10, v89
    v_sub_u32 v88, v88, v90
    v_add_u32 v89, s52, v89
    v_and_b32 v90, 0xfff3, v89
    v_bfe_u32 v91, v89, 2, 1
    v_lshl_add_u32 v90, v91, 3, v90
    v_bfe_u32 v91, v89, 3, 1
    v_lshl_add_u32 v90, v91, 2, v90
    v_mul_u32_u24 v90, 1280, v90
    v_lshl_add_u32 v90, v88, 4, v90
    v_add_u32 v234, v90, v92
    v_add_u32 v88, s54, v0
    v_add_u32 v88, 128, v88
    v_add_u32 v92, 484, v88
    v_lshrrev_b32 v92, 10, v92
    v_lshlrev_b32 v92, 29, v92
    v_lshl_add_u32 v124, v88, 4, v92
    v_mul_u32_u24 v89, 6554, v88
    v_lshrrev_b32 v89, 16, v89
    v_mul_u32_u24 v90, 10, v89
    v_sub_u32 v88, v88, v90
    v_add_u32 v89, s52, v89
    v_and_b32 v90, 0xfff3, v89
    v_bfe_u32 v91, v89, 2, 1
    v_lshl_add_u32 v90, v91, 3, v90
    v_bfe_u32 v91, v89, 3, 1
    v_lshl_add_u32 v90, v91, 2, v90
    v_mul_u32_u24 v90, 1280, v90
    v_lshl_add_u32 v90, v88, 4, v90
    v_add_u32 v236, v90, v92
    v_add_u32 v88, s54, v0
    v_add_u32 v88, 192, v88
    v_add_u32 v92, 484, v88
    v_lshrrev_b32 v92, 10, v92
    v_lshlrev_b32 v92, 29, v92
    v_lshl_add_u32 v125, v88, 4, v92
    v_mul_u32_u24 v89, 6554, v88
    v_lshrrev_b32 v89, 16, v89
    v_mul_u32_u24 v90, 10, v89
    v_sub_u32 v88, v88, v90
    v_add_u32 v89, s52, v89
    v_and_b32 v90, 0xfff3, v89
    v_bfe_u32 v91, v89, 2, 1
    v_lshl_add_u32 v90, v91, 3, v90
    v_bfe_u32 v91, v89, 3, 1
    v_lshl_add_u32 v90, v91, 2, v90
    v_mul_u32_u24 v90, 1280, v90
    v_lshl_add_u32 v90, v88, 4, v90
    v_add_u32 v238, v90, v92
    v_add_u32 v88, s54, v0
    v_add_u32 v88, 256, v88
    v_add_u32 v92, 484, v88
    v_lshrrev_b32 v92, 10, v92
    v_lshlrev_b32 v92, 29, v92
    v_lshl_add_u32 v126, v88, 4, v92
    v_mul_u32_u24 v89, 6554, v88
    v_lshrrev_b32 v89, 16, v89
    v_mul_u32_u24 v90, 10, v89
    v_sub_u32 v88, v88, v90
    v_add_u32 v89, s52, v89
    v_and_b32 v90, 0xfff3, v89
    v_bfe_u32 v91, v89, 2, 1
    v_lshl_add_u32 v90, v91, 3, v90
    v_bfe_u32 v91, v89, 3, 1
    v_lshl_add_u32 v90, v91, 2, v90
    v_mul_u32_u24 v90, 1280, v90
    v_lshl_add_u32 v90, v88, 4, v90
    v_add_u32 v240, v90, v92
.pb19:
    buffer_load_dwordx4 v[192:195], v232, s[40:43], s96 offen
    buffer_load_dwordx4 v[196:199], v233, s[40:43], s96 offen
    buffer_load_dwordx4 v[200:203], v234, s[40:43], s96 offen
    buffer_load_dwordx4 v[204:207], v235, s[40:43], s96 offen
    buffer_load_dwordx4 v[208:211], v236, s[40:43], s96 offen
    buffer_load_dwordx4 v[212:215], v237, s[40:43], s96 offen
    buffer_load_dwordx4 v[216:219], v238, s[40:43], s96 offen
    buffer_load_dwordx4 v[220:223], v239, s[40:43], s96 offen
    buffer_load_dwordx4 v[224:227], v240, s[40:43], s96 offen
    buffer_load_dwordx4 v[228:231], v241, s[40:43], s96 offen
    v_and_b32 v88, 15, v0
    v_and_b32 v89, 1, v0
    v_lshlrev_b32 v89, 4, v89
    v_mov_b32 v90, 0x3f80
    v_lshlrev_b32 v89, v89, v90
    v_lshrrev_b32 v90, 1, v88
    v_cmp_eq_u32 vcc, 0, v90
    s_nop 1
    v_cndmask_b32 v244, 0, v89, vcc
    v_cmp_eq_u32 vcc, 1, v90
    s_nop 1
    v_cndmask_b32 v245, 0, v89, vcc
    v_cmp_eq_u32 vcc, 2, v90
    s_nop 1
    v_cndmask_b32 v246, 0, v89, vcc
    v_cmp_eq_u32 vcc, 3, v90
    s_nop 1
    v_cndmask_b32 v247, 0, v89, vcc
    v_bfe_u32 v89, v0, 4, 1
    v_lshlrev_b32 v89, 4, v89
    v_lshl_add_u32 v89, v88, 5, v89
    v_lshrrev_b32 v90, 5, v0
    v_lshl_add_u32 v242, v90, 29, v89
    s_waitcnt vmcnt(0)
    s_cmp_ge_u32 s46, 2
    s_cbranch_scc1 .pp16
    s_add_u32 s96, s46, 1
    v_mfma_f32_16x16x32_bf16 v[248:251], v[244:247], v[192:195], 0
    v_mfma_f32_16x16x32_bf16 v[248:251], v[244:247], v[196:199], v[248:251]
    v_mfma_f32_16x16x32_bf16 v[248:251], v[244:247], v[200:203], v[248:251]
    v_mfma_f32_16x16x32_bf16 v[248:251], v[244:247], v[204:207], v[248:251]
    v_mfma_f32_16x16x32_bf16 v[248:251], v[244:247], v[208:211], v[248:251]
    v_mfma_f32_16x16x32_bf16 v[248:251], v[244:247], v[212:215], v[248:251]
    v_mfma_f32_16x16x32_bf16 v[248:251], v[244:247], v[216:219], v[248:251]
    v_mfma_f32_16x16x32_bf16 v[248:251], v[244:247], v[220:223], v[248:251]
    v_mfma_f32_16x16x32_bf16 v[248:251], v[244:247], v[224:227], v[248:251]
    v_mfma_f32_16x16x32_bf16 v[248:251], v[244:247], v[228:231], v[248:251]
    s_mul_i32 s97, s45, 3
    s_add_u32 s97, s97, s96
    s_lshl_b32 s97, s97, 4
    s_add_u32 s97, s97, s44
    s_lshl_b32 s97, s97, 9
    s_add_u32 s97, s97, 0x4000000
    s_nop 4
    buffer_store_dwordx4 v[248:251], v242, s[4:7], s97 offen sc1
    s_branch .pq17
.pp16:
    buffer_store_dwordx4 v[192:195], v122, s[4:7], s98 offen sc1
    buffer_store_dwordx4 v[200:203], v123, s[4:7], s98 offen sc1
    buffer_store_dwordx4 v[208:211], v124, s[4:7], s98 offen sc1
    buffer_store_dwordx4 v[216:219], v125, s[4:7], s98 offen sc1
    buffer_store_dwordx4 v[224:227], v126, s[4:7], s98 offen sc1
.pq17:
    s_and_b32 s54, s46, 1
    s_lshr_b32 s55, s46, 1
    v_and_b32 v100, 15, v0
    v_lshrrev_b32 v101, 4, v0
    v_lshlrev_b32 v102, 10, v101
    v_lshl_add_u32 v102, v100, 4, v102
    s_lshl_b32 s52, s55, 12
    s_lshl_b32 s53, s54, 9
    s_add_u32 s52, s52, s53
    s_lshl_b32 s53, s55, 8
    s_add_u32 s52, s52, s53
    s_add_u32 s52, s52, 0x19000
    v_add_u32 v24, s52, v102
    v_xor_b32 v25, 256, v24
    v_bfe_u32 v102, v0, 2, 2
    v_bfe_u32 v103, v0, 5, 1
    v_lshl_add_u32 v102, v103, 4, v102
    v_bfe_u32 v103, v0, 4, 1
    v_lshl_add_u32 v102, v103, 2, v102
    v_mul_u32_u24 v102, 160, v102
    v_and_b32 v103, 3, v0
    v_lshl_add_u32 v102, v103, 3, v102
    s_mul_i32 s52, s55, 5120
    v_add_u32 v26, s52, v102
    v_add_u32 v27, 0xf000, v26
    s_mul_i32 s52, s46, 5120
    s_add_u32 s52, s52, 0x19000
    v_lshl_add_u32 v102, v0, 4, s52
    s_xor_b32 s52, s46, 2
    s_mul_i32 s52, s52, 5120
    s_add_u32 s52, s52, 0x19000
    v_lshl_add_u32 v103, v0, 4, s52
    s_mov_b32 s40, s4
    s_mov_b32 s41, s5
    s_mov_b32 s42, s6
    s_mov_b32 s43, s7
    s_mov_b32 s56, 0x10
    s_mov_b32 s57, 0x800
    s_add_u32 s58, s49, 0xc00000
    s_lshr_b32 s52, s45, 3
    s_lshl_b32 s52, s52, 6
    s_and_b32 s60, s46, 1
    s_lshl_b32 s60, s60, 5
    s_add_u32 s52, s52, s60
    s_lshr_b32 s60, s46, 1
    s_lshl_b32 s60, s60, 4
    s_add_u32 s52, s52, s60
    s_mul_i32 s52, s52, s56
    s_add_u32 s58, s58, s52
    s_mul_i32 s52, s44, 163840
    s_add_u32 s58, s58, s52
    s_and_b32 s52, s45, 7
    s_mul_i32 s52, s52, 10
    s_mul_i32 s52, s52, s57
    s_add_u32 s58, s58, s52
    s_lshl_b32 s59, s57, 2
    s_add_u32 s59, s59, s58
    v_and_b32 v92, 15, v0
    v_mul_lo_u32 v92, v92, s56
    v_bfe_u32 v93, v0, 4, 1
    v_lshrrev_b32 v94, 5, v0
    v_lshl_add_u32 v95, v93, 1, v94
    v_mul_lo_u32 v95, v95, s57
    v_add_u32 v90, v92, v95
    v_add_u32 v95, 8, v94
    v_mul_lo_u32 v95, v95, s57
    v_add_u32 v91, v92, v95
    v_lshl_add_u32 v91, v93, 3, v91
    s_lshr_b32 s52, s45, 3
    s_lshl_b32 s52, s52, 6
    s_and_b32 s60, s46, 1
    s_lshl_b32 s60, s60, 5
    s_add_u32 s52, s52, s60
    s_lshr_b32 s60, s46, 1
    s_lshl_b32 s60, s60, 4
    s_add_u32 s52, s52, s60
    s_lshl_b32 s52, s52, 3
    s_lshl_b32 s53, s44, 13
    s_add_u32 s52, s52, s53
    s_and_b32 s53, s45, 7
    s_lshl_b32 s53, s53, 10
    s_add_u32 s52, s52, s53
    s_lshl_b32 s53, s47, 18
    s_add_u32 s52, s52, s53
    s_add_u32 s101, s52, 0x40000
    v_and_b32 v96, 15, v0
    v_lshrrev_b32 v97, 5, v0
    v_lshlrev_b32 v96, 3, v96
    v_lshl_add_u32 v96, v97, 2, v96
    s_barrier
    ds_read_b128 v[32:35], v24 offset:0
    ds_read_b128 v[36:39], v25 offset:0
    ds_read_b64_tr_b16 v[40:41], v26 offset:0
    ds_read_b64_tr_b16 v[42:43], v26 offset:1280
    ds_read_b64_tr_b16 v[44:45], v26 offset:32
    ds_read_b64_tr_b16 v[46:47], v26 offset:1312
    ds_read_b64_tr_b16 v[48:49], v26 offset:64
    ds_read_b64_tr_b16 v[50:51], v26 offset:1344
    ds_read_b64_tr_b16 v[52:53], v26 offset:96
    ds_read_b64_tr_b16 v[54:55], v26 offset:1376
    ds_read_b64_tr_b16 v[56:57], v26 offset:128
    ds_read_b64_tr_b16 v[58:59], v26 offset:1408
    s_waitcnt lgkmcnt(0)
    v_mfma_f32_16x16x32_bf16 v[128:131], v[40:43], v[32:35], 0
    v_mfma_f32_16x16x32_bf16 v[148:151], v[40:43], v[36:39], 0
    s_barrier
    ds_read_b128 v[60:63], v24 offset:8192
    ds_read_b128 v[64:67], v25 offset:8192
    v_mfma_f32_16x16x32_bf16 v[132:135], v[44:47], v[32:35], 0
    ds_read_b64_tr_b16 v[68:69], v26 offset:10240
    ds_read_b64_tr_b16 v[70:71], v26 offset:11520
    v_mfma_f32_16x16x32_bf16 v[152:155], v[44:47], v[36:39], 0
    ds_read_b64_tr_b16 v[72:73], v26 offset:10272
    ds_read_b64_tr_b16 v[74:75], v26 offset:11552
    v_mfma_f32_16x16x32_bf16 v[136:139], v[48:51], v[32:35], 0
    ds_read_b64_tr_b16 v[76:77], v26 offset:10304
    ds_read_b64_tr_b16 v[78:79], v26 offset:11584
    v_mfma_f32_16x16x32_bf16 v[156:159], v[48:51], v[36:39], 0
    ds_read_b64_tr_b16 v[80:81], v26 offset:10336
    ds_read_b64_tr_b16 v[82:83], v26 offset:11616
    v_mfma_f32_16x16x32_bf16 v[140:143], v[52:55], v[32:35], 0
    ds_read_b64_tr_b16 v[84:85], v26 offset:10368
    ds_read_b64_tr_b16 v[86:87], v26 offset:11648
    v_mfma_f32_16x16x32_bf16 v[160:163], v[52:55], v[36:39], 0
    v_mfma_f32_16x16x32_bf16 v[144:147], v[56:59], v[32:35], 0
    v_mfma_f32_16x16x32_bf16 v[164:167], v[56:59], v[36:39], 0
    s_waitcnt lgkmcnt(0)
    v_mfma_f32_16x16x32_bf16 v[128:131], v[68:71], v[60:63], v[128:131]
    v_mfma_f32_16x16x32_bf16 v[148:151], v[68:71], v[64:67], v[148:151]
    s_barrier
    ds_read_b128 v[32:35], v24 offset:16384
    ds_read_b128 v[36:39], v25 offset:16384
    v_mfma_f32_16x16x32_bf16 v[132:135], v[72:75], v[60:63], v[132:135]
    ds_read_b64_tr_b16 v[40:41], v26 offset:20480
    ds_read_b64_tr_b16 v[42:43], v26 offset:21760
    v_mfma_f32_16x16x32_bf16 v[152:155], v[72:75], v[64:67], v[152:155]
    ds_read_b64_tr_b16 v[44:45], v26 offset:20512
    ds_read_b64_tr_b16 v[46:47], v26 offset:21792
    v_mfma_f32_16x16x32_bf16 v[136:139], v[76:79], v[60:63], v[136:139]
    ds_read_b64_tr_b16 v[48:49], v26 offset:20544
    ds_read_b64_tr_b16 v[50:51], v26 offset:21824
    v_mfma_f32_16x16x32_bf16 v[156:159], v[76:79], v[64:67], v[156:159]
    ds_read_b64_tr_b16 v[52:53], v26 offset:20576
    ds_read_b64_tr_b16 v[54:55], v26 offset:21856
    v_mfma_f32_16x16x32_bf16 v[140:143], v[80:83], v[60:63], v[140:143]
    ds_read_b64_tr_b16 v[56:57], v26 offset:20608
    ds_read_b64_tr_b16 v[58:59], v26 offset:21888
    v_mfma_f32_16x16x32_bf16 v[160:163], v[80:83], v[64:67], v[160:163]
    v_mfma_f32_16x16x32_bf16 v[144:147], v[84:87], v[60:63], v[144:147]
    v_mfma_f32_16x16x32_bf16 v[164:167], v[84:87], v[64:67], v[164:167]
    s_waitcnt lgkmcnt(0)
    v_mfma_f32_16x16x32_bf16 v[128:131], v[40:43], v[32:35], v[128:131]
    v_mfma_f32_16x16x32_bf16 v[148:151], v[40:43], v[36:39], v[148:151]
    s_barrier
    ds_read_b128 v[60:63], v24 offset:24576
    ds_read_b128 v[64:67], v25 offset:24576
    v_mfma_f32_16x16x32_bf16 v[132:135], v[44:47], v[32:35], v[132:135]
    ds_read_b64_tr_b16 v[68:69], v26 offset:30720
    ds_read_b64_tr_b16 v[70:71], v26 offset:32000
    v_mfma_f32_16x16x32_bf16 v[152:155], v[44:47], v[36:39], v[152:155]
    ds_read_b64_tr_b16 v[72:73], v26 offset:30752
    ds_read_b64_tr_b16 v[74:75], v26 offset:32032
    v_mfma_f32_16x16x32_bf16 v[136:139], v[48:51], v[32:35], v[136:139]
    ds_read_b64_tr_b16 v[76:77], v26 offset:30784
    ds_read_b64_tr_b16 v[78:79], v26 offset:32064
    v_mfma_f32_16x16x32_bf16 v[156:159], v[48:51], v[36:39], v[156:159]
    ds_read_b64_tr_b16 v[80:81], v26 offset:30816
    ds_read_b64_tr_b16 v[82:83], v26 offset:32096
    v_mfma_f32_16x16x32_bf16 v[140:143], v[52:55], v[32:35], v[140:143]
    ds_read_b64_tr_b16 v[84:85], v26 offset:30848
    ds_read_b64_tr_b16 v[86:87], v26 offset:32128
    v_mfma_f32_16x16x32_bf16 v[160:163], v[52:55], v[36:39], v[160:163]
    v_mfma_f32_16x16x32_bf16 v[144:147], v[56:59], v[32:35], v[144:147]
    v_mfma_f32_16x16x32_bf16 v[164:167], v[56:59], v[36:39], v[164:167]
    s_waitcnt lgkmcnt(0)
    v_mfma_f32_16x16x32_bf16 v[128:131], v[68:71], v[60:63], v[128:131]
    v_mfma_f32_16x16x32_bf16 v[148:151], v[68:71], v[64:67], v[148:151]
    s_barrier
    ds_read_b128 v[32:35], v24 offset:32768
    ds_read_b128 v[36:39], v25 offset:32768
    v_mfma_f32_16x16x32_bf16 v[132:135], v[72:75], v[60:63], v[132:135]
    ds_read_b64_tr_b16 v[40:41], v26 offset:40960
    ds_read_b64_tr_b16 v[42:43], v26 offset:42240
    v_mfma_f32_16x16x32_bf16 v[152:155], v[72:75], v[64:67], v[152:155]
    ds_read_b64_tr_b16 v[44:45], v26 offset:40992
    ds_read_b64_tr_b16 v[46:47], v26 offset:42272
    v_mfma_f32_16x16x32_bf16 v[136:139], v[76:79], v[60:63], v[136:139]
    ds_read_b64_tr_b16 v[48:49], v26 offset:41024
    ds_read_b64_tr_b16 v[50:51], v26 offset:42304
    v_mfma_f32_16x16x32_bf16 v[156:159], v[76:79], v[64:67], v[156:159]
    ds_read_b64_tr_b16 v[52:53], v26 offset:41056
    ds_read_b64_tr_b16 v[54:55], v26 offset:42336
    v_mfma_f32_16x16x32_bf16 v[140:143], v[80:83], v[60:63], v[140:143]
    ds_read_b64_tr_b16 v[56:57], v26 offset:41088
    ds_read_b64_tr_b16 v[58:59], v26 offset:42368
    v_mfma_f32_16x16x32_bf16 v[160:163], v[80:83], v[64:67], v[160:163]
    v_mfma_f32_16x16x32_bf16 v[144:147], v[84:87], v[60:63], v[144:147]
    v_mfma_f32_16x16x32_bf16 v[164:167], v[84:87], v[64:67], v[164:167]
    s_waitcnt lgkmcnt(0)
    v_mfma_f32_16x16x32_bf16 v[128:131], v[40:43], v[32:35], v[128:131]
    v_mfma_f32_16x16x32_bf16 v[148:151], v[40:43], v[36:39], v[148:151]
    s_barrier
    ds_read_b128 v[60:63], v24 offset:40960
    ds_read_b128 v[64:67], v25 offset:40960
    v_mfma_f32_16x16x32_bf16 v[132:135], v[44:47], v[32:35], v[132:135]
    ds_read_b64_tr_b16 v[68:69], v26 offset:51200
    ds_read_b64_tr_b16 v[70:71], v26 offset:52480
    v_mfma_f32_16x16x32_bf16 v[152:155], v[44:47], v[36:39], v[152:155]
    ds_read_b64_tr_b16 v[72:73], v26 offset:51232
    ds_read_b64_tr_b16 v[74:75], v26 offset:52512
    v_mfma_f32_16x16x32_bf16 v[136:139], v[48:51], v[32:35], v[136:139]
    ds_read_b64_tr_b16 v[76:77], v26 offset:51264
    ds_read_b64_tr_b16 v[78:79], v26 offset:52544
    v_mfma_f32_16x16x32_bf16 v[156:159], v[48:51], v[36:39], v[156:159]
    ds_read_b64_tr_b16 v[80:81], v26 offset:51296
    ds_read_b64_tr_b16 v[82:83], v26 offset:52576
    v_mfma_f32_16x16x32_bf16 v[140:143], v[52:55], v[32:35], v[140:143]
    ds_read_b64_tr_b16 v[84:85], v26 offset:51328
    ds_read_b64_tr_b16 v[86:87], v26 offset:52608
    v_mfma_f32_16x16x32_bf16 v[160:163], v[52:55], v[36:39], v[160:163]
    v_mfma_f32_16x16x32_bf16 v[144:147], v[56:59], v[32:35], v[144:147]
    v_mfma_f32_16x16x32_bf16 v[164:167], v[56:59], v[36:39], v[164:167]
    s_waitcnt lgkmcnt(0)
    v_mfma_f32_16x16x32_bf16 v[128:131], v[68:71], v[60:63], v[128:131]
    v_mfma_f32_16x16x32_bf16 v[148:151], v[68:71], v[64:67], v[148:151]
    s_barrier
    ds_read_b128 v[32:35], v24 offset:49152
    ds_read_b128 v[36:39], v25 offset:49152
    v_mfma_f32_16x16x32_bf16 v[132:135], v[72:75], v[60:63], v[132:135]
    ds_read_b64_tr_b16 v[40:41], v27 offset:0
    ds_read_b64_tr_b16 v[42:43], v27 offset:1280
    v_mfma_f32_16x16x32_bf16 v[152:155], v[72:75], v[64:67], v[152:155]
    ds_read_b64_tr_b16 v[44:45], v27 offset:32
    ds_read_b64_tr_b16 v[46:47], v27 offset:1312
    v_mfma_f32_16x16x32_bf16 v[136:139], v[76:79], v[60:63], v[136:139]
    ds_read_b64_tr_b16 v[48:49], v27 offset:64
    ds_read_b64_tr_b16 v[50:51], v27 offset:1344
    v_mfma_f32_16x16x32_bf16 v[156:159], v[76:79], v[64:67], v[156:159]
    ds_read_b64_tr_b16 v[52:53], v27 offset:96
    ds_read_b64_tr_b16 v[54:55], v27 offset:1376
    v_mfma_f32_16x16x32_bf16 v[140:143], v[80:83], v[60:63], v[140:143]
    ds_read_b64_tr_b16 v[56:57], v27 offset:128
    ds_read_b64_tr_b16 v[58:59], v27 offset:1408
    v_mfma_f32_16x16x32_bf16 v[160:163], v[80:83], v[64:67], v[160:163]
    v_mfma_f32_16x16x32_bf16 v[144:147], v[84:87], v[60:63], v[144:147]
    v_mfma_f32_16x16x32_bf16 v[164:167], v[84:87], v[64:67], v[164:167]
    s_waitcnt lgkmcnt(0)
    v_mfma_f32_16x16x32_bf16 v[128:131], v[40:43], v[32:35], v[128:131]
    v_mfma_f32_16x16x32_bf16 v[148:151], v[40:43], v[36:39], v[148:151]
    s_barrier
    ds_read_b128 v[60:63], v24 offset:0
    ds_read_b128 v[64:67], v25 offset:0
    v_mfma_f32_16x16x32_bf16 v[132:135], v[44:47], v[32:35], v[132:135]
    ds_read_b64_tr_b16 v[68:69], v27 offset:10240
    ds_read_b64_tr_b16 v[70:71], v27 offset:11520
    v_mfma_f32_16x16x32_bf16 v[152:155], v[44:47], v[36:39], v[152:155]
    ds_read_b64_tr_b16 v[72:73], v27 offset:10272
    ds_read_b64_tr_b16 v[74:75], v27 offset:11552
    v_mfma_f32_16x16x32_bf16 v[136:139], v[48:51], v[32:35], v[136:139]
    ds_read_b64_tr_b16 v[76:77], v27 offset:10304
    ds_read_b64_tr_b16 v[78:79], v27 offset:11584
    v_mfma_f32_16x16x32_bf16 v[156:159], v[48:51], v[36:39], v[156:159]
    ds_read_b64_tr_b16 v[80:81], v27 offset:10336
    ds_read_b64_tr_b16 v[82:83], v27 offset:11616
    v_mfma_f32_16x16x32_bf16 v[140:143], v[52:55], v[32:35], v[140:143]
    ds_read_b64_tr_b16 v[84:85], v27 offset:10368
    ds_read_b64_tr_b16 v[86:87], v27 offset:11648
    v_mfma_f32_16x16x32_bf16 v[160:163], v[52:55], v[36:39], v[160:163]
    v_mfma_f32_16x16x32_bf16 v[144:147], v[56:59], v[32:35], v[144:147]
    v_mfma_f32_16x16x32_bf16 v[164:167], v[56:59], v[36:39], v[164:167]
    s_waitcnt lgkmcnt(0)
    v_mfma_f32_16x16x32_bf16 v[128:131], v[68:71], v[60:63], v[128:131]
    v_mfma_f32_16x16x32_bf16 v[148:151], v[68:71], v[64:67], v[148:151]
    s_barrier
    ds_read_b128 v[32:35], v24 offset:8192
    ds_read_b128 v[36:39], v25 offset:8192
    v_mfma_f32_16x16x32_bf16 v[132:135], v[72:75], v[60:63], v[132:135]
    ds_read_b64_tr_b16 v[40:41], v27 offset:20480
    ds_read_b64_tr_b16 v[42:43], v27 offset:21760
    v_mfma_f32_16x16x32_bf16 v[152:155], v[72:75], v[64:67], v[152:155]
    ds_read_b64_tr_b16 v[44:45], v27 offset:20512
    ds_read_b64_tr_b16 v[46:47], v27 offset:21792
    v_mfma_f32_16x16x32_bf16 v[136:139], v[76:79], v[60:63], v[136:139]
    ds_read_b64_tr_b16 v[48:49], v27 offset:20544
    ds_read_b64_tr_b16 v[50:51], v27 offset:21824
    v_mfma_f32_16x16x32_bf16 v[156:159], v[76:79], v[64:67], v[156:159]
    ds_read_b64_tr_b16 v[52:53], v27 offset:20576
    ds_read_b64_tr_b16 v[54:55], v27 offset:21856
    v_mfma_f32_16x16x32_bf16 v[140:143], v[80:83], v[60:63], v[140:143]
    ds_read_b64_tr_b16 v[56:57], v27 offset:20608
    ds_read_b64_tr_b16 v[58:59], v27 offset:21888
    v_mfma_f32_16x16x32_bf16 v[160:163], v[80:83], v[64:67], v[160:163]
    v_mfma_f32_16x16x32_bf16 v[144:147], v[84:87], v[60:63], v[144:147]
    v_mfma_f32_16x16x32_bf16 v[164:167], v[84:87], v[64:67], v[164:167]
    s_waitcnt lgkmcnt(0)
    v_mfma_f32_16x16x32_bf16 v[128:131], v[40:43], v[32:35], v[128:131]
    v_mfma_f32_16x16x32_bf16 v[148:151], v[40:43], v[36:39], v[148:151]
    s_barrier
    ds_read_b128 v[60:63], v24 offset:16384
    ds_read_b128 v[64:67], v25 offset:16384
    v_mfma_f32_16x16x32_bf16 v[132:135], v[44:47], v[32:35], v[132:135]
    ds_read_b64_tr_b16 v[68:69], v27 offset:30720
    ds_read_b64_tr_b16 v[70:71], v27 offset:32000
    v_mfma_f32_16x16x32_bf16 v[152:155], v[44:47], v[36:39], v[152:155]
    ds_read_b64_tr_b16 v[72:73], v27 offset:30752
    ds_read_b64_tr_b16 v[74:75], v27 offset:32032
    v_mfma_f32_16x16x32_bf16 v[136:139], v[48:51], v[32:35], v[136:139]
    ds_read_b64_tr_b16 v[76:77], v27 offset:30784
    ds_read_b64_tr_b16 v[78:79], v27 offset:32064
    v_mfma_f32_16x16x32_bf16 v[156:159], v[48:51], v[36:39], v[156:159]
    ds_read_b64_tr_b16 v[80:81], v27 offset:30816
    ds_read_b64_tr_b16 v[82:83], v27 offset:32096
    v_mfma_f32_16x16x32_bf16 v[140:143], v[52:55], v[32:35], v[140:143]
    ds_read_b64_tr_b16 v[84:85], v27 offset:30848
    ds_read_b64_tr_b16 v[86:87], v27 offset:32128
    v_mfma_f32_16x16x32_bf16 v[160:163], v[52:55], v[36:39], v[160:163]
    v_mfma_f32_16x16x32_bf16 v[144:147], v[56:59], v[32:35], v[144:147]
    v_mfma_f32_16x16x32_bf16 v[164:167], v[56:59], v[36:39], v[164:167]
    s_waitcnt lgkmcnt(0)
    v_mfma_f32_16x16x32_bf16 v[128:131], v[68:71], v[60:63], v[128:131]
    v_mfma_f32_16x16x32_bf16 v[148:151], v[68:71], v[64:67], v[148:151]
    s_barrier
    v_mfma_f32_16x16x32_bf16 v[132:135], v[72:75], v[60:63], v[132:135]
    v_mfma_f32_16x16x32_bf16 v[152:155], v[72:75], v[64:67], v[152:155]
    v_mfma_f32_16x16x32_bf16 v[136:139], v[76:79], v[60:63], v[136:139]
    v_mfma_f32_16x16x32_bf16 v[156:159], v[76:79], v[64:67], v[156:159]
    v_mfma_f32_16x16x32_bf16 v[140:143], v[80:83], v[60:63], v[140:143]
    v_mfma_f32_16x16x32_bf16 v[160:163], v[80:83], v[64:67], v[160:163]
    v_mfma_f32_16x16x32_bf16 v[144:147], v[84:87], v[60:63], v[144:147]
    v_mfma_f32_16x16x32_bf16 v[164:167], v[84:87], v[64:67], v[164:167]
    s_waitcnt lgkmcnt(0)
    s_nop 4
    ds_write_b128 v102, v[148:151] offset:0
    ds_write_b128 v102, v[152:155] offset:1024
    ds_write_b128 v102, v[156:159] offset:2048
    ds_write_b128 v102, v[160:163] offset:3072
    ds_write_b128 v102, v[164:167] offset:4096
    v_pk_add_f32 v[128:129], v[128:129], v[2:3]
    v_pk_add_f32 v[130:131], v[130:131], v[4:5]
    v_pk_add_f32 v[132:133], v[132:133], v[6:7]
    v_pk_add_f32 v[134:135], v[134:135], v[8:9]
    v_pk_add_f32 v[136:137], v[136:137], v[10:11]
    v_pk_add_f32 v[138:139], v[138:139], v[12:13]
    v_pk_add_f32 v[140:141], v[140:141], v[14:15]
    v_pk_add_f32 v[142:143], v[142:143], v[16:17]
    v_pk_add_f32 v[144:145], v[144:145], v[18:19]
    v_pk_add_f32 v[146:147], v[146:147], v[20:21]
    s_waitcnt lgkmcnt(0)
    s_barrier
    ds_read_b128 v[32:35], v103 offset:0
    ds_read_b128 v[36:39], v103 offset:1024
    ds_read_b128 v[40:43], v103 offset:2048
    ds_read_b128 v[44:47], v103 offset:3072
    ds_read_b128 v[48:51], v103 offset:4096
    s_waitcnt lgkmcnt(4)
    v_pk_add_f32 v[128:129], v[128:129], v[32:33]
    v_pk_add_f32 v[130:131], v[130:131], v[34:35]
    v_cvt_pk_bf16_f32 v64, v128, v129
    v_cvt_pk_bf16_f32 v65, v130, v131
    s_waitcnt lgkmcnt(3)
    v_pk_add_f32 v[132:133], v[132:133], v[36:37]
    v_pk_add_f32 v[134:135], v[134:135], v[38:39]
    v_cvt_pk_bf16_f32 v66, v132, v133
    v_cvt_pk_bf16_f32 v67, v134, v135
    s_waitcnt lgkmcnt(2)
    v_pk_add_f32 v[136:137], v[136:137], v[40:41]
    v_pk_add_f32 v[138:139], v[138:139], v[42:43]
    v_cvt_pk_bf16_f32 v68, v136, v137
    v_cvt_pk_bf16_f32 v69, v138, v139
    s_waitcnt lgkmcnt(1)
    v_pk_add_f32 v[140:141], v[140:141], v[44:45]
    v_pk_add_f32 v[142:143], v[142:143], v[46:47]
    v_cvt_pk_bf16_f32 v70, v140, v141
    v_cvt_pk_bf16_f32 v71, v142, v143
    s_waitcnt lgkmcnt(0)
    v_pk_add_f32 v[144:145], v[144:145], v[48:49]
    v_pk_add_f32 v[146:147], v[146:147], v[50:51]
    v_cvt_pk_bf16_f32 v72, v144, v145
    v_cvt_pk_bf16_f32 v73, v146, v147
    v_lshlrev_b32 v2, 16, v64
    v_and_b32 v3, 0xffff0000, v64
    v_lshlrev_b32 v4, 16, v65
    v_and_b32 v5, 0xffff0000, v65
    v_lshlrev_b32 v6, 16, v66
    v_and_b32 v7, 0xffff0000, v66
    v_lshlrev_b32 v8, 16, v67
    v_and_b32 v9, 0xffff0000, v67
    v_lshlrev_b32 v10, 16, v68
    v_and_b32 v11, 0xffff0000, v68
    v_lshlrev_b32 v12, 16, v69
    v_and_b32 v13, 0xffff0000, v69
    v_lshlrev_b32 v14, 16, v70
    v_and_b32 v15, 0xffff0000, v70
    v_lshlrev_b32 v16, 16, v71
    v_and_b32 v17, 0xffff0000, v71
    v_lshlrev_b32 v18, 16, v72
    v_and_b32 v19, 0xffff0000, v72
    v_lshlrev_b32 v20, 16, v73
    v_and_b32 v21, 0xffff0000, v73
    v_permlane16_swap_b32 v64, v66
    v_permlane16_swap_b32 v65, v67
    v_permlane16_swap_b32 v68, v70
    v_permlane16_swap_b32 v69, v71
    buffer_store_dwordx2 v[72:73], v91, s[40:43], s58 offen sc1
    buffer_store_dwordx4 v[64:67], v90, s[40:43], s58 offen sc1
    buffer_store_dwordx4 v[68:71], v90, s[40:43], s59 offen sc1
    v_pk_add_f32 v[32:33], v[2:3], v[4:5]
    v_pk_mul_f32 v[34:35], v[2:3], v[2:3]
    v_pk_fma_f32 v[34:35], v[4:5], v[4:5], v[34:35]
    v_pk_add_f32 v[32:33], v[32:33], v[6:7]
    v_pk_fma_f32 v[34:35], v[6:7], v[6:7], v[34:35]
    v_pk_add_f32 v[32:33], v[32:33], v[8:9]
    v_pk_fma_f32 v[34:35], v[8:9], v[8:9], v[34:35]
    v_pk_add_f32 v[32:33], v[32:33], v[10:11]
    v_pk_fma_f32 v[34:35], v[10:11], v[10:11], v[34:35]
    v_pk_add_f32 v[32:33], v[32:33], v[12:13]
    v_pk_fma_f32 v[34:35], v[12:13], v[12:13], v[34:35]
    v_pk_add_f32 v[32:33], v[32:33], v[14:15]
    v_pk_fma_f32 v[34:35], v[14:15], v[14:15], v[34:35]
    v_pk_add_f32 v[32:33], v[32:33], v[16:17]
    v_pk_fma_f32 v[34:35], v[16:17], v[16:17], v[34:35]
    v_pk_add_f32 v[32:33], v[32:33], v[18:19]
    v_pk_fma_f32 v[34:35], v[18:19], v[18:19], v[34:35]
    v_pk_add_f32 v[32:33], v[32:33], v[20:21]
    v_pk_fma_f32 v[34:35], v[20:21], v[20:21], v[34:35]
    v_add_f32 v32, v32, v33
    v_add_f32 v34, v34, v35
    s_nop 1
    v_permlane32_swap_b32 v32, v34
    s_nop 1
    v_add_f32 v32, v32, v34
    v_mov_b32 v34, v32
    s_nop 1
    v_permlane16_swap_b32 v32, v34
    s_nop 1
    v_add_f32 v32, v32, v34
    buffer_store_dword v32, v96, s[4:7], s101 offen sc1
    s_waitcnt vmcnt(0)
    s_barrier
    v_bfe_u32 v100, v0, 2, 2
    v_and_b32 v101, 3, v0
    v_bfe_u32 v102, v0, 4, 1
    v_lshrrev_b32 v103, 5, v0
    v_and_b32 v104, 1, v101
    v_lshlrev_b32 v104, 4, v104
    v_lshrrev_b32 v105, 1, v101
    v_lshl_add_u32 v104, v105, 3, v104
    v_lshl_add_u32 v105, v103, 3, v100
    v_mul_u32_u24 v105, 224, v105
    v_add_u32 v104, v104, v105
    v_mul_u32_u24 v105, 14464, v102
    v_add_u32 v28, v104, v105
    v_and_b32 v100, 31, v0
    v_lshrrev_b32 v101, 5, v0
    s_lshl_b32 s52, s46, 5
    v_add_u32 v102, s52, v100
    v_bfe_u32 v103, v100, 1, 3
    s_cmp_eq_u32 s47, 7
    s_cselect_b64 vcc, -1, 0
    v_add_u32 v104, 0, v101
    v_lshlrev_b32 v24, 11, v104
    v_lshl_add_u32 v24, v102, 4, v24
    v_add_u32 v24, 0x17000, v24
    v_add_u32 v104, 2, v101
    v_lshlrev_b32 v25, 11, v104
    v_lshl_add_u32 v25, v102, 4, v25
    v_add_u32 v25, 0x17000, v25
    v_add_u32 v104, 4, v101
    v_lshlrev_b32 v26, 11, v104
    v_lshl_add_u32 v26, v102, 4, v26
    v_add_u32 v26, 0x17000, v26
    v_add_u32 v104, 6, v101
    v_lshlrev_b32 v27, 11, v104
    v_lshl_add_u32 v27, v102, 4, v27
    v_add_u32 v27, 0x17000, v27
    v_add_u32 v108, 0xe200, v28
    v_lshlrev_b32 v121, 12, v101
    v_lshl_add_u32 v121, v102, 3, v121
    s_lshl_b32 s101, s47, 18
    s_lshl_b32 s52, s44, 13
    s_add_u32 s101, s101, s52
    s_add_u32 s101, s101, 0x40000
    s_waitcnt lgkmcnt(0)
    s_barrier
    ds_read_b128 v[32:35], v24 offset:0
    ds_read_b64_tr_b16 v[36:37], v28 offset:0
    ds_read_b64_tr_b16 v[38:39], v28 offset:896
    ds_read_b64_tr_b16 v[40:41], v28 offset:32
    ds_read_b64_tr_b16 v[42:43], v28 offset:928
    ds_read_b64_tr_b16 v[44:45], v28 offset:64
    ds_read_b64_tr_b16 v[46:47], v28 offset:960
    ds_read_b64_tr_b16 v[48:49], v28 offset:96
    ds_read_b64_tr_b16 v[50:51], v28 offset:992
    ds_read_b64_tr_b16 v[52:53], v28 offset:128
    ds_read_b64_tr_b16 v[54:55], v28 offset:1024
    ds_read_b64_tr_b16 v[56:57], v28 offset:160
    ds_read_b64_tr_b16 v[58:59], v28 offset:1056
    ds_read_b64_tr_b16 v[60:61], v28 offset:192
    ds_read_b64_tr_b16 v[62:63], v28 offset:1088
    s_waitcnt lgkmcnt(12)
    v_mfma_f32_32x32x16_bf16 v[128:143], v[36:39], v[32:35], 0
    ds_read_b128 v[64:67], v25 offset:0
    ds_read_b64_tr_b16 v[68:69], v28 offset:3584
    ds_read_b64_tr_b16 v[70:71], v28 offset:4480
    s_waitcnt lgkmcnt(13)
    v_mfma_f32_32x32x16_bf16 v[144:159], v[40:43], v[32:35], 0
    ds_read_b64_tr_b16 v[72:73], v28 offset:3616
    ds_read_b64_tr_b16 v[74:75], v28 offset:4512
    s_waitcnt lgkmcnt(13)
    v_mfma_f32_32x32x16_bf16 v[160:175], v[44:47], v[32:35], 0
    ds_read_b64_tr_b16 v[76:77], v28 offset:3648
    ds_read_b64_tr_b16 v[78:79], v28 offset:4544
    s_waitcnt lgkmcnt(13)
    v_mfma_f32_32x32x16_bf16 v[176:191], v[48:51], v[32:35], 0
    ds_read_b64_tr_b16 v[80:81], v28 offset:3680
    ds_read_b64_tr_b16 v[82:83], v28 offset:4576
    s_waitcnt lgkmcnt(13)
    v_mfma_f32_32x32x16_bf16 v[192:207], v[52:55], v[32:35], 0
    ds_read_b64_tr_b16 v[84:85], v28 offset:3712
    ds_read_b64_tr_b16 v[86:87], v28 offset:4608
    s_waitcnt lgkmcnt(13)
    v_mfma_f32_32x32x16_bf16 v[208:223], v[56:59], v[32:35], 0
    ds_read_b64_tr_b16 v[88:89], v28 offset:3744
    ds_read_b64_tr_b16 v[90:91], v28 offset:4640
    s_waitcnt lgkmcnt(13)
    v_mfma_f32_32x32x16_bf16 v[224:239], v[60:63], v[32:35], 0
    ds_read_b64_tr_b16 v[92:93], v28 offset:3776
    ds_read_b64_tr_b16 v[94:95], v28 offset:4672
    s_waitcnt lgkmcnt(12)
    v_mfma_f32_32x32x16_bf16 v[128:143], v[68:71], v[64:67], v[128:143]
    ds_read_b128 v[32:35], v26 offset:0
    ds_read_b64_tr_b16 v[36:37], v28 offset:7168
    ds_read_b64_tr_b16 v[38:39], v28 offset:8064
    s_waitcnt lgkmcnt(13)
    v_mfma_f32_32x32x16_bf16 v[144:159], v[72:75], v[64:67], v[144:159]
    ds_read_b64_tr_b16 v[40:41], v28 offset:7200
    ds_read_b64_tr_b16 v[42:43], v28 offset:8096
    s_waitcnt lgkmcnt(13)
    v_mfma_f32_32x32x16_bf16 v[160:175], v[76:79], v[64:67], v[160:175]
    ds_read_b64_tr_b16 v[44:45], v28 offset:7232
    ds_read_b64_tr_b16 v[46:47], v28 offset:8128
    s_waitcnt lgkmcnt(13)
    v_mfma_f32_32x32x16_bf16 v[176:191], v[80:83], v[64:67], v[176:191]
    ds_read_b64_tr_b16 v[48:49], v28 offset:7264
    ds_read_b64_tr_b16 v[50:51], v28 offset:8160
    s_waitcnt lgkmcnt(13)
    v_mfma_f32_32x32x16_bf16 v[192:207], v[84:87], v[64:67], v[192:207]
    ds_read_b64_tr_b16 v[52:53], v28 offset:7296
    ds_read_b64_tr_b16 v[54:55], v28 offset:8192
    s_waitcnt lgkmcnt(13)
    v_mfma_f32_32x32x16_bf16 v[208:223], v[88:91], v[64:67], v[208:223]
    ds_read_b64_tr_b16 v[56:57], v28 offset:7328
    ds_read_b64_tr_b16 v[58:59], v28 offset:8224
    s_waitcnt lgkmcnt(13)
    v_mfma_f32_32x32x16_bf16 v[224:239], v[92:95], v[64:67], v[224:239]
    ds_read_b64_tr_b16 v[60:61], v28 offset:7360
    ds_read_b64_tr_b16 v[62:63], v28 offset:8256
    s_waitcnt lgkmcnt(12)
    v_mfma_f32_32x32x16_bf16 v[128:143], v[36:39], v[32:35], v[128:143]
    ds_read_b128 v[64:67], v27 offset:0
    ds_read_b64_tr_b16 v[68:69], v28 offset:10752
    ds_read_b64_tr_b16 v[70:71], v28 offset:11648
    s_waitcnt lgkmcnt(13)
    v_mfma_f32_32x32x16_bf16 v[144:159], v[40:43], v[32:35], v[144:159]
    ds_read_b64_tr_b16 v[72:73], v28 offset:10784
    ds_read_b64_tr_b16 v[74:75], v28 offset:11680
    s_waitcnt lgkmcnt(13)
    v_mfma_f32_32x32x16_bf16 v[160:175], v[44:47], v[32:35], v[160:175]
    ds_read_b64_tr_b16 v[76:77], v28 offset:10816
    ds_read_b64_tr_b16 v[78:79], v28 offset:11712
    s_waitcnt lgkmcnt(13)
    v_mfma_f32_32x32x16_bf16 v[176:191], v[48:51], v[32:35], v[176:191]
    ds_read_b64_tr_b16 v[80:81], v28 offset:10848
    ds_read_b64_tr_b16 v[82:83], v28 offset:11744
    s_waitcnt lgkmcnt(13)
    v_mfma_f32_32x32x16_bf16 v[192:207], v[52:55], v[32:35], v[192:207]
    ds_read_b64_tr_b16 v[84:85], v28 offset:10880
    ds_read_b64_tr_b16 v[86:87], v28 offset:11776
    s_waitcnt lgkmcnt(13)
    v_mfma_f32_32x32x16_bf16 v[208:223], v[56:59], v[32:35], v[208:223]
    ds_read_b64_tr_b16 v[88:89], v28 offset:10912
    ds_read_b64_tr_b16 v[90:91], v28 offset:11808
    s_waitcnt lgkmcnt(13)
    v_mfma_f32_32x32x16_bf16 v[224:239], v[60:63], v[32:35], v[224:239]
    ds_read_b64_tr_b16 v[92:93], v28 offset:10944
    ds_read_b64_tr_b16 v[94:95], v28 offset:11840
    s_waitcnt lgkmcnt(12)
    v_mfma_f32_32x32x16_bf16 v[128:143], v[68:71], v[64:67], v[128:143]
    s_waitcnt lgkmcnt(10)
    v_mfma_f32_32x32x16_bf16 v[144:159], v[72:75], v[64:67], v[144:159]
    s_waitcnt lgkmcnt(0)
    s_barrier
    ds_read_b128 v[32:35], v24 offset:16384
    ds_read_b64_tr_b16 v[36:37], v28 offset:28928
    ds_read_b64_tr_b16 v[38:39], v28 offset:29824
    v_mfma_f32_32x32x16_bf16 v[160:175], v[76:79], v[64:67], v[160:175]
    ds_read_b64_tr_b16 v[40:41], v28 offset:28960
    ds_read_b64_tr_b16 v[42:43], v28 offset:29856
    ds_read_b64_tr_b16 v[44:45], v28 offset:28992
    v_mfma_f32_32x32x16_bf16 v[176:191], v[80:83], v[64:67], v[176:191]
    ds_read_b64_tr_b16 v[46:47], v28 offset:29888
    ds_read_b64_tr_b16 v[48:49], v28 offset:29024
    ds_read_b64_tr_b16 v[50:51], v28 offset:29920
    v_mfma_f32_32x32x16_bf16 v[192:207], v[84:87], v[64:67], v[192:207]
    ds_read_b64_tr_b16 v[52:53], v28 offset:29056
    ds_read_b64_tr_b16 v[54:55], v28 offset:29952
    v_mfma_f32_32x32x16_bf16 v[208:223], v[88:91], v[64:67], v[208:223]
    ds_read_b64_tr_b16 v[56:57], v28 offset:29088
    ds_read_b64_tr_b16 v[58:59], v28 offset:29984
    v_mfma_f32_32x32x16_bf16 v[224:239], v[92:95], v[64:67], v[224:239]
    ds_read_b64_tr_b16 v[60:61], v28 offset:29120
    ds_read_b64_tr_b16 v[62:63], v28 offset:30016
    s_waitcnt lgkmcnt(12)
    v_mfma_f32_32x32x16_bf16 v[128:143], v[36:39], v[32:35], v[128:143]
    ds_read_b128 v[64:67], v25 offset:16384
    ds_read_b64_tr_b16 v[68:69], v28 offset:32512
    ds_read_b64_tr_b16 v[70:71], v28 offset:33408
    s_waitcnt lgkmcnt(13)
    v_mfma_f32_32x32x16_bf16 v[144:159], v[40:43], v[32:35], v[144:159]
    ds_read_b64_tr_b16 v[72:73], v28 offset:32544
    ds_read_b64_tr_b16 v[74:75], v28 offset:33440
    s_waitcnt lgkmcnt(13)
    v_mfma_f32_32x32x16_bf16 v[160:175], v[44:47], v[32:35], v[160:175]
    ds_read_b64_tr_b16 v[76:77], v28 offset:32576
    ds_read_b64_tr_b16 v[78:79], v28 offset:33472
    s_waitcnt lgkmcnt(13)
    v_mfma_f32_32x32x16_bf16 v[176:191], v[48:51], v[32:35], v[176:191]
    ds_read_b64_tr_b16 v[80:81], v28 offset:32608
    ds_read_b64_tr_b16 v[82:83], v28 offset:33504
    s_waitcnt lgkmcnt(13)
    v_mfma_f32_32x32x16_bf16 v[192:207], v[52:55], v[32:35], v[192:207]
    ds_read_b64_tr_b16 v[84:85], v28 offset:32640
    ds_read_b64_tr_b16 v[86:87], v28 offset:33536
    s_waitcnt lgkmcnt(13)
    v_mfma_f32_32x32x16_bf16 v[208:223], v[56:59], v[32:35], v[208:223]
    ds_read_b64_tr_b16 v[88:89], v28 offset:32672
    ds_read_b64_tr_b16 v[90:91], v28 offset:33568
    s_waitcnt lgkmcnt(13)
    v_mfma_f32_32x32x16_bf16 v[224:239], v[60:63], v[32:35], v[224:239]
    ds_read_b64_tr_b16 v[92:93], v28 offset:32704
    ds_read_b64_tr_b16 v[94:95], v28 offset:33600
    buffer_load_dwordx2 v[112:113], v121, s[4:7], s101 offen offset:0 sc1
    buffer_load_dwordx2 v[114:115], v121, s[4:7], s101 offen offset:1024 sc1
    buffer_load_dwordx2 v[116:117], v121, s[4:7], s101 offen offset:2048 sc1
    buffer_load_dwordx2 v[118:119], v121, s[4:7], s101 offen offset:3072 sc1
    s_waitcnt lgkmcnt(12)
    v_mfma_f32_32x32x16_bf16 v[128:143], v[68:71], v[64:67], v[128:143]
    ds_read_b128 v[32:35], v26 offset:16384
    ds_read_b64_tr_b16 v[36:37], v28 offset:36096
    ds_read_b64_tr_b16 v[38:39], v28 offset:36992
    s_waitcnt lgkmcnt(13)
    v_mfma_f32_32x32x16_bf16 v[144:159], v[72:75], v[64:67], v[144:159]
    ds_read_b64_tr_b16 v[40:41], v28 offset:36128
    ds_read_b64_tr_b16 v[42:43], v28 offset:37024
    s_waitcnt lgkmcnt(13)
    v_mfma_f32_32x32x16_bf16 v[160:175], v[76:79], v[64:67], v[160:175]
    ds_read_b64_tr_b16 v[44:45], v28 offset:36160
    ds_read_b64_tr_b16 v[46:47], v28 offset:37056
    s_waitcnt lgkmcnt(13)
    v_mfma_f32_32x32x16_bf16 v[176:191], v[80:83], v[64:67], v[176:191]
    ds_read_b64_tr_b16 v[48:49], v28 offset:36192
    ds_read_b64_tr_b16 v[50:51], v28 offset:37088
    s_waitcnt lgkmcnt(13)
    v_mfma_f32_32x32x16_bf16 v[192:207], v[84:87], v[64:67], v[192:207]
    ds_read_b64_tr_b16 v[52:53], v28 offset:36224
    ds_read_b64_tr_b16 v[54:55], v28 offset:37120
    s_waitcnt lgkmcnt(13)
    v_mfma_f32_32x32x16_bf16 v[208:223], v[88:91], v[64:67], v[208:223]
    ds_read_b64_tr_b16 v[56:57], v28 offset:36256
    ds_read_b64_tr_b16 v[58:59], v28 offset:37152
    s_waitcnt lgkmcnt(13)
    v_mfma_f32_32x32x16_bf16 v[224:239], v[92:95], v[64:67], v[224:239]
    ds_read_b64_tr_b16 v[60:61], v28 offset:36288
    ds_read_b64_tr_b16 v[62:63], v28 offset:37184
    s_waitcnt lgkmcnt(12)
    v_mfma_f32_32x32x16_bf16 v[128:143], v[36:39], v[32:35], v[128:143]
    ds_read_b128 v[64:67], v27 offset:16384
    ds_read_b64_tr_b16 v[68:69], v28 offset:39680
    ds_read_b64_tr_b16 v[70:71], v28 offset:40576
    s_waitcnt lgkmcnt(13)
    v_mfma_f32_32x32x16_bf16 v[144:159], v[40:43], v[32:35], v[144:159]
    ds_read_b64_tr_b16 v[72:73], v28 offset:39712
    ds_read_b64_tr_b16 v[74:75], v28 offset:40608
    s_waitcnt lgkmcnt(13)
    v_mfma_f32_32x32x16_bf16 v[160:175], v[44:47], v[32:35], v[160:175]
    ds_read_b64_tr_b16 v[76:77], v28 offset:39744
    ds_read_b64_tr_b16 v[78:79], v28 offset:40640
    s_waitcnt lgkmcnt(13)
    v_mfma_f32_32x32x16_bf16 v[176:191], v[48:51], v[32:35], v[176:191]
    ds_read_b64_tr_b16 v[80:81], v28 offset:39776
    ds_read_b64_tr_b16 v[82:83], v28 offset:40672
    s_waitcnt lgkmcnt(13)
    v_mfma_f32_32x32x16_bf16 v[192:207], v[52:55], v[32:35], v[192:207]
    ds_read_b64_tr_b16 v[84:85], v28 offset:39808
    ds_read_b64_tr_b16 v[86:87], v28 offset:40704
    s_waitcnt lgkmcnt(13)
    v_mfma_f32_32x32x16_bf16 v[208:223], v[56:59], v[32:35], v[208:223]
    ds_read_b64_tr_b16 v[88:89], v28 offset:39840
    ds_read_b64_tr_b16 v[90:91], v28 offset:40736
    s_waitcnt lgkmcnt(13)
    v_mfma_f32_32x32x16_bf16 v[224:239], v[60:63], v[32:35], v[224:239]
    ds_read_b64_tr_b16 v[92:93], v28 offset:39872
    ds_read_b64_tr_b16 v[94:95], v28 offset:40768
    s_waitcnt lgkmcnt(12)
    v_mfma_f32_32x32x16_bf16 v[128:143], v[68:71], v[64:67], v[128:143]
    s_waitcnt lgkmcnt(10)
    v_mfma_f32_32x32x16_bf16 v[144:159], v[72:75], v[64:67], v[144:159]
    s_waitcnt lgkmcnt(0)
    s_barrier
    ds_read_b128 v[32:35], v24 offset:32768
    ds_read_b64_tr_b16 v[36:37], v108 offset:0
    ds_read_b64_tr_b16 v[38:39], v108 offset:896
    v_mfma_f32_32x32x16_bf16 v[160:175], v[76:79], v[64:67], v[160:175]
    ds_read_b64_tr_b16 v[40:41], v108 offset:32
    ds_read_b64_tr_b16 v[42:43], v108 offset:928
    ds_read_b64_tr_b16 v[44:45], v108 offset:64
    v_mfma_f32_32x32x16_bf16 v[176:191], v[80:83], v[64:67], v[176:191]
    ds_read_b64_tr_b16 v[46:47], v108 offset:960
    ds_read_b64_tr_b16 v[48:49], v108 offset:96
    ds_read_b64_tr_b16 v[50:51], v108 offset:992
    v_mfma_f32_32x32x16_bf16 v[192:207], v[84:87], v[64:67], v[192:207]
    ds_read_b64_tr_b16 v[52:53], v108 offset:128
    ds_read_b64_tr_b16 v[54:55], v108 offset:1024
    v_mfma_f32_32x32x16_bf16 v[208:223], v[88:91], v[64:67], v[208:223]
    ds_read_b64_tr_b16 v[56:57], v108 offset:160
    ds_read_b64_tr_b16 v[58:59], v108 offset:1056
    v_mfma_f32_32x32x16_bf16 v[224:239], v[92:95], v[64:67], v[224:239]
    ds_read_b64_tr_b16 v[60:61], v108 offset:192
    ds_read_b64_tr_b16 v[62:63], v108 offset:1088
    s_waitcnt lgkmcnt(12)
    v_mfma_f32_32x32x16_bf16 v[128:143], v[36:39], v[32:35], v[128:143]
    ds_read_b128 v[64:67], v25 offset:32768
    ds_read_b64_tr_b16 v[68:69], v108 offset:3584
    ds_read_b64_tr_b16 v[70:71], v108 offset:4480
    s_waitcnt lgkmcnt(13)
    v_mfma_f32_32x32x16_bf16 v[144:159], v[40:43], v[32:35], v[144:159]
    ds_read_b64_tr_b16 v[72:73], v108 offset:3616
    ds_read_b64_tr_b16 v[74:75], v108 offset:4512
    s_waitcnt lgkmcnt(13)
    v_mfma_f32_32x32x16_bf16 v[160:175], v[44:47], v[32:35], v[160:175]
    ds_read_b64_tr_b16 v[76:77], v108 offset:3648
    ds_read_b64_tr_b16 v[78:79], v108 offset:4544
    s_waitcnt lgkmcnt(13)
    v_mfma_f32_32x32x16_bf16 v[176:191], v[48:51], v[32:35], v[176:191]
    ds_read_b64_tr_b16 v[80:81], v108 offset:3680
    ds_read_b64_tr_b16 v[82:83], v108 offset:4576
    s_waitcnt lgkmcnt(13)
    v_mfma_f32_32x32x16_bf16 v[192:207], v[52:55], v[32:35], v[192:207]
    ds_read_b64_tr_b16 v[84:85], v108 offset:3712
    ds_read_b64_tr_b16 v[86:87], v108 offset:4608
    s_waitcnt lgkmcnt(13)
    v_mfma_f32_32x32x16_bf16 v[208:223], v[56:59], v[32:35], v[208:223]
    ds_read_b64_tr_b16 v[88:89], v108 offset:3744
    ds_read_b64_tr_b16 v[90:91], v108 offset:4640
    s_waitcnt lgkmcnt(13)
    v_mfma_f32_32x32x16_bf16 v[224:239], v[60:63], v[32:35], v[224:239]
    ds_read_b64_tr_b16 v[92:93], v108 offset:3776
    ds_read_b64_tr_b16 v[94:95], v108 offset:4672
    s_waitcnt lgkmcnt(12)
    v_mfma_f32_32x32x16_bf16 v[128:143], v[68:71], v[64:67], v[128:143]
    ds_read_b128 v[32:35], v26 offset:32768
    ds_read_b64_tr_b16 v[36:37], v108 offset:7168
    ds_read_b64_tr_b16 v[38:39], v108 offset:8064
    s_waitcnt lgkmcnt(13)
    v_mfma_f32_32x32x16_bf16 v[144:159], v[72:75], v[64:67], v[144:159]
    ds_read_b64_tr_b16 v[40:41], v108 offset:7200
    ds_read_b64_tr_b16 v[42:43], v108 offset:8096
    s_waitcnt lgkmcnt(13)
    v_mfma_f32_32x32x16_bf16 v[160:175], v[76:79], v[64:67], v[160:175]
    ds_read_b64_tr_b16 v[44:45], v108 offset:7232
    ds_read_b64_tr_b16 v[46:47], v108 offset:8128
    s_waitcnt lgkmcnt(13)
    v_mfma_f32_32x32x16_bf16 v[176:191], v[80:83], v[64:67], v[176:191]
    ds_read_b64_tr_b16 v[48:49], v108 offset:7264
    ds_read_b64_tr_b16 v[50:51], v108 offset:8160
    s_waitcnt lgkmcnt(13)
    v_mfma_f32_32x32x16_bf16 v[192:207], v[84:87], v[64:67], v[192:207]
    ds_read_b64_tr_b16 v[52:53], v108 offset:7296
    ds_read_b64_tr_b16 v[54:55], v108 offset:8192
    s_waitcnt lgkmcnt(13)
    v_mfma_f32_32x32x16_bf16 v[208:223], v[88:91], v[64:67], v[208:223]
    ds_read_b64_tr_b16 v[56:57], v108 offset:7328
    ds_read_b64_tr_b16 v[58:59], v108 offset:8224
    s_waitcnt lgkmcnt(13)
    v_mfma_f32_32x32x16_bf16 v[224:239], v[92:95], v[64:67], v[224:239]
    ds_read_b64_tr_b16 v[60:61], v108 offset:7360
    ds_read_b64_tr_b16 v[62:63], v108 offset:8256
    s_waitcnt lgkmcnt(12)
    v_mfma_f32_32x32x16_bf16 v[128:143], v[36:39], v[32:35], v[128:143]
    ds_read_b128 v[64:67], v27 offset:32768
    ds_read_b64_tr_b16 v[68:69], v108 offset:10752
    ds_read_b64_tr_b16 v[70:71], v108 offset:11648
    s_waitcnt lgkmcnt(13)
    v_mfma_f32_32x32x16_bf16 v[144:159], v[40:43], v[32:35], v[144:159]
    ds_read_b64_tr_b16 v[72:73], v108 offset:10784
    ds_read_b64_tr_b16 v[74:75], v108 offset:11680
    s_waitcnt lgkmcnt(13)
    v_mfma_f32_32x32x16_bf16 v[160:175], v[44:47], v[32:35], v[160:175]
    ds_read_b64_tr_b16 v[76:77], v108 offset:10816
    ds_read_b64_tr_b16 v[78:79], v108 offset:11712
    s_waitcnt lgkmcnt(13)
    v_mfma_f32_32x32x16_bf16 v[176:191], v[48:51], v[32:35], v[176:191]
    ds_read_b64_tr_b16 v[80:81], v108 offset:10848
    ds_read_b64_tr_b16 v[82:83], v108 offset:11744
    s_waitcnt lgkmcnt(13)
    v_mfma_f32_32x32x16_bf16 v[192:207], v[52:55], v[32:35], v[192:207]
    ds_read_b64_tr_b16 v[84:85], v108 offset:10880
    ds_read_b64_tr_b16 v[86:87], v108 offset:11776
    s_waitcnt lgkmcnt(13)
    v_mfma_f32_32x32x16_bf16 v[208:223], v[56:59], v[32:35], v[208:223]
    ds_read_b64_tr_b16 v[88:89], v108 offset:10912
    ds_read_b64_tr_b16 v[90:91], v108 offset:11808
    s_waitcnt lgkmcnt(13)
    v_mfma_f32_32x32x16_bf16 v[224:239], v[60:63], v[32:35], v[224:239]
    ds_read_b64_tr_b16 v[92:93], v108 offset:10944
    ds_read_b64_tr_b16 v[94:95], v108 offset:11840
    s_waitcnt lgkmcnt(12)
    v_mfma_f32_32x32x16_bf16 v[128:143], v[68:71], v[64:67], v[128:143]
    s_waitcnt lgkmcnt(10)
    v_mfma_f32_32x32x16_bf16 v[144:159], v[72:75], v[64:67], v[144:159]
    s_waitcnt lgkmcnt(0)
    s_barrier
    ds_read_b128 v[32:35], v24 offset:49152
    ds_read_b64_tr_b16 v[36:37], v28 offset:0
    ds_read_b64_tr_b16 v[38:39], v28 offset:896
    v_mfma_f32_32x32x16_bf16 v[160:175], v[76:79], v[64:67], v[160:175]
    ds_read_b64_tr_b16 v[40:41], v28 offset:32
    ds_read_b64_tr_b16 v[42:43], v28 offset:928
    ds_read_b64_tr_b16 v[44:45], v28 offset:64
    v_mfma_f32_32x32x16_bf16 v[176:191], v[80:83], v[64:67], v[176:191]
    ds_read_b64_tr_b16 v[46:47], v28 offset:960
    ds_read_b64_tr_b16 v[48:49], v28 offset:96
    ds_read_b64_tr_b16 v[50:51], v28 offset:992
    v_mfma_f32_32x32x16_bf16 v[192:207], v[84:87], v[64:67], v[192:207]
    ds_read_b64_tr_b16 v[52:53], v28 offset:128
    ds_read_b64_tr_b16 v[54:55], v28 offset:1024
    v_mfma_f32_32x32x16_bf16 v[208:223], v[88:91], v[64:67], v[208:223]
    ds_read_b64_tr_b16 v[56:57], v28 offset:160
    ds_read_b64_tr_b16 v[58:59], v28 offset:1056
    v_mfma_f32_32x32x16_bf16 v[224:239], v[92:95], v[64:67], v[224:239]
    ds_read_b64_tr_b16 v[60:61], v28 offset:192
    ds_read_b64_tr_b16 v[62:63], v28 offset:1088
    s_waitcnt lgkmcnt(12)
    v_mfma_f32_32x32x16_bf16 v[128:143], v[36:39], v[32:35], v[128:143]
    ds_read_b128 v[64:67], v25 offset:49152
    ds_read_b64_tr_b16 v[68:69], v28 offset:3584
    ds_read_b64_tr_b16 v[70:71], v28 offset:4480
    s_waitcnt lgkmcnt(13)
    v_mfma_f32_32x32x16_bf16 v[144:159], v[40:43], v[32:35], v[144:159]
    ds_read_b64_tr_b16 v[72:73], v28 offset:3616
    ds_read_b64_tr_b16 v[74:75], v28 offset:4512
    s_waitcnt lgkmcnt(13)
    v_mfma_f32_32x32x16_bf16 v[160:175], v[44:47], v[32:35], v[160:175]
    ds_read_b64_tr_b16 v[76:77], v28 offset:3648
    ds_read_b64_tr_b16 v[78:79], v28 offset:4544
    s_waitcnt lgkmcnt(13)
    v_mfma_f32_32x32x16_bf16 v[176:191], v[48:51], v[32:35], v[176:191]
    ds_read_b64_tr_b16 v[80:81], v28 offset:3680
    ds_read_b64_tr_b16 v[82:83], v28 offset:4576
    s_waitcnt lgkmcnt(13)
    v_mfma_f32_32x32x16_bf16 v[192:207], v[52:55], v[32:35], v[192:207]
    ds_read_b64_tr_b16 v[84:85], v28 offset:3712
    ds_read_b64_tr_b16 v[86:87], v28 offset:4608
    s_waitcnt lgkmcnt(13)
    v_mfma_f32_32x32x16_bf16 v[208:223], v[56:59], v[32:35], v[208:223]
    ds_read_b64_tr_b16 v[88:89], v28 offset:3744
    ds_read_b64_tr_b16 v[90:91], v28 offset:4640
    s_waitcnt lgkmcnt(13)
    v_mfma_f32_32x32x16_bf16 v[224:239], v[60:63], v[32:35], v[224:239]
    ds_read_b64_tr_b16 v[92:93], v28 offset:3776
    ds_read_b64_tr_b16 v[94:95], v28 offset:4672
    s_waitcnt lgkmcnt(12)
    v_mfma_f32_32x32x16_bf16 v[128:143], v[68:71], v[64:67], v[128:143]
    ds_read_b128 v[32:35], v26 offset:49152
    ds_read_b64_tr_b16 v[36:37], v28 offset:7168
    ds_read_b64_tr_b16 v[38:39], v28 offset:8064
    s_waitcnt lgkmcnt(13)
    v_mfma_f32_32x32x16_bf16 v[144:159], v[72:75], v[64:67], v[144:159]
    ds_read_b64_tr_b16 v[40:41], v28 offset:7200
    ds_read_b64_tr_b16 v[42:43], v28 offset:8096
    s_waitcnt lgkmcnt(13)
    v_mfma_f32_32x32x16_bf16 v[160:175], v[76:79], v[64:67], v[160:175]
    ds_read_b64_tr_b16 v[44:45], v28 offset:7232
    ds_read_b64_tr_b16 v[46:47], v28 offset:8128
    s_waitcnt lgkmcnt(13)
    v_mfma_f32_32x32x16_bf16 v[176:191], v[80:83], v[64:67], v[176:191]
    ds_read_b64_tr_b16 v[48:49], v28 offset:7264
    ds_read_b64_tr_b16 v[50:51], v28 offset:8160
    s_waitcnt lgkmcnt(13)
    v_mfma_f32_32x32x16_bf16 v[192:207], v[84:87], v[64:67], v[192:207]
    ds_read_b64_tr_b16 v[52:53], v28 offset:7296
    ds_read_b64_tr_b16 v[54:55], v28 offset:8192
    s_waitcnt lgkmcnt(13)
    v_mfma_f32_32x32x16_bf16 v[208:223], v[88:91], v[64:67], v[208:223]
    ds_read_b64_tr_b16 v[56:57], v28 offset:7328
    ds_read_b64_tr_b16 v[58:59], v28 offset:8224
    s_waitcnt lgkmcnt(13)
    v_mfma_f32_32x32x16_bf16 v[224:239], v[92:95], v[64:67], v[224:239]
    ds_read_b64_tr_b16 v[60:61], v28 offset:7360
    ds_read_b64_tr_b16 v[62:63], v28 offset:8256
    s_waitcnt lgkmcnt(12)
    v_mfma_f32_32x32x16_bf16 v[128:143], v[36:39], v[32:35], v[128:143]
    ds_read_b128 v[64:67], v27 offset:49152
    ds_read_b64_tr_b16 v[68:69], v28 offset:10752
    ds_read_b64_tr_b16 v[70:71], v28 offset:11648
    s_waitcnt lgkmcnt(13)
    v_mfma_f32_32x32x16_bf16 v[144:159], v[40:43], v[32:35], v[144:159]
    ds_read_b64_tr_b16 v[72:73], v28 offset:10784
    ds_read_b64_tr_b16 v[74:75], v28 offset:11680
    s_waitcnt lgkmcnt(13)
    v_mfma_f32_32x32x16_bf16 v[160:175], v[44:47], v[32:35], v[160:175]
    ds_read_b64_tr_b16 v[76:77], v28 offset:10816
    ds_read_b64_tr_b16 v[78:79], v28 offset:11712
    s_waitcnt lgkmcnt(13)
    v_mfma_f32_32x32x16_bf16 v[176:191], v[48:51], v[32:35], v[176:191]
    ds_read_b64_tr_b16 v[80:81], v28 offset:10848
    ds_read_b64_tr_b16 v[82:83], v28 offset:11744
    s_waitcnt lgkmcnt(13)
    v_mfma_f32_32x32x16_bf16 v[192:207], v[52:55], v[32:35], v[192:207]
    ds_read_b64_tr_b16 v[84:85], v28 offset:10880
    ds_read_b64_tr_b16 v[86:87], v28 offset:11776
    s_waitcnt lgkmcnt(13)
    v_mfma_f32_32x32x16_bf16 v[208:223], v[56:59], v[32:35], v[208:223]
    ds_read_b64_tr_b16 v[88:89], v28 offset:10912
    ds_read_b64_tr_b16 v[90:91], v28 offset:11808
    s_waitcnt lgkmcnt(13)
    v_mfma_f32_32x32x16_bf16 v[224:239], v[60:63], v[32:35], v[224:239]
    ds_read_b64_tr_b16 v[92:93], v28 offset:10944
    ds_read_b64_tr_b16 v[94:95], v28 offset:11840
    s_waitcnt lgkmcnt(12)
    v_mfma_f32_32x32x16_bf16 v[128:143], v[68:71], v[64:67], v[128:143]
    s_waitcnt lgkmcnt(10)
    v_mfma_f32_32x32x16_bf16 v[144:159], v[72:75], v[64:67], v[144:159]
    s_waitcnt lgkmcnt(0)
    s_barrier
    ds_read_b128 v[32:35], v24 offset:0
    ds_read_b64_tr_b16 v[36:37], v28 offset:28928
    ds_read_b64_tr_b16 v[38:39], v28 offset:29824
    v_mfma_f32_32x32x16_bf16 v[160:175], v[76:79], v[64:67], v[160:175]
    ds_read_b64_tr_b16 v[40:41], v28 offset:28960
    ds_read_b64_tr_b16 v[42:43], v28 offset:29856
    ds_read_b64_tr_b16 v[44:45], v28 offset:28992
    v_mfma_f32_32x32x16_bf16 v[176:191], v[80:83], v[64:67], v[176:191]
    ds_read_b64_tr_b16 v[46:47], v28 offset:29888
    ds_read_b64_tr_b16 v[48:49], v28 offset:29024
    ds_read_b64_tr_b16 v[50:51], v28 offset:29920
    v_mfma_f32_32x32x16_bf16 v[192:207], v[84:87], v[64:67], v[192:207]
    ds_read_b64_tr_b16 v[52:53], v28 offset:29056
    ds_read_b64_tr_b16 v[54:55], v28 offset:29952
    v_mfma_f32_32x32x16_bf16 v[208:223], v[88:91], v[64:67], v[208:223]
    ds_read_b64_tr_b16 v[56:57], v28 offset:29088
    ds_read_b64_tr_b16 v[58:59], v28 offset:29984
    v_mfma_f32_32x32x16_bf16 v[224:239], v[92:95], v[64:67], v[224:239]
    ds_read_b64_tr_b16 v[60:61], v28 offset:29120
    ds_read_b64_tr_b16 v[62:63], v28 offset:30016
    s_waitcnt lgkmcnt(12)
    v_mfma_f32_32x32x16_bf16 v[128:143], v[36:39], v[32:35], v[128:143]
    ds_read_b128 v[64:67], v25 offset:0
    ds_read_b64_tr_b16 v[68:69], v28 offset:32512
    ds_read_b64_tr_b16 v[70:71], v28 offset:33408
    s_waitcnt lgkmcnt(13)
    v_mfma_f32_32x32x16_bf16 v[144:159], v[40:43], v[32:35], v[144:159]
    ds_read_b64_tr_b16 v[72:73], v28 offset:32544
    ds_read_b64_tr_b16 v[74:75], v28 offset:33440
    s_waitcnt lgkmcnt(13)
    v_mfma_f32_32x32x16_bf16 v[160:175], v[44:47], v[32:35], v[160:175]
    ds_read_b64_tr_b16 v[76:77], v28 offset:32576
    ds_read_b64_tr_b16 v[78:79], v28 offset:33472
    s_waitcnt lgkmcnt(13)
    v_mfma_f32_32x32x16_bf16 v[176:191], v[48:51], v[32:35], v[176:191]
    ds_read_b64_tr_b16 v[80:81], v28 offset:32608
    ds_read_b64_tr_b16 v[82:83], v28 offset:33504
    s_waitcnt lgkmcnt(13)
    v_mfma_f32_32x32x16_bf16 v[192:207], v[52:55], v[32:35], v[192:207]
    ds_read_b64_tr_b16 v[84:85], v28 offset:32640
    ds_read_b64_tr_b16 v[86:87], v28 offset:33536
    s_waitcnt lgkmcnt(13)
    v_mfma_f32_32x32x16_bf16 v[208:223], v[56:59], v[32:35], v[208:223]
    ds_read_b64_tr_b16 v[88:89], v28 offset:32672
    ds_read_b64_tr_b16 v[90:91], v28 offset:33568
    s_waitcnt lgkmcnt(13)
    v_mfma_f32_32x32x16_bf16 v[224:239], v[60:63], v[32:35], v[224:239]
    ds_read_b64_tr_b16 v[92:93], v28 offset:32704
    ds_read_b64_tr_b16 v[94:95], v28 offset:33600
    s_waitcnt lgkmcnt(12)
    v_mfma_f32_32x32x16_bf16 v[128:143], v[68:71], v[64:67], v[128:143]
    ds_read_b128 v[32:35], v26 offset:0
    ds_read_b64_tr_b16 v[36:37], v28 offset:36096
    ds_read_b64_tr_b16 v[38:39], v28 offset:36992
    s_waitcnt lgkmcnt(13)
    v_mfma_f32_32x32x16_bf16 v[144:159], v[72:75], v[64:67], v[144:159]
    ds_read_b64_tr_b16 v[40:41], v28 offset:36128
    ds_read_b64_tr_b16 v[42:43], v28 offset:37024
    s_waitcnt lgkmcnt(13)
    v_mfma_f32_32x32x16_bf16 v[160:175], v[76:79], v[64:67], v[160:175]
    ds_read_b64_tr_b16 v[44:45], v28 offset:36160
    ds_read_b64_tr_b16 v[46:47], v28 offset:37056
    s_waitcnt lgkmcnt(13)
    v_mfma_f32_32x32x16_bf16 v[176:191], v[80:83], v[64:67], v[176:191]
    ds_read_b64_tr_b16 v[48:49], v28 offset:36192
    ds_read_b64_tr_b16 v[50:51], v28 offset:37088
    s_waitcnt lgkmcnt(13)
    v_mfma_f32_32x32x16_bf16 v[192:207], v[84:87], v[64:67], v[192:207]
    ds_read_b64_tr_b16 v[52:53], v28 offset:36224
    ds_read_b64_tr_b16 v[54:55], v28 offset:37120
    s_waitcnt lgkmcnt(13)
    v_mfma_f32_32x32x16_bf16 v[208:223], v[88:91], v[64:67], v[208:223]
    ds_read_b64_tr_b16 v[56:57], v28 offset:36256
    ds_read_b64_tr_b16 v[58:59], v28 offset:37152
    s_waitcnt lgkmcnt(13)
    v_mfma_f32_32x32x16_bf16 v[224:239], v[92:95], v[64:67], v[224:239]
    ds_read_b64_tr_b16 v[60:61], v28 offset:36288
    ds_read_b64_tr_b16 v[62:63], v28 offset:37184
    s_waitcnt lgkmcnt(12)
    v_mfma_f32_32x32x16_bf16 v[128:143], v[36:39], v[32:35], v[128:143]
    ds_read_b128 v[64:67], v27 offset:0
    ds_read_b64_tr_b16 v[68:69], v28 offset:39680
    ds_read_b64_tr_b16 v[70:71], v28 offset:40576
    s_waitcnt lgkmcnt(13)
    v_mfma_f32_32x32x16_bf16 v[144:159], v[40:43], v[32:35], v[144:159]
    ds_read_b64_tr_b16 v[72:73], v28 offset:39712
    ds_read_b64_tr_b16 v[74:75], v28 offset:40608
    s_waitcnt lgkmcnt(13)
    v_mfma_f32_32x32x16_bf16 v[160:175], v[44:47], v[32:35], v[160:175]
    ds_read_b64_tr_b16 v[76:77], v28 offset:39744
    ds_read_b64_tr_b16 v[78:79], v28 offset:40640
    s_waitcnt lgkmcnt(13)
    v_mfma_f32_32x32x16_bf16 v[176:191], v[48:51], v[32:35], v[176:191]
    ds_read_b64_tr_b16 v[80:81], v28 offset:39776
    ds_read_b64_tr_b16 v[82:83], v28 offset:40672
    s_waitcnt lgkmcnt(13)
    v_mfma_f32_32x32x16_bf16 v[192:207], v[52:55], v[32:35], v[192:207]
    ds_read_b64_tr_b16 v[84:85], v28 offset:39808
    ds_read_b64_tr_b16 v[86:87], v28 offset:40704
    s_waitcnt lgkmcnt(13)
    v_mfma_f32_32x32x16_bf16 v[208:223], v[56:59], v[32:35], v[208:223]
    ds_read_b64_tr_b16 v[88:89], v28 offset:39840
    ds_read_b64_tr_b16 v[90:91], v28 offset:40736
    s_waitcnt lgkmcnt(13)
    v_mfma_f32_32x32x16_bf16 v[224:239], v[60:63], v[32:35], v[224:239]
    ds_read_b64_tr_b16 v[92:93], v28 offset:39872
    ds_read_b64_tr_b16 v[94:95], v28 offset:40768
    s_waitcnt lgkmcnt(12)
    v_mfma_f32_32x32x16_bf16 v[128:143], v[68:71], v[64:67], v[128:143]
    s_waitcnt lgkmcnt(10)
    v_mfma_f32_32x32x16_bf16 v[144:159], v[72:75], v[64:67], v[144:159]
    s_waitcnt lgkmcnt(0)
    s_barrier
    ds_read_b128 v[32:35], v24 offset:16384
    ds_read_b64_tr_b16 v[36:37], v108 offset:0
    ds_read_b64_tr_b16 v[38:39], v108 offset:896
    v_mfma_f32_32x32x16_bf16 v[160:175], v[76:79], v[64:67], v[160:175]
    ds_read_b64_tr_b16 v[40:41], v108 offset:32
    ds_read_b64_tr_b16 v[42:43], v108 offset:928
    ds_read_b64_tr_b16 v[44:45], v108 offset:64
    v_mfma_f32_32x32x16_bf16 v[176:191], v[80:83], v[64:67], v[176:191]
    ds_read_b64_tr_b16 v[46:47], v108 offset:960
    ds_read_b64_tr_b16 v[48:49], v108 offset:96
    ds_read_b64_tr_b16 v[50:51], v108 offset:992
    v_mfma_f32_32x32x16_bf16 v[192:207], v[84:87], v[64:67], v[192:207]
    ds_read_b64_tr_b16 v[52:53], v108 offset:128
    ds_read_b64_tr_b16 v[54:55], v108 offset:1024
    v_mfma_f32_32x32x16_bf16 v[208:223], v[88:91], v[64:67], v[208:223]
    ds_read_b64_tr_b16 v[56:57], v108 offset:160
    ds_read_b64_tr_b16 v[58:59], v108 offset:1056
    v_mfma_f32_32x32x16_bf16 v[224:239], v[92:95], v[64:67], v[224:239]
    ds_read_b64_tr_b16 v[60:61], v108 offset:192
    ds_read_b64_tr_b16 v[62:63], v108 offset:1088
    s_waitcnt lgkmcnt(12)
    v_mfma_f32_32x32x16_bf16 v[128:143], v[36:39], v[32:35], v[128:143]
    ds_read_b128 v[64:67], v25 offset:16384
    ds_read_b64_tr_b16 v[68:69], v108 offset:3584
    ds_read_b64_tr_b16 v[70:71], v108 offset:4480
    s_waitcnt lgkmcnt(13)
    v_mfma_f32_32x32x16_bf16 v[144:159], v[40:43], v[32:35], v[144:159]
    ds_read_b64_tr_b16 v[72:73], v108 offset:3616
    ds_read_b64_tr_b16 v[74:75], v108 offset:4512
    s_waitcnt lgkmcnt(13)
    v_mfma_f32_32x32x16_bf16 v[160:175], v[44:47], v[32:35], v[160:175]
    ds_read_b64_tr_b16 v[76:77], v108 offset:3648
    ds_read_b64_tr_b16 v[78:79], v108 offset:4544
    s_waitcnt lgkmcnt(13)
    v_mfma_f32_32x32x16_bf16 v[176:191], v[48:51], v[32:35], v[176:191]
    ds_read_b64_tr_b16 v[80:81], v108 offset:3680
    ds_read_b64_tr_b16 v[82:83], v108 offset:4576
    s_waitcnt lgkmcnt(13)
    v_mfma_f32_32x32x16_bf16 v[192:207], v[52:55], v[32:35], v[192:207]
    ds_read_b64_tr_b16 v[84:85], v108 offset:3712
    ds_read_b64_tr_b16 v[86:87], v108 offset:4608
    s_waitcnt lgkmcnt(13)
    v_mfma_f32_32x32x16_bf16 v[208:223], v[56:59], v[32:35], v[208:223]
    ds_read_b64_tr_b16 v[88:89], v108 offset:3744
    ds_read_b64_tr_b16 v[90:91], v108 offset:4640
    s_waitcnt lgkmcnt(13)
    v_mfma_f32_32x32x16_bf16 v[224:239], v[60:63], v[32:35], v[224:239]
    ds_read_b64_tr_b16 v[92:93], v108 offset:3776
    ds_read_b64_tr_b16 v[94:95], v108 offset:4672
    s_waitcnt lgkmcnt(12)
    v_mfma_f32_32x32x16_bf16 v[128:143], v[68:71], v[64:67], v[128:143]
    ds_read_b128 v[32:35], v26 offset:16384
    ds_read_b64_tr_b16 v[36:37], v108 offset:7168
    ds_read_b64_tr_b16 v[38:39], v108 offset:8064
    s_waitcnt lgkmcnt(13)
    v_mfma_f32_32x32x16_bf16 v[144:159], v[72:75], v[64:67], v[144:159]
    ds_read_b64_tr_b16 v[40:41], v108 offset:7200
    ds_read_b64_tr_b16 v[42:43], v108 offset:8096
    s_waitcnt lgkmcnt(13)
    v_mfma_f32_32x32x16_bf16 v[160:175], v[76:79], v[64:67], v[160:175]
    ds_read_b64_tr_b16 v[44:45], v108 offset:7232
    ds_read_b64_tr_b16 v[46:47], v108 offset:8128
    s_waitcnt lgkmcnt(13)
    v_mfma_f32_32x32x16_bf16 v[176:191], v[80:83], v[64:67], v[176:191]
    ds_read_b64_tr_b16 v[48:49], v108 offset:7264
    ds_read_b64_tr_b16 v[50:51], v108 offset:8160
    s_waitcnt lgkmcnt(13)
    v_mfma_f32_32x32x16_bf16 v[192:207], v[84:87], v[64:67], v[192:207]
    ds_read_b64_tr_b16 v[52:53], v108 offset:7296
    ds_read_b64_tr_b16 v[54:55], v108 offset:8192
    s_waitcnt lgkmcnt(13)
    v_mfma_f32_32x32x16_bf16 v[208:223], v[88:91], v[64:67], v[208:223]
    ds_read_b64_tr_b16 v[56:57], v108 offset:7328
    ds_read_b64_tr_b16 v[58:59], v108 offset:8224
    s_waitcnt lgkmcnt(13)
    v_mfma_f32_32x32x16_bf16 v[224:239], v[92:95], v[64:67], v[224:239]
    ds_read_b64_tr_b16 v[60:61], v108 offset:7360
    ds_read_b64_tr_b16 v[62:63], v108 offset:8256
    s_waitcnt lgkmcnt(12)
    v_mfma_f32_32x32x16_bf16 v[128:143], v[36:39], v[32:35], v[128:143]
    ds_read_b128 v[64:67], v27 offset:16384
    ds_read_b64_tr_b16 v[68:69], v108 offset:10752
    ds_read_b64_tr_b16 v[70:71], v108 offset:11648
    s_waitcnt lgkmcnt(13)
    v_mfma_f32_32x32x16_bf16 v[144:159], v[40:43], v[32:35], v[144:159]
    ds_read_b64_tr_b16 v[72:73], v108 offset:10784
    ds_read_b64_tr_b16 v[74:75], v108 offset:11680
    s_waitcnt lgkmcnt(13)
    v_mfma_f32_32x32x16_bf16 v[160:175], v[44:47], v[32:35], v[160:175]
    ds_read_b64_tr_b16 v[76:77], v108 offset:10816
    ds_read_b64_tr_b16 v[78:79], v108 offset:11712
    s_waitcnt lgkmcnt(13)
    v_mfma_f32_32x32x16_bf16 v[176:191], v[48:51], v[32:35], v[176:191]
    ds_read_b64_tr_b16 v[80:81], v108 offset:10848
    ds_read_b64_tr_b16 v[82:83], v108 offset:11744
    s_waitcnt lgkmcnt(13)
    v_mfma_f32_32x32x16_bf16 v[192:207], v[52:55], v[32:35], v[192:207]
    ds_read_b64_tr_b16 v[84:85], v108 offset:10880
    ds_read_b64_tr_b16 v[86:87], v108 offset:11776
    s_waitcnt lgkmcnt(13)
    v_mfma_f32_32x32x16_bf16 v[208:223], v[56:59], v[32:35], v[208:223]
    ds_read_b64_tr_b16 v[88:89], v108 offset:10912
    ds_read_b64_tr_b16 v[90:91], v108 offset:11808
    s_waitcnt lgkmcnt(13)
    v_mfma_f32_32x32x16_bf16 v[224:239], v[60:63], v[32:35], v[224:239]
    ds_read_b64_tr_b16 v[92:93], v108 offset:10944
    ds_read_b64_tr_b16 v[94:95], v108 offset:11840
    s_waitcnt lgkmcnt(12)
    v_mfma_f32_32x32x16_bf16 v[128:143], v[68:71], v[64:67], v[128:143]
    s_waitcnt lgkmcnt(10)
    v_mfma_f32_32x32x16_bf16 v[144:159], v[72:75], v[64:67], v[144:159]
    s_waitcnt lgkmcnt(0)
    s_barrier
    ds_read_b128 v[32:35], v24 offset:32768
    ds_read_b64_tr_b16 v[36:37], v28 offset:0
    ds_read_b64_tr_b16 v[38:39], v28 offset:896
    v_mfma_f32_32x32x16_bf16 v[160:175], v[76:79], v[64:67], v[160:175]
    ds_read_b64_tr_b16 v[40:41], v28 offset:32
    ds_read_b64_tr_b16 v[42:43], v28 offset:928
    ds_read_b64_tr_b16 v[44:45], v28 offset:64
    v_mfma_f32_32x32x16_bf16 v[176:191], v[80:83], v[64:67], v[176:191]
    ds_read_b64_tr_b16 v[46:47], v28 offset:960
    ds_read_b64_tr_b16 v[48:49], v28 offset:96
    ds_read_b64_tr_b16 v[50:51], v28 offset:992
    v_mfma_f32_32x32x16_bf16 v[192:207], v[84:87], v[64:67], v[192:207]
    ds_read_b64_tr_b16 v[52:53], v28 offset:128
    ds_read_b64_tr_b16 v[54:55], v28 offset:1024
    v_mfma_f32_32x32x16_bf16 v[208:223], v[88:91], v[64:67], v[208:223]
    ds_read_b64_tr_b16 v[56:57], v28 offset:160
    ds_read_b64_tr_b16 v[58:59], v28 offset:1056
    v_mfma_f32_32x32x16_bf16 v[224:239], v[92:95], v[64:67], v[224:239]
    ds_read_b64_tr_b16 v[60:61], v28 offset:192
    ds_read_b64_tr_b16 v[62:63], v28 offset:1088
    s_waitcnt lgkmcnt(12)
    v_mfma_f32_32x32x16_bf16 v[128:143], v[36:39], v[32:35], v[128:143]
    ds_read_b128 v[64:67], v25 offset:32768
    ds_read_b64_tr_b16 v[68:69], v28 offset:3584
    ds_read_b64_tr_b16 v[70:71], v28 offset:4480
    s_waitcnt lgkmcnt(13)
    v_mfma_f32_32x32x16_bf16 v[144:159], v[40:43], v[32:35], v[144:159]
    ds_read_b64_tr_b16 v[72:73], v28 offset:3616
    ds_read_b64_tr_b16 v[74:75], v28 offset:4512
    s_waitcnt lgkmcnt(13)
    v_mfma_f32_32x32x16_bf16 v[160:175], v[44:47], v[32:35], v[160:175]
    ds_read_b64_tr_b16 v[76:77], v28 offset:3648
    ds_read_b64_tr_b16 v[78:79], v28 offset:4544
    s_waitcnt lgkmcnt(13)
    v_mfma_f32_32x32x16_bf16 v[176:191], v[48:51], v[32:35], v[176:191]
    ds_read_b64_tr_b16 v[80:81], v28 offset:3680
    ds_read_b64_tr_b16 v[82:83], v28 offset:4576
    s_waitcnt lgkmcnt(13)
    v_mfma_f32_32x32x16_bf16 v[192:207], v[52:55], v[32:35], v[192:207]
    ds_read_b64_tr_b16 v[84:85], v28 offset:3712
    ds_read_b64_tr_b16 v[86:87], v28 offset:4608
    s_waitcnt lgkmcnt(13)
    v_mfma_f32_32x32x16_bf16 v[208:223], v[56:59], v[32:35], v[208:223]
    ds_read_b64_tr_b16 v[88:89], v28 offset:3744
    ds_read_b64_tr_b16 v[90:91], v28 offset:4640
    s_waitcnt lgkmcnt(13)
    v_mfma_f32_32x32x16_bf16 v[224:239], v[60:63], v[32:35], v[224:239]
    ds_read_b64_tr_b16 v[92:93], v28 offset:3776
    ds_read_b64_tr_b16 v[94:95], v28 offset:4672
    s_waitcnt lgkmcnt(12)
    v_mfma_f32_32x32x16_bf16 v[128:143], v[68:71], v[64:67], v[128:143]
    ds_read_b128 v[32:35], v26 offset:32768
    ds_read_b64_tr_b16 v[36:37], v28 offset:7168
    ds_read_b64_tr_b16 v[38:39], v28 offset:8064
    s_waitcnt lgkmcnt(13)
    v_mfma_f32_32x32x16_bf16 v[144:159], v[72:75], v[64:67], v[144:159]
    ds_read_b64_tr_b16 v[40:41], v28 offset:7200
    ds_read_b64_tr_b16 v[42:43], v28 offset:8096
    s_waitcnt lgkmcnt(13)
    v_mfma_f32_32x32x16_bf16 v[160:175], v[76:79], v[64:67], v[160:175]
    ds_read_b64_tr_b16 v[44:45], v28 offset:7232
    ds_read_b64_tr_b16 v[46:47], v28 offset:8128
    s_waitcnt lgkmcnt(13)
    v_mfma_f32_32x32x16_bf16 v[176:191], v[80:83], v[64:67], v[176:191]
    ds_read_b64_tr_b16 v[48:49], v28 offset:7264
    ds_read_b64_tr_b16 v[50:51], v28 offset:8160
    s_waitcnt lgkmcnt(13)
    v_mfma_f32_32x32x16_bf16 v[192:207], v[84:87], v[64:67], v[192:207]
    ds_read_b64_tr_b16 v[52:53], v28 offset:7296
    ds_read_b64_tr_b16 v[54:55], v28 offset:8192
    s_waitcnt lgkmcnt(13)
    v_mfma_f32_32x32x16_bf16 v[208:223], v[88:91], v[64:67], v[208:223]
    ds_read_b64_tr_b16 v[56:57], v28 offset:7328
    ds_read_b64_tr_b16 v[58:59], v28 offset:8224
    s_waitcnt lgkmcnt(13)
    v_mfma_f32_32x32x16_bf16 v[224:239], v[92:95], v[64:67], v[224:239]
    ds_read_b64_tr_b16 v[60:61], v28 offset:7360
    ds_read_b64_tr_b16 v[62:63], v28 offset:8256
    s_waitcnt lgkmcnt(12)
    v_mfma_f32_32x32x16_bf16 v[128:143], v[36:39], v[32:35], v[128:143]
    ds_read_b128 v[64:67], v27 offset:32768
    ds_read_b64_tr_b16 v[68:69], v28 offset:10752
    ds_read_b64_tr_b16 v[70:71], v28 offset:11648
    s_waitcnt lgkmcnt(13)
    v_mfma_f32_32x32x16_bf16 v[144:159], v[40:43], v[32:35], v[144:159]
    ds_read_b64_tr_b16 v[72:73], v28 offset:10784
    ds_read_b64_tr_b16 v[74:75], v28 offset:11680
    s_waitcnt lgkmcnt(13)
    v_mfma_f32_32x32x16_bf16 v[160:175], v[44:47], v[32:35], v[160:175]
    ds_read_b64_tr_b16 v[76:77], v28 offset:10816
    ds_read_b64_tr_b16 v[78:79], v28 offset:11712
    s_waitcnt lgkmcnt(13)
    v_mfma_f32_32x32x16_bf16 v[176:191], v[48:51], v[32:35], v[176:191]
    ds_read_b64_tr_b16 v[80:81], v28 offset:10848
    ds_read_b64_tr_b16 v[82:83], v28 offset:11744
    s_waitcnt lgkmcnt(13)
    v_mfma_f32_32x32x16_bf16 v[192:207], v[52:55], v[32:35], v[192:207]
    ds_read_b64_tr_b16 v[84:85], v28 offset:10880
    ds_read_b64_tr_b16 v[86:87], v28 offset:11776
    s_waitcnt lgkmcnt(13)
    v_mfma_f32_32x32x16_bf16 v[208:223], v[56:59], v[32:35], v[208:223]
    ds_read_b64_tr_b16 v[88:89], v28 offset:10912
    ds_read_b64_tr_b16 v[90:91], v28 offset:11808
    s_waitcnt lgkmcnt(13)
    v_mfma_f32_32x32x16_bf16 v[224:239], v[60:63], v[32:35], v[224:239]
    ds_read_b64_tr_b16 v[92:93], v28 offset:10944
    ds_read_b64_tr_b16 v[94:95], v28 offset:11840
    s_waitcnt lgkmcnt(12)
    v_mfma_f32_32x32x16_bf16 v[128:143], v[68:71], v[64:67], v[128:143]
    s_waitcnt lgkmcnt(10)
    v_mfma_f32_32x32x16_bf16 v[144:159], v[72:75], v[64:67], v[144:159]
    s_waitcnt lgkmcnt(0)
    s_barrier
    ds_read_b128 v[32:35], v24 offset:49152
    ds_read_b64_tr_b16 v[36:37], v28 offset:28928
    ds_read_b64_tr_b16 v[38:39], v28 offset:29824
    v_mfma_f32_32x32x16_bf16 v[160:175], v[76:79], v[64:67], v[160:175]
    ds_read_b64_tr_b16 v[40:41], v28 offset:28960
    ds_read_b64_tr_b16 v[42:43], v28 offset:29856
    ds_read_b64_tr_b16 v[44:45], v28 offset:28992
    v_mfma_f32_32x32x16_bf16 v[176:191], v[80:83], v[64:67], v[176:191]
    ds_read_b64_tr_b16 v[46:47], v28 offset:29888
    ds_read_b64_tr_b16 v[48:49], v28 offset:29024
    ds_read_b64_tr_b16 v[50:51], v28 offset:29920
    v_mfma_f32_32x32x16_bf16 v[192:207], v[84:87], v[64:67], v[192:207]
    ds_read_b64_tr_b16 v[52:53], v28 offset:29056
    ds_read_b64_tr_b16 v[54:55], v28 offset:29952
    v_mfma_f32_32x32x16_bf16 v[208:223], v[88:91], v[64:67], v[208:223]
    ds_read_b64_tr_b16 v[56:57], v28 offset:29088
    ds_read_b64_tr_b16 v[58:59], v28 offset:29984
    v_mfma_f32_32x32x16_bf16 v[224:239], v[92:95], v[64:67], v[224:239]
    ds_read_b64_tr_b16 v[60:61], v28 offset:29120
    ds_read_b64_tr_b16 v[62:63], v28 offset:30016
    s_waitcnt lgkmcnt(12)
    v_mfma_f32_32x32x16_bf16 v[128:143], v[36:39], v[32:35], v[128:143]
    ds_read_b128 v[64:67], v25 offset:49152
    ds_read_b64_tr_b16 v[68:69], v28 offset:32512
    ds_read_b64_tr_b16 v[70:71], v28 offset:33408
    s_waitcnt lgkmcnt(13)
    v_mfma_f32_32x32x16_bf16 v[144:159], v[40:43], v[32:35], v[144:159]
    ds_read_b64_tr_b16 v[72:73], v28 offset:32544
    ds_read_b64_tr_b16 v[74:75], v28 offset:33440
    s_waitcnt lgkmcnt(13)
    v_mfma_f32_32x32x16_bf16 v[160:175], v[44:47], v[32:35], v[160:175]
    ds_read_b64_tr_b16 v[76:77], v28 offset:32576
    ds_read_b64_tr_b16 v[78:79], v28 offset:33472
    s_waitcnt lgkmcnt(13)
    v_mfma_f32_32x32x16_bf16 v[176:191], v[48:51], v[32:35], v[176:191]
    ds_read_b64_tr_b16 v[80:81], v28 offset:32608
    ds_read_b64_tr_b16 v[82:83], v28 offset:33504
    s_waitcnt lgkmcnt(13)
    v_mfma_f32_32x32x16_bf16 v[192:207], v[52:55], v[32:35], v[192:207]
    ds_read_b64_tr_b16 v[84:85], v28 offset:32640
    ds_read_b64_tr_b16 v[86:87], v28 offset:33536
    s_waitcnt lgkmcnt(13)
    v_mfma_f32_32x32x16_bf16 v[208:223], v[56:59], v[32:35], v[208:223]
    ds_read_b64_tr_b16 v[88:89], v28 offset:32672
    ds_read_b64_tr_b16 v[90:91], v28 offset:33568
    s_waitcnt lgkmcnt(13)
    v_mfma_f32_32x32x16_bf16 v[224:239], v[60:63], v[32:35], v[224:239]
    ds_read_b64_tr_b16 v[92:93], v28 offset:32704
    ds_read_b64_tr_b16 v[94:95], v28 offset:33600
    s_waitcnt lgkmcnt(12)
    v_mfma_f32_32x32x16_bf16 v[128:143], v[68:71], v[64:67], v[128:143]
    ds_read_b128 v[32:35], v26 offset:49152
    ds_read_b64_tr_b16 v[36:37], v28 offset:36096
    ds_read_b64_tr_b16 v[38:39], v28 offset:36992
    s_waitcnt lgkmcnt(13)
    v_mfma_f32_32x32x16_bf16 v[144:159], v[72:75], v[64:67], v[144:159]
    ds_read_b64_tr_b16 v[40:41], v28 offset:36128
    ds_read_b64_tr_b16 v[42:43], v28 offset:37024
    s_waitcnt lgkmcnt(13)
    v_mfma_f32_32x32x16_bf16 v[160:175], v[76:79], v[64:67], v[160:175]
    ds_read_b64_tr_b16 v[44:45], v28 offset:36160
    ds_read_b64_tr_b16 v[46:47], v28 offset:37056
    s_waitcnt lgkmcnt(13)
    v_mfma_f32_32x32x16_bf16 v[176:191], v[80:83], v[64:67], v[176:191]
    ds_read_b64_tr_b16 v[48:49], v28 offset:36192
    ds_read_b64_tr_b16 v[50:51], v28 offset:37088
    s_waitcnt lgkmcnt(13)
    v_mfma_f32_32x32x16_bf16 v[192:207], v[84:87], v[64:67], v[192:207]
    ds_read_b64_tr_b16 v[52:53], v28 offset:36224
    ds_read_b64_tr_b16 v[54:55], v28 offset:37120
    s_waitcnt lgkmcnt(13)
    v_mfma_f32_32x32x16_bf16 v[208:223], v[88:91], v[64:67], v[208:223]
    ds_read_b64_tr_b16 v[56:57], v28 offset:36256
    ds_read_b64_tr_b16 v[58:59], v28 offset:37152
    s_waitcnt lgkmcnt(13)
    v_mfma_f32_32x32x16_bf16 v[224:239], v[92:95], v[64:67], v[224:239]
    ds_read_b64_tr_b16 v[60:61], v28 offset:36288
    ds_read_b64_tr_b16 v[62:63], v28 offset:37184
    s_waitcnt lgkmcnt(12)
    v_mfma_f32_32x32x16_bf16 v[128:143], v[36:39], v[32:35], v[128:143]
    ds_read_b128 v[64:67], v27 offset:49152
    ds_read_b64_tr_b16 v[68:69], v28 offset:39680
    ds_read_b64_tr_b16 v[70:71], v28 offset:40576
    s_waitcnt lgkmcnt(13)
    v_mfma_f32_32x32x16_bf16 v[144:159], v[40:43], v[32:35], v[144:159]
    ds_read_b64_tr_b16 v[72:73], v28 offset:39712
    ds_read_b64_tr_b16 v[74:75], v28 offset:40608
    s_waitcnt lgkmcnt(13)
    v_mfma_f32_32x32x16_bf16 v[160:175], v[44:47], v[32:35], v[160:175]
    ds_read_b64_tr_b16 v[76:77], v28 offset:39744
    ds_read_b64_tr_b16 v[78:79], v28 offset:40640
    s_waitcnt lgkmcnt(13)
    v_mfma_f32_32x32x16_bf16 v[176:191], v[48:51], v[32:35], v[176:191]
    ds_read_b64_tr_b16 v[80:81], v28 offset:39776
    ds_read_b64_tr_b16 v[82:83], v28 offset:40672
    s_waitcnt lgkmcnt(13)
    v_mfma_f32_32x32x16_bf16 v[192:207], v[52:55], v[32:35], v[192:207]
    ds_read_b64_tr_b16 v[84:85], v28 offset:39808
    ds_read_b64_tr_b16 v[86:87], v28 offset:40704
    s_waitcnt lgkmcnt(13)
    v_mfma_f32_32x32x16_bf16 v[208:223], v[56:59], v[32:35], v[208:223]
    ds_read_b64_tr_b16 v[88:89], v28 offset:39840
    ds_read_b64_tr_b16 v[90:91], v28 offset:40736
    s_waitcnt lgkmcnt(13)
    v_mfma_f32_32x32x16_bf16 v[224:239], v[60:63], v[32:35], v[224:239]
    ds_read_b64_tr_b16 v[92:93], v28 offset:39872
    ds_read_b64_tr_b16 v[94:95], v28 offset:40768
    s_waitcnt lgkmcnt(12)
    v_mfma_f32_32x32x16_bf16 v[128:143], v[68:71], v[64:67], v[128:143]
    s_waitcnt lgkmcnt(10)
    v_mfma_f32_32x32x16_bf16 v[144:159], v[72:75], v[64:67], v[144:159]
    s_waitcnt lgkmcnt(0)
    s_barrier
    ds_read_b128 v[32:35], v24 offset:0
    ds_read_b64_tr_b16 v[36:37], v108 offset:0
    ds_read_b64_tr_b16 v[38:39], v108 offset:896
    v_mfma_f32_32x32x16_bf16 v[160:175], v[76:79], v[64:67], v[160:175]
    ds_read_b64_tr_b16 v[40:41], v108 offset:32
    ds_read_b64_tr_b16 v[42:43], v108 offset:928
    ds_read_b64_tr_b16 v[44:45], v108 offset:64
    v_mfma_f32_32x32x16_bf16 v[176:191], v[80:83], v[64:67], v[176:191]
    ds_read_b64_tr_b16 v[46:47], v108 offset:960
    ds_read_b64_tr_b16 v[48:49], v108 offset:96
    ds_read_b64_tr_b16 v[50:51], v108 offset:992
    v_mfma_f32_32x32x16_bf16 v[192:207], v[84:87], v[64:67], v[192:207]
    ds_read_b64_tr_b16 v[52:53], v108 offset:128
    ds_read_b64_tr_b16 v[54:55], v108 offset:1024
    v_mfma_f32_32x32x16_bf16 v[208:223], v[88:91], v[64:67], v[208:223]
    ds_read_b64_tr_b16 v[56:57], v108 offset:160
    ds_read_b64_tr_b16 v[58:59], v108 offset:1056
    v_mfma_f32_32x32x16_bf16 v[224:239], v[92:95], v[64:67], v[224:239]
    ds_read_b64_tr_b16 v[60:61], v108 offset:192
    ds_read_b64_tr_b16 v[62:63], v108 offset:1088
    s_waitcnt lgkmcnt(12)
    v_mfma_f32_32x32x16_bf16 v[128:143], v[36:39], v[32:35], v[128:143]
    ds_read_b128 v[64:67], v25 offset:0
    ds_read_b64_tr_b16 v[68:69], v108 offset:3584
    ds_read_b64_tr_b16 v[70:71], v108 offset:4480
    s_waitcnt lgkmcnt(13)
    v_mfma_f32_32x32x16_bf16 v[144:159], v[40:43], v[32:35], v[144:159]
    ds_read_b64_tr_b16 v[72:73], v108 offset:3616
    ds_read_b64_tr_b16 v[74:75], v108 offset:4512
    s_waitcnt lgkmcnt(13)
    v_mfma_f32_32x32x16_bf16 v[160:175], v[44:47], v[32:35], v[160:175]
    ds_read_b64_tr_b16 v[76:77], v108 offset:3648
    ds_read_b64_tr_b16 v[78:79], v108 offset:4544
    s_waitcnt lgkmcnt(13)
    v_mfma_f32_32x32x16_bf16 v[176:191], v[48:51], v[32:35], v[176:191]
    ds_read_b64_tr_b16 v[80:81], v108 offset:3680
    ds_read_b64_tr_b16 v[82:83], v108 offset:4576
    s_waitcnt lgkmcnt(13)
    v_mfma_f32_32x32x16_bf16 v[192:207], v[52:55], v[32:35], v[192:207]
    ds_read_b64_tr_b16 v[84:85], v108 offset:3712
    ds_read_b64_tr_b16 v[86:87], v108 offset:4608
    s_waitcnt lgkmcnt(13)
    v_mfma_f32_32x32x16_bf16 v[208:223], v[56:59], v[32:35], v[208:223]
    ds_read_b64_tr_b16 v[88:89], v108 offset:3744
    ds_read_b64_tr_b16 v[90:91], v108 offset:4640
    s_waitcnt lgkmcnt(13)
    v_mfma_f32_32x32x16_bf16 v[224:239], v[60:63], v[32:35], v[224:239]
    ds_read_b64_tr_b16 v[92:93], v108 offset:3776
    ds_read_b64_tr_b16 v[94:95], v108 offset:4672
    s_waitcnt lgkmcnt(12)
    v_mfma_f32_32x32x16_bf16 v[128:143], v[68:71], v[64:67], v[128:143]
    ds_read_b128 v[32:35], v26 offset:0
    ds_read_b64_tr_b16 v[36:37], v108 offset:7168
    ds_read_b64_tr_b16 v[38:39], v108 offset:8064
    s_waitcnt lgkmcnt(13)
    v_mfma_f32_32x32x16_bf16 v[144:159], v[72:75], v[64:67], v[144:159]
    ds_read_b64_tr_b16 v[40:41], v108 offset:7200
    ds_read_b64_tr_b16 v[42:43], v108 offset:8096
    s_waitcnt lgkmcnt(13)
    v_mfma_f32_32x32x16_bf16 v[160:175], v[76:79], v[64:67], v[160:175]
    ds_read_b64_tr_b16 v[44:45], v108 offset:7232
    ds_read_b64_tr_b16 v[46:47], v108 offset:8128
    s_waitcnt lgkmcnt(13)
    v_mfma_f32_32x32x16_bf16 v[176:191], v[80:83], v[64:67], v[176:191]
    ds_read_b64_tr_b16 v[48:49], v108 offset:7264
    ds_read_b64_tr_b16 v[50:51], v108 offset:8160
    s_waitcnt lgkmcnt(13)
    v_mfma_f32_32x32x16_bf16 v[192:207], v[84:87], v[64:67], v[192:207]
    ds_read_b64_tr_b16 v[52:53], v108 offset:7296
    ds_read_b64_tr_b16 v[54:55], v108 offset:8192
    s_waitcnt lgkmcnt(13)
    v_mfma_f32_32x32x16_bf16 v[208:223], v[88:91], v[64:67], v[208:223]
    ds_read_b64_tr_b16 v[56:57], v108 offset:7328
    ds_read_b64_tr_b16 v[58:59], v108 offset:8224
    s_waitcnt lgkmcnt(13)
    v_mfma_f32_32x32x16_bf16 v[224:239], v[92:95], v[64:67], v[224:239]
    ds_read_b64_tr_b16 v[60:61], v108 offset:7360
    ds_read_b64_tr_b16 v[62:63], v108 offset:8256
    s_waitcnt lgkmcnt(12)
    v_mfma_f32_32x32x16_bf16 v[128:143], v[36:39], v[32:35], v[128:143]
    ds_read_b128 v[64:67], v27 offset:0
    ds_read_b64_tr_b16 v[68:69], v108 offset:10752
    ds_read_b64_tr_b16 v[70:71], v108 offset:11648
    s_waitcnt lgkmcnt(13)
    v_mfma_f32_32x32x16_bf16 v[144:159], v[40:43], v[32:35], v[144:159]
    ds_read_b64_tr_b16 v[72:73], v108 offset:10784
    ds_read_b64_tr_b16 v[74:75], v108 offset:11680
    s_waitcnt lgkmcnt(13)
    v_mfma_f32_32x32x16_bf16 v[160:175], v[44:47], v[32:35], v[160:175]
    ds_read_b64_tr_b16 v[76:77], v108 offset:10816
    ds_read_b64_tr_b16 v[78:79], v108 offset:11712
    s_waitcnt lgkmcnt(13)
    v_mfma_f32_32x32x16_bf16 v[176:191], v[48:51], v[32:35], v[176:191]
    ds_read_b64_tr_b16 v[80:81], v108 offset:10848
    ds_read_b64_tr_b16 v[82:83], v108 offset:11744
    s_waitcnt lgkmcnt(13)
    v_mfma_f32_32x32x16_bf16 v[192:207], v[52:55], v[32:35], v[192:207]
    ds_read_b64_tr_b16 v[84:85], v108 offset:10880
    ds_read_b64_tr_b16 v[86:87], v108 offset:11776
    s_waitcnt lgkmcnt(13)
    v_mfma_f32_32x32x16_bf16 v[208:223], v[56:59], v[32:35], v[208:223]
    ds_read_b64_tr_b16 v[88:89], v108 offset:10912
    ds_read_b64_tr_b16 v[90:91], v108 offset:11808
    s_waitcnt lgkmcnt(13)
    v_mfma_f32_32x32x16_bf16 v[224:239], v[60:63], v[32:35], v[224:239]
    ds_read_b64_tr_b16 v[92:93], v108 offset:10944
    ds_read_b64_tr_b16 v[94:95], v108 offset:11840
    s_waitcnt lgkmcnt(12)
    v_mfma_f32_32x32x16_bf16 v[128:143], v[68:71], v[64:67], v[128:143]
    s_waitcnt lgkmcnt(10)
    v_mfma_f32_32x32x16_bf16 v[144:159], v[72:75], v[64:67], v[144:159]
    s_waitcnt lgkmcnt(0)
    s_barrier
    ds_read_b128 v[32:35], v24 offset:16384
    ds_read_b64_tr_b16 v[36:37], v28 offset:0
    ds_read_b64_tr_b16 v[38:39], v28 offset:896
    v_mfma_f32_32x32x16_bf16 v[160:175], v[76:79], v[64:67], v[160:175]
    ds_read_b64_tr_b16 v[40:41], v28 offset:32
    ds_read_b64_tr_b16 v[42:43], v28 offset:928
    ds_read_b64_tr_b16 v[44:45], v28 offset:64
    v_mfma_f32_32x32x16_bf16 v[176:191], v[80:83], v[64:67], v[176:191]
    ds_read_b64_tr_b16 v[46:47], v28 offset:960
    ds_read_b64_tr_b16 v[48:49], v28 offset:96
    ds_read_b64_tr_b16 v[50:51], v28 offset:992
    v_mfma_f32_32x32x16_bf16 v[192:207], v[84:87], v[64:67], v[192:207]
    ds_read_b64_tr_b16 v[52:53], v28 offset:128
    ds_read_b64_tr_b16 v[54:55], v28 offset:1024
    v_mfma_f32_32x32x16_bf16 v[208:223], v[88:91], v[64:67], v[208:223]
    ds_read_b64_tr_b16 v[56:57], v28 offset:160
    ds_read_b64_tr_b16 v[58:59], v28 offset:1056
    v_mfma_f32_32x32x16_bf16 v[224:239], v[92:95], v[64:67], v[224:239]
    ds_read_b64_tr_b16 v[60:61], v28 offset:192
    ds_read_b64_tr_b16 v[62:63], v28 offset:1088
    s_waitcnt lgkmcnt(12)
    v_mfma_f32_32x32x16_bf16 v[128:143], v[36:39], v[32:35], v[128:143]
    ds_read_b128 v[64:67], v25 offset:16384
    ds_read_b64_tr_b16 v[68:69], v28 offset:3584
    ds_read_b64_tr_b16 v[70:71], v28 offset:4480
    s_waitcnt lgkmcnt(13)
    v_mfma_f32_32x32x16_bf16 v[144:159], v[40:43], v[32:35], v[144:159]
    ds_read_b64_tr_b16 v[72:73], v28 offset:3616
    ds_read_b64_tr_b16 v[74:75], v28 offset:4512
    s_waitcnt lgkmcnt(13)
    v_mfma_f32_32x32x16_bf16 v[160:175], v[44:47], v[32:35], v[160:175]
    ds_read_b64_tr_b16 v[76:77], v28 offset:3648
    ds_read_b64_tr_b16 v[78:79], v28 offset:4544
    s_waitcnt lgkmcnt(13)
    v_mfma_f32_32x32x16_bf16 v[176:191], v[48:51], v[32:35], v[176:191]
    ds_read_b64_tr_b16 v[80:81], v28 offset:3680
    ds_read_b64_tr_b16 v[82:83], v28 offset:4576
    s_waitcnt lgkmcnt(13)
    v_mfma_f32_32x32x16_bf16 v[192:207], v[52:55], v[32:35], v[192:207]
    ds_read_b64_tr_b16 v[84:85], v28 offset:3712
    ds_read_b64_tr_b16 v[86:87], v28 offset:4608
    s_waitcnt lgkmcnt(13)
    v_mfma_f32_32x32x16_bf16 v[208:223], v[56:59], v[32:35], v[208:223]
    ds_read_b64_tr_b16 v[88:89], v28 offset:3744
    ds_read_b64_tr_b16 v[90:91], v28 offset:4640
    s_waitcnt lgkmcnt(13)
    v_mfma_f32_32x32x16_bf16 v[224:239], v[60:63], v[32:35], v[224:239]
    ds_read_b64_tr_b16 v[92:93], v28 offset:3776
    ds_read_b64_tr_b16 v[94:95], v28 offset:4672
    s_waitcnt lgkmcnt(12)
    v_mfma_f32_32x32x16_bf16 v[128:143], v[68:71], v[64:67], v[128:143]
    ds_read_b128 v[32:35], v26 offset:16384
    ds_read_b64_tr_b16 v[36:37], v28 offset:7168
    ds_read_b64_tr_b16 v[38:39], v28 offset:8064
    s_waitcnt lgkmcnt(13)
    v_mfma_f32_32x32x16_bf16 v[144:159], v[72:75], v[64:67], v[144:159]
    ds_read_b64_tr_b16 v[40:41], v28 offset:7200
    ds_read_b64_tr_b16 v[42:43], v28 offset:8096
    s_waitcnt lgkmcnt(13)
    v_mfma_f32_32x32x16_bf16 v[160:175], v[76:79], v[64:67], v[160:175]
    ds_read_b64_tr_b16 v[44:45], v28 offset:7232
    ds_read_b64_tr_b16 v[46:47], v28 offset:8128
    s_waitcnt lgkmcnt(13)
    v_mfma_f32_32x32x16_bf16 v[176:191], v[80:83], v[64:67], v[176:191]
    ds_read_b64_tr_b16 v[48:49], v28 offset:7264
    ds_read_b64_tr_b16 v[50:51], v28 offset:8160
    s_waitcnt lgkmcnt(13)
    v_mfma_f32_32x32x16_bf16 v[192:207], v[84:87], v[64:67], v[192:207]
    ds_read_b64_tr_b16 v[52:53], v28 offset:7296
    ds_read_b64_tr_b16 v[54:55], v28 offset:8192
    s_waitcnt lgkmcnt(13)
    v_mfma_f32_32x32x16_bf16 v[208:223], v[88:91], v[64:67], v[208:223]
    ds_read_b64_tr_b16 v[56:57], v28 offset:7328
    ds_read_b64_tr_b16 v[58:59], v28 offset:8224
    s_waitcnt lgkmcnt(13)
    v_mfma_f32_32x32x16_bf16 v[224:239], v[92:95], v[64:67], v[224:239]
    ds_read_b64_tr_b16 v[60:61], v28 offset:7360
    ds_read_b64_tr_b16 v[62:63], v28 offset:8256
    s_waitcnt lgkmcnt(12)
    v_mfma_f32_32x32x16_bf16 v[128:143], v[36:39], v[32:35], v[128:143]
    ds_read_b128 v[64:67], v27 offset:16384
    ds_read_b64_tr_b16 v[68:69], v28 offset:10752
    ds_read_b64_tr_b16 v[70:71], v28 offset:11648
    s_waitcnt lgkmcnt(13)
    v_mfma_f32_32x32x16_bf16 v[144:159], v[40:43], v[32:35], v[144:159]
    ds_read_b64_tr_b16 v[72:73], v28 offset:10784
    ds_read_b64_tr_b16 v[74:75], v28 offset:11680
    s_waitcnt lgkmcnt(13)
    v_mfma_f32_32x32x16_bf16 v[160:175], v[44:47], v[32:35], v[160:175]
    ds_read_b64_tr_b16 v[76:77], v28 offset:10816
    ds_read_b64_tr_b16 v[78:79], v28 offset:11712
    s_waitcnt lgkmcnt(13)
    v_mfma_f32_32x32x16_bf16 v[176:191], v[48:51], v[32:35], v[176:191]
    ds_read_b64_tr_b16 v[80:81], v28 offset:10848
    ds_read_b64_tr_b16 v[82:83], v28 offset:11744
    s_waitcnt lgkmcnt(13)
    v_mfma_f32_32x32x16_bf16 v[192:207], v[52:55], v[32:35], v[192:207]
    ds_read_b64_tr_b16 v[84:85], v28 offset:10880
    ds_read_b64_tr_b16 v[86:87], v28 offset:11776
    s_waitcnt lgkmcnt(13)
    v_mfma_f32_32x32x16_bf16 v[208:223], v[56:59], v[32:35], v[208:223]
    ds_read_b64_tr_b16 v[88:89], v28 offset:10912
    ds_read_b64_tr_b16 v[90:91], v28 offset:11808
    s_waitcnt lgkmcnt(13)
    v_mfma_f32_32x32x16_bf16 v[224:239], v[60:63], v[32:35], v[224:239]
    ds_read_b64_tr_b16 v[92:93], v28 offset:10944
    ds_read_b64_tr_b16 v[94:95], v28 offset:11840
    s_waitcnt lgkmcnt(12)
    v_mfma_f32_32x32x16_bf16 v[128:143], v[68:71], v[64:67], v[128:143]
    s_waitcnt lgkmcnt(10)
    v_mfma_f32_32x32x16_bf16 v[144:159], v[72:75], v[64:67], v[144:159]
    s_waitcnt lgkmcnt(0)
    s_barrier
    v_mfma_f32_32x32x16_bf16 v[160:175], v[76:79], v[64:67], v[160:175]
    v_mfma_f32_32x32x16_bf16 v[176:191], v[80:83], v[64:67], v[176:191]
    v_mfma_f32_32x32x16_bf16 v[192:207], v[84:87], v[64:67], v[192:207]
    v_mfma_f32_32x32x16_bf16 v[208:223], v[88:91], v[64:67], v[208:223]
    v_mfma_f32_32x32x16_bf16 v[224:239], v[92:95], v[64:67], v[224:239]
    v_lshlrev_b32 v29, 5, v101
    v_add_u32 v29, 0x27400, v29
    ds_read_b128 v[32:35], v29 offset:0
    ds_read_b128 v[36:39], v29 offset:16
    ds_read_b128 v[40:43], v29 offset:512
    ds_read_b128 v[44:47], v29 offset:528
    v_lshlrev_b32 v28, 11, v101
    v_lshl_add_u32 v28, v102, 4, v28
    s_mul_i32 s52, s44, 442368
    s_mul_i32 s53, s45, 28672
    s_add_u32 s52, s52, 0xf00000
    s_add_u32 s52, s52, s53
    s_add_u32 s52, s52, s49
    s_waitcnt vmcnt(0)
    v_pk_add_f32 v[112:113], v[112:113], v[114:115]
    v_pk_add_f32 v[116:117], v[116:117], v[118:119]
    v_pk_add_f32 v[112:113], v[112:113], v[116:117]
    v_mov_b32 v114, v112
    v_mov_b32 v115, v113
    s_nop 1
    v_permlane32_swap_b32 v112, v114
    v_permlane32_swap_b32 v113, v115
    s_nop 1
    v_pk_add_f32 v[112:113], v[112:113], v[114:115]
    v_mul_f32 v96, 0xbacccccd, v112
    v_mul_f32 v97, 0x3acccccd, v113
    v_fma_f32 v97, -v96, v96, v97
    v_max_f32 v97, 0, v97
    v_add_f32 v97, 0x3727c5ac, v97
    v_mov_b32 v30, v97
    v_mov_b32 v31, v97
    v_rsq_f32 v97, v97
    v_mov_b32 v24, v96
    v_mov_b32 v25, v96
    v_mul_f32 v26, 0xbfb8aa3b, v97
    v_mov_b32 v27, v26
    s_nop 4
    ds_read_b128 v[48:51], v29 offset:64
    ds_read_b128 v[52:55], v29 offset:80
    ds_read_b128 v[56:59], v29 offset:576
    ds_read_b128 v[60:63], v29 offset:592
    s_waitcnt lgkmcnt(4)
    v_pk_fma_f32 v[128:129], v[24:25], v[32:33], v[128:129]
    v_pk_fma_f32 v[130:131], v[24:25], v[34:35], v[130:131]
    v_pk_fma_f32 v[132:133], v[24:25], v[36:37], v[132:133]
    v_pk_fma_f32 v[134:135], v[24:25], v[38:39], v[134:135]
    v_pk_fma_f32 v[136:137], v[24:25], v[40:41], v[136:137]
    v_pk_fma_f32 v[138:139], v[24:25], v[42:43], v[138:139]
    v_pk_fma_f32 v[140:141], v[24:25], v[44:45], v[140:141]
    v_pk_fma_f32 v[142:143], v[24:25], v[46:47], v[142:143]
    v_pk_mul_f32 v[80:81], v[128:129], v[26:27]
    v_pk_mul_f32 v[82:83], v[130:131], v[26:27]
    v_pk_mul_f32 v[84:85], v[132:133], v[26:27]
    v_pk_mul_f32 v[86:87], v[134:135], v[26:27]
    v_exp_f32 v80, v80
    v_exp_f32 v81, v81
    v_exp_f32 v82, v82
    v_exp_f32 v83, v83
    v_exp_f32 v84, v84
    v_exp_f32 v85, v85
    v_exp_f32 v86, v86
    v_exp_f32 v87, v87
    v_pk_mul_f32 v[128:129], v[128:129], v[136:137]
    v_pk_mul_f32 v[130:131], v[130:131], v[138:139]
    v_pk_mul_f32 v[132:133], v[132:133], v[140:141]
    v_pk_mul_f32 v[134:135], v[134:135], v[142:143]
    v_pk_fma_f32 v[80:81], v[80:81], v[30:31], v[30:31]
    v_pk_fma_f32 v[82:83], v[82:83], v[30:31], v[30:31]
    v_pk_fma_f32 v[84:85], v[84:85], v[30:31], v[30:31]
    v_pk_fma_f32 v[86:87], v[86:87], v[30:31], v[30:31]
    v_rcp_f32 v80, v80
    v_rcp_f32 v81, v81
    v_rcp_f32 v82, v82
    v_rcp_f32 v83, v83
    v_rcp_f32 v84, v84
    v_rcp_f32 v85, v85
    v_rcp_f32 v86, v86
    v_rcp_f32 v87, v87
    v_pk_mul_f32 v[128:129], v[128:129], v[80:81]
    v_pk_mul_f32 v[130:131], v[130:131], v[82:83]
    v_pk_mul_f32 v[132:133], v[132:133], v[84:85]
    v_pk_mul_f32 v[134:135], v[134:135], v[86:87]
    v_cvt_pk_bf16_f32 v64, v128, v129
    v_cvt_pk_bf16_f32 v65, v130, v131
    v_cvt_pk_bf16_f32 v66, v132, v133
    v_cvt_pk_bf16_f32 v67, v134, v135
    buffer_store_dwordx4 v[64:67], v28, s[4:7], s52 offen sc1
    s_add_u32 s52, s52, 4096
    ds_read_b128 v[32:35], v29 offset:128
    ds_read_b128 v[36:39], v29 offset:144
    ds_read_b128 v[40:43], v29 offset:640
    ds_read_b128 v[44:47], v29 offset:656
    s_waitcnt lgkmcnt(4)
    v_pk_fma_f32 v[144:145], v[24:25], v[48:49], v[144:145]
    v_pk_fma_f32 v[146:147], v[24:25], v[50:51], v[146:147]
    v_pk_fma_f32 v[148:149], v[24:25], v[52:53], v[148:149]
    v_pk_fma_f32 v[150:151], v[24:25], v[54:55], v[150:151]
    v_pk_fma_f32 v[152:153], v[24:25], v[56:57], v[152:153]
    v_pk_fma_f32 v[154:155], v[24:25], v[58:59], v[154:155]
    v_pk_fma_f32 v[156:157], v[24:25], v[60:61], v[156:157]
    v_pk_fma_f32 v[158:159], v[24:25], v[62:63], v[158:159]
    v_pk_mul_f32 v[80:81], v[144:145], v[26:27]
    v_pk_mul_f32 v[82:83], v[146:147], v[26:27]
    v_pk_mul_f32 v[84:85], v[148:149], v[26:27]
    v_pk_mul_f32 v[86:87], v[150:151], v[26:27]
    v_exp_f32 v80, v80
    v_exp_f32 v81, v81
    v_exp_f32 v82, v82
    v_exp_f32 v83, v83
    v_exp_f32 v84, v84
    v_exp_f32 v85, v85
    v_exp_f32 v86, v86
    v_exp_f32 v87, v87
    v_pk_mul_f32 v[144:145], v[144:145], v[152:153]
    v_pk_mul_f32 v[146:147], v[146:147], v[154:155]
    v_pk_mul_f32 v[148:149], v[148:149], v[156:157]
    v_pk_mul_f32 v[150:151], v[150:151], v[158:159]
    v_pk_fma_f32 v[80:81], v[80:81], v[30:31], v[30:31]
    v_pk_fma_f32 v[82:83], v[82:83], v[30:31], v[30:31]
    v_pk_fma_f32 v[84:85], v[84:85], v[30:31], v[30:31]
    v_pk_fma_f32 v[86:87], v[86:87], v[30:31], v[30:31]
    v_rcp_f32 v80, v80
    v_rcp_f32 v81, v81
    v_rcp_f32 v82, v82
    v_rcp_f32 v83, v83
    v_rcp_f32 v84, v84
    v_rcp_f32 v85, v85
    v_rcp_f32 v86, v86
    v_rcp_f32 v87, v87
    v_pk_mul_f32 v[144:145], v[144:145], v[80:81]
    v_pk_mul_f32 v[146:147], v[146:147], v[82:83]
    v_pk_mul_f32 v[148:149], v[148:149], v[84:85]
    v_pk_mul_f32 v[150:151], v[150:151], v[86:87]
    v_cvt_pk_bf16_f32 v72, v144, v145
    v_cvt_pk_bf16_f32 v73, v146, v147
    v_cvt_pk_bf16_f32 v74, v148, v149
    v_cvt_pk_bf16_f32 v75, v150, v151
    buffer_store_dwordx4 v[72:75], v28, s[4:7], s52 offen sc1
    s_add_u32 s52, s52, 4096
    ds_read_b128 v[48:51], v29 offset:192
    ds_read_b128 v[52:55], v29 offset:208
    ds_read_b128 v[56:59], v29 offset:704
    ds_read_b128 v[60:63], v29 offset:720
    s_waitcnt lgkmcnt(4)
    v_pk_fma_f32 v[160:161], v[24:25], v[32:33], v[160:161]
    v_pk_fma_f32 v[162:163], v[24:25], v[34:35], v[162:163]
    v_pk_fma_f32 v[164:165], v[24:25], v[36:37], v[164:165]
    v_pk_fma_f32 v[166:167], v[24:25], v[38:39], v[166:167]
    v_pk_fma_f32 v[168:169], v[24:25], v[40:41], v[168:169]
    v_pk_fma_f32 v[170:171], v[24:25], v[42:43], v[170:171]
    v_pk_fma_f32 v[172:173], v[24:25], v[44:45], v[172:173]
    v_pk_fma_f32 v[174:175], v[24:25], v[46:47], v[174:175]
    v_pk_mul_f32 v[80:81], v[160:161], v[26:27]
    v_pk_mul_f32 v[82:83], v[162:163], v[26:27]
    v_pk_mul_f32 v[84:85], v[164:165], v[26:27]
    v_pk_mul_f32 v[86:87], v[166:167], v[26:27]
    v_exp_f32 v80, v80
    v_exp_f32 v81, v81
    v_exp_f32 v82, v82
    v_exp_f32 v83, v83
    v_exp_f32 v84, v84
    v_exp_f32 v85, v85
    v_exp_f32 v86, v86
    v_exp_f32 v87, v87
    v_pk_mul_f32 v[160:161], v[160:161], v[168:169]
    v_pk_mul_f32 v[162:163], v[162:163], v[170:171]
    v_pk_mul_f32 v[164:165], v[164:165], v[172:173]
    v_pk_mul_f32 v[166:167], v[166:167], v[174:175]
    v_pk_fma_f32 v[80:81], v[80:81], v[30:31], v[30:31]
    v_pk_fma_f32 v[82:83], v[82:83], v[30:31], v[30:31]
    v_pk_fma_f32 v[84:85], v[84:85], v[30:31], v[30:31]
    v_pk_fma_f32 v[86:87], v[86:87], v[30:31], v[30:31]
    v_rcp_f32 v80, v80
    v_rcp_f32 v81, v81
    v_rcp_f32 v82, v82
    v_rcp_f32 v83, v83
    v_rcp_f32 v84, v84
    v_rcp_f32 v85, v85
    v_rcp_f32 v86, v86
    v_rcp_f32 v87, v87
    v_pk_mul_f32 v[160:161], v[160:161], v[80:81]
    v_pk_mul_f32 v[162:163], v[162:163], v[82:83]
    v_pk_mul_f32 v[164:165], v[164:165], v[84:85]
    v_pk_mul_f32 v[166:167], v[166:167], v[86:87]
    v_cvt_pk_bf16_f32 v64, v160, v161
    v_cvt_pk_bf16_f32 v65, v162, v163
    v_cvt_pk_bf16_f32 v66, v164, v165
    v_cvt_pk_bf16_f32 v67, v166, v167
    buffer_store_dwordx4 v[64:67], v28, s[4:7], s52 offen sc1
    s_add_u32 s52, s52, 4096
    s_cmp_eq_u32 s45, 15
    s_cbranch_scc1 .ed20
    ds_read_b128 v[32:35], v29 offset:256
    ds_read_b128 v[36:39], v29 offset:272
    ds_read_b128 v[40:43], v29 offset:768
    ds_read_b128 v[44:47], v29 offset:784
    s_waitcnt lgkmcnt(4)
    v_pk_fma_f32 v[176:177], v[24:25], v[48:49], v[176:177]
    v_pk_fma_f32 v[178:179], v[24:25], v[50:51], v[178:179]
    v_pk_fma_f32 v[180:181], v[24:25], v[52:53], v[180:181]
    v_pk_fma_f32 v[182:183], v[24:25], v[54:55], v[182:183]
    v_pk_fma_f32 v[184:185], v[24:25], v[56:57], v[184:185]
    v_pk_fma_f32 v[186:187], v[24:25], v[58:59], v[186:187]
    v_pk_fma_f32 v[188:189], v[24:25], v[60:61], v[188:189]
    v_pk_fma_f32 v[190:191], v[24:25], v[62:63], v[190:191]
    v_pk_mul_f32 v[80:81], v[176:177], v[26:27]
    v_pk_mul_f32 v[82:83], v[178:179], v[26:27]
    v_pk_mul_f32 v[84:85], v[180:181], v[26:27]
    v_pk_mul_f32 v[86:87], v[182:183], v[26:27]
    v_exp_f32 v80, v80
    v_exp_f32 v81, v81
    v_exp_f32 v82, v82
    v_exp_f32 v83, v83
    v_exp_f32 v84, v84
    v_exp_f32 v85, v85
    v_exp_f32 v86, v86
    v_exp_f32 v87, v87
    v_pk_mul_f32 v[176:177], v[176:177], v[184:185]
    v_pk_mul_f32 v[178:179], v[178:179], v[186:187]
    v_pk_mul_f32 v[180:181], v[180:181], v[188:189]
    v_pk_mul_f32 v[182:183], v[182:183], v[190:191]
    v_pk_fma_f32 v[80:81], v[80:81], v[30:31], v[30:31]
    v_pk_fma_f32 v[82:83], v[82:83], v[30:31], v[30:31]
    v_pk_fma_f32 v[84:85], v[84:85], v[30:31], v[30:31]
    v_pk_fma_f32 v[86:87], v[86:87], v[30:31], v[30:31]
    v_rcp_f32 v80, v80
    v_rcp_f32 v81, v81
    v_rcp_f32 v82, v82
    v_rcp_f32 v83, v83
    v_rcp_f32 v84, v84
    v_rcp_f32 v85, v85
    v_rcp_f32 v86, v86
    v_rcp_f32 v87, v87
    v_pk_mul_f32 v[176:177], v[176:177], v[80:81]
    v_pk_mul_f32 v[178:179], v[178:179], v[82:83]
    v_pk_mul_f32 v[180:181], v[180:181], v[84:85]
    v_pk_mul_f32 v[182:183], v[182:183], v[86:87]
    v_cvt_pk_bf16_f32 v72, v176, v177
    v_cvt_pk_bf16_f32 v73, v178, v179
    v_cvt_pk_bf16_f32 v74, v180, v181
    v_cvt_pk_bf16_f32 v75, v182, v183
    buffer_store_dwordx4 v[72:75], v28, s[4:7], s52 offen sc1
    s_add_u32 s52, s52, 4096
    ds_read_b128 v[48:51], v29 offset:320
    ds_read_b128 v[52:55], v29 offset:336
    ds_read_b128 v[56:59], v29 offset:832
    ds_read_b128 v[60:63], v29 offset:848
    s_waitcnt lgkmcnt(4)
    v_pk_fma_f32 v[192:193], v[24:25], v[32:33], v[192:193]
    v_pk_fma_f32 v[194:195], v[24:25], v[34:35], v[194:195]
    v_pk_fma_f32 v[196:197], v[24:25], v[36:37], v[196:197]
    v_pk_fma_f32 v[198:199], v[24:25], v[38:39], v[198:199]
    v_pk_fma_f32 v[200:201], v[24:25], v[40:41], v[200:201]
    v_pk_fma_f32 v[202:203], v[24:25], v[42:43], v[202:203]
    v_pk_fma_f32 v[204:205], v[24:25], v[44:45], v[204:205]
    v_pk_fma_f32 v[206:207], v[24:25], v[46:47], v[206:207]
    v_pk_mul_f32 v[80:81], v[192:193], v[26:27]
    v_pk_mul_f32 v[82:83], v[194:195], v[26:27]
    v_pk_mul_f32 v[84:85], v[196:197], v[26:27]
    v_pk_mul_f32 v[86:87], v[198:199], v[26:27]
    v_exp_f32 v80, v80
    v_exp_f32 v81, v81
    v_exp_f32 v82, v82
    v_exp_f32 v83, v83
    v_exp_f32 v84, v84
    v_exp_f32 v85, v85
    v_exp_f32 v86, v86
    v_exp_f32 v87, v87
    v_pk_mul_f32 v[192:193], v[192:193], v[200:201]
    v_pk_mul_f32 v[194:195], v[194:195], v[202:203]
    v_pk_mul_f32 v[196:197], v[196:197], v[204:205]
    v_pk_mul_f32 v[198:199], v[198:199], v[206:207]
    v_pk_fma_f32 v[80:81], v[80:81], v[30:31], v[30:31]
    v_pk_fma_f32 v[82:83], v[82:83], v[30:31], v[30:31]
    v_pk_fma_f32 v[84:85], v[84:85], v[30:31], v[30:31]
    v_pk_fma_f32 v[86:87], v[86:87], v[30:31], v[30:31]
    v_rcp_f32 v80, v80
    v_rcp_f32 v81, v81
    v_rcp_f32 v82, v82
    v_rcp_f32 v83, v83
    v_rcp_f32 v84, v84
    v_rcp_f32 v85, v85
    v_rcp_f32 v86, v86
    v_rcp_f32 v87, v87
    v_pk_mul_f32 v[192:193], v[192:193], v[80:81]
    v_pk_mul_f32 v[194:195], v[194:195], v[82:83]
    v_pk_mul_f32 v[196:197], v[196:197], v[84:85]
    v_pk_mul_f32 v[198:199], v[198:199], v[86:87]
    v_cvt_pk_bf16_f32 v64, v192, v193
    v_cvt_pk_bf16_f32 v65, v194, v195
    v_cvt_pk_bf16_f32 v66, v196, v197
    v_cvt_pk_bf16_f32 v67, v198, v199
    buffer_store_dwordx4 v[64:67], v28, s[4:7], s52 offen sc1
    s_add_u32 s52, s52, 4096
    ds_read_b128 v[32:35], v29 offset:384
    ds_read_b128 v[36:39], v29 offset:400
    ds_read_b128 v[40:43], v29 offset:896
    ds_read_b128 v[44:47], v29 offset:912
    s_waitcnt lgkmcnt(4)
    v_pk_fma_f32 v[208:209], v[24:25], v[48:49], v[208:209]
    v_pk_fma_f32 v[210:211], v[24:25], v[50:51], v[210:211]
    v_pk_fma_f32 v[212:213], v[24:25], v[52:53], v[212:213]
    v_pk_fma_f32 v[214:215], v[24:25], v[54:55], v[214:215]
    v_pk_fma_f32 v[216:217], v[24:25], v[56:57], v[216:217]
    v_pk_fma_f32 v[218:219], v[24:25], v[58:59], v[218:219]
    v_pk_fma_f32 v[220:221], v[24:25], v[60:61], v[220:221]
    v_pk_fma_f32 v[222:223], v[24:25], v[62:63], v[222:223]
    v_pk_mul_f32 v[80:81], v[208:209], v[26:27]
    v_pk_mul_f32 v[82:83], v[210:211], v[26:27]
    v_pk_mul_f32 v[84:85], v[212:213], v[26:27]
    v_pk_mul_f32 v[86:87], v[214:215], v[26:27]
    v_exp_f32 v80, v80
    v_exp_f32 v81, v81
    v_exp_f32 v82, v82
    v_exp_f32 v83, v83
    v_exp_f32 v84, v84
    v_exp_f32 v85, v85
    v_exp_f32 v86, v86
    v_exp_f32 v87, v87
    v_pk_mul_f32 v[208:209], v[208:209], v[216:217]
    v_pk_mul_f32 v[210:211], v[210:211], v[218:219]
    v_pk_mul_f32 v[212:213], v[212:213], v[220:221]
    v_pk_mul_f32 v[214:215], v[214:215], v[222:223]
    v_pk_fma_f32 v[80:81], v[80:81], v[30:31], v[30:31]
    v_pk_fma_f32 v[82:83], v[82:83], v[30:31], v[30:31]
    v_pk_fma_f32 v[84:85], v[84:85], v[30:31], v[30:31]
    v_pk_fma_f32 v[86:87], v[86:87], v[30:31], v[30:31]
    v_rcp_f32 v80, v80
    v_rcp_f32 v81, v81
    v_rcp_f32 v82, v82
    v_rcp_f32 v83, v83
    v_rcp_f32 v84, v84
    v_rcp_f32 v85, v85
    v_rcp_f32 v86, v86
    v_rcp_f32 v87, v87
    v_pk_mul_f32 v[208:209], v[208:209], v[80:81]
    v_pk_mul_f32 v[210:211], v[210:211], v[82:83]
    v_pk_mul_f32 v[212:213], v[212:213], v[84:85]
    v_pk_mul_f32 v[214:215], v[214:215], v[86:87]
    v_cvt_pk_bf16_f32 v72, v208, v209
    v_cvt_pk_bf16_f32 v73, v210, v211
    v_cvt_pk_bf16_f32 v74, v212, v213
    v_cvt_pk_bf16_f32 v75, v214, v215
    buffer_store_dwordx4 v[72:75], v28, s[4:7], s52 offen sc1
    s_add_u32 s52, s52, 4096
    s_waitcnt lgkmcnt(0)
    v_pk_fma_f32 v[224:225], v[24:25], v[32:33], v[224:225]
    v_pk_fma_f32 v[226:227], v[24:25], v[34:35], v[226:227]
    v_pk_fma_f32 v[228:229], v[24:25], v[36:37], v[228:229]
    v_pk_fma_f32 v[230:231], v[24:25], v[38:39], v[230:231]
    v_pk_fma_f32 v[232:233], v[24:25], v[40:41], v[232:233]
    v_pk_fma_f32 v[234:235], v[24:25], v[42:43], v[234:235]
    v_pk_fma_f32 v[236:237], v[24:25], v[44:45], v[236:237]
    v_pk_fma_f32 v[238:239], v[24:25], v[46:47], v[238:239]
    v_pk_mul_f32 v[80:81], v[224:225], v[26:27]
    v_pk_mul_f32 v[82:83], v[226:227], v[26:27]
    v_pk_mul_f32 v[84:85], v[228:229], v[26:27]
    v_pk_mul_f32 v[86:87], v[230:231], v[26:27]
    v_exp_f32 v80, v80
    v_exp_f32 v81, v81
    v_exp_f32 v82, v82
    v_exp_f32 v83, v83
    v_exp_f32 v84, v84
    v_exp_f32 v85, v85
    v_exp_f32 v86, v86
    v_exp_f32 v87, v87
    v_pk_mul_f32 v[224:225], v[224:225], v[232:233]
    v_pk_mul_f32 v[226:227], v[226:227], v[234:235]
    v_pk_mul_f32 v[228:229], v[228:229], v[236:237]
    v_pk_mul_f32 v[230:231], v[230:231], v[238:239]
    v_pk_fma_f32 v[80:81], v[80:81], v[30:31], v[30:31]
    v_pk_fma_f32 v[82:83], v[82:83], v[30:31], v[30:31]
    v_pk_fma_f32 v[84:85], v[84:85], v[30:31], v[30:31]
    v_pk_fma_f32 v[86:87], v[86:87], v[30:31], v[30:31]
    v_rcp_f32 v80, v80
    v_rcp_f32 v81, v81
    v_rcp_f32 v82, v82
    v_rcp_f32 v83, v83
    v_rcp_f32 v84, v84
    v_rcp_f32 v85, v85
    v_rcp_f32 v86, v86
    v_rcp_f32 v87, v87
    v_pk_mul_f32 v[224:225], v[224:225], v[80:81]
    v_pk_mul_f32 v[226:227], v[226:227], v[82:83]
    v_pk_mul_f32 v[228:229], v[228:229], v[84:85]
    v_pk_mul_f32 v[230:231], v[230:231], v[86:87]
    v_cvt_pk_bf16_f32 v64, v224, v225
    v_cvt_pk_bf16_f32 v65, v226, v227
    v_cvt_pk_bf16_f32 v66, v228, v229
    v_cvt_pk_bf16_f32 v67, v230, v231
    buffer_store_dwordx4 v[64:67], v28, s[4:7], s52 offen sc1
    s_add_u32 s52, s52, 4096
.ed20:
    s_waitcnt vmcnt(0) lgkmcnt(0)
    s_barrier
    s_and_b32 s54, s46, 1
    s_lshr_b32 s55, s46, 1
    v_and_b32 v100, 15, v0
    v_lshrrev_b32 v101, 4, v0
    v_lshlrev_b32 v102, 10, v101
    v_lshl_add_u32 v102, v100, 4, v102
    s_lshl_b32 s52, s55, 12
    s_lshl_b32 s53, s54, 9
    s_add_u32 s52, s52, s53
    s_lshl_b32 s53, s55, 8
    s_add_u32 s52, s52, s53
    s_add_u32 s52, s52, 0x19000
    v_add_u32 v24, s52, v102
    v_xor_b32 v25, 256, v24
    v_bfe_u32 v102, v0, 2, 2
    v_bfe_u32 v103, v0, 5, 1
    v_lshl_add_u32 v102, v103, 4, v102
    v_bfe_u32 v103, v0, 4, 1
    v_lshl_add_u32 v102, v103, 2, v102
    v_mul_u32_u24 v102, 160, v102
    v_and_b32 v103, 3, v0
    v_lshl_add_u32 v102, v103, 3, v102
    s_mul_i32 s52, s55, 5120
    v_add_u32 v26, s52, v102
    v_add_u32 v27, 0xf000, v26
    s_mul_i32 s52, s46, 5120
    s_add_u32 s52, s52, 0x19000
    v_lshl_add_u32 v102, v0, 4, s52
    s_xor_b32 s52, s46, 2
    s_mul_i32 s52, s52, 5120
    s_add_u32 s52, s52, 0x19000
    v_lshl_add_u32 v103, v0, 4, s52
    s_cmp_eq_u32 s47, 0
    s_cselect_b32 s40, s4, s32
    s_cselect_b32 s41, s5, s33
    s_cselect_b32 s42, s6, s34
    s_cselect_b32 s43, s7, s35
    s_cselect_b32 s56, 16, 1280
    s_cselect_b32 s57, 2048, 16
    s_cselect_b32 s58, 0x1700000, 0
    s_lshr_b32 s52, s45, 3
    s_lshl_b32 s52, s52, 6
    s_and_b32 s60, s46, 1
    s_lshl_b32 s60, s60, 5
    s_add_u32 s52, s52, s60
    s_lshr_b32 s60, s46, 1
    s_lshl_b32 s60, s60, 4
    s_add_u32 s52, s52, s60
    s_mul_i32 s52, s52, s56
    s_add_u32 s58, s58, s52
    s_mul_i32 s52, s44, 163840
    s_add_u32 s58, s58, s52
    s_and_b32 s52, s45, 7
    s_mul_i32 s52, s52, 10
    s_mul_i32 s52, s52, s57
    s_add_u32 s58, s58, s52
    s_lshl_b32 s59, s57, 2
    s_add_u32 s59, s59, s58
    v_and_b32 v92, 15, v0
    v_mul_lo_u32 v92, v92, s56
    v_bfe_u32 v93, v0, 4, 1
    v_lshrrev_b32 v94, 5, v0
    v_lshl_add_u32 v95, v93, 1, v94
    v_mul_lo_u32 v95, v95, s57
    v_add_u32 v90, v92, v95
    v_add_u32 v95, 8, v94
    v_mul_lo_u32 v95, v95, s57
    v_add_u32 v91, v92, v95
    v_lshl_add_u32 v91, v93, 3, v91
    s_lshr_b32 s52, s45, 3
    s_lshl_b32 s52, s52, 6
    s_and_b32 s60, s46, 1
    s_lshl_b32 s60, s60, 5
    s_add_u32 s52, s52, s60
    s_lshr_b32 s60, s46, 1
    s_lshl_b32 s60, s60, 4
    s_add_u32 s52, s52, s60
    s_lshl_b32 s52, s52, 3
    s_lshl_b32 s53, s44, 13
    s_add_u32 s52, s52, s53
    s_and_b32 s53, s45, 7
    s_lshl_b32 s53, s53, 10
    s_add_u32 s52, s52, s53
    s_lshl_b32 s53, s47, 18
    s_add_u32 s52, s52, s53
    s_add_u32 s101, s52, 0x60000
    v_and_b32 v96, 15, v0
    v_lshrrev_b32 v97, 5, v0
    v_lshlrev_b32 v96, 3, v96
    v_lshl_add_u32 v96, v97, 2, v96
    s_barrier
    ds_read_b128 v[32:35], v24 offset:0
    ds_read_b128 v[36:39], v25 offset:0
    ds_read_b64_tr_b16 v[40:41], v26 offset:30720
    ds_read_b64_tr_b16 v[42:43], v26 offset:32000
    ds_read_b64_tr_b16 v[44:45], v26 offset:30752
    ds_read_b64_tr_b16 v[46:47], v26 offset:32032
    ds_read_b64_tr_b16 v[48:49], v26 offset:30784
    ds_read_b64_tr_b16 v[50:51], v26 offset:32064
    ds_read_b64_tr_b16 v[52:53], v26 offset:30816
    ds_read_b64_tr_b16 v[54:55], v26 offset:32096
    ds_read_b64_tr_b16 v[56:57], v26 offset:30848
    ds_read_b64_tr_b16 v[58:59], v26 offset:32128
    s_waitcnt lgkmcnt(0)
    v_mfma_f32_16x16x32_bf16 v[128:131], v[40:43], v[32:35], 0
    v_mfma_f32_16x16x32_bf16 v[148:151], v[40:43], v[36:39], 0
    s_barrier
    ds_read_b128 v[60:63], v24 offset:8192
    ds_read_b128 v[64:67], v25 offset:8192
    v_mfma_f32_16x16x32_bf16 v[132:135], v[44:47], v[32:35], 0
    ds_read_b64_tr_b16 v[68:69], v26 offset:40960
    ds_read_b64_tr_b16 v[70:71], v26 offset:42240
    v_mfma_f32_16x16x32_bf16 v[152:155], v[44:47], v[36:39], 0
    ds_read_b64_tr_b16 v[72:73], v26 offset:40992
    ds_read_b64_tr_b16 v[74:75], v26 offset:42272
    v_mfma_f32_16x16x32_bf16 v[136:139], v[48:51], v[32:35], 0
    ds_read_b64_tr_b16 v[76:77], v26 offset:41024
    ds_read_b64_tr_b16 v[78:79], v26 offset:42304
    v_mfma_f32_16x16x32_bf16 v[156:159], v[48:51], v[36:39], 0
    ds_read_b64_tr_b16 v[80:81], v26 offset:41056
    ds_read_b64_tr_b16 v[82:83], v26 offset:42336
    v_mfma_f32_16x16x32_bf16 v[140:143], v[52:55], v[32:35], 0
    ds_read_b64_tr_b16 v[84:85], v26 offset:41088
    ds_read_b64_tr_b16 v[86:87], v26 offset:42368
    v_mfma_f32_16x16x32_bf16 v[160:163], v[52:55], v[36:39], 0
    v_mfma_f32_16x16x32_bf16 v[144:147], v[56:59], v[32:35], 0
    v_mfma_f32_16x16x32_bf16 v[164:167], v[56:59], v[36:39], 0
    s_waitcnt lgkmcnt(0)
    v_mfma_f32_16x16x32_bf16 v[128:131], v[68:71], v[60:63], v[128:131]
    v_mfma_f32_16x16x32_bf16 v[148:151], v[68:71], v[64:67], v[148:151]
    s_barrier
    ds_read_b128 v[32:35], v24 offset:16384
    ds_read_b128 v[36:39], v25 offset:16384
    v_mfma_f32_16x16x32_bf16 v[132:135], v[72:75], v[60:63], v[132:135]
    ds_read_b64_tr_b16 v[40:41], v26 offset:51200
    ds_read_b64_tr_b16 v[42:43], v26 offset:52480
    v_mfma_f32_16x16x32_bf16 v[152:155], v[72:75], v[64:67], v[152:155]
    ds_read_b64_tr_b16 v[44:45], v26 offset:51232
    ds_read_b64_tr_b16 v[46:47], v26 offset:52512
    v_mfma_f32_16x16x32_bf16 v[136:139], v[76:79], v[60:63], v[136:139]
    ds_read_b64_tr_b16 v[48:49], v26 offset:51264
    ds_read_b64_tr_b16 v[50:51], v26 offset:52544
    v_mfma_f32_16x16x32_bf16 v[156:159], v[76:79], v[64:67], v[156:159]
    ds_read_b64_tr_b16 v[52:53], v26 offset:51296
    ds_read_b64_tr_b16 v[54:55], v26 offset:52576
    v_mfma_f32_16x16x32_bf16 v[140:143], v[80:83], v[60:63], v[140:143]
    ds_read_b64_tr_b16 v[56:57], v26 offset:51328
    ds_read_b64_tr_b16 v[58:59], v26 offset:52608
    v_mfma_f32_16x16x32_bf16 v[160:163], v[80:83], v[64:67], v[160:163]
    v_mfma_f32_16x16x32_bf16 v[144:147], v[84:87], v[60:63], v[144:147]
    v_mfma_f32_16x16x32_bf16 v[164:167], v[84:87], v[64:67], v[164:167]
    s_waitcnt lgkmcnt(0)
    v_mfma_f32_16x16x32_bf16 v[128:131], v[40:43], v[32:35], v[128:131]
    v_mfma_f32_16x16x32_bf16 v[148:151], v[40:43], v[36:39], v[148:151]
    s_barrier
    ds_read_b128 v[60:63], v24 offset:24576
    ds_read_b128 v[64:67], v25 offset:24576
    v_mfma_f32_16x16x32_bf16 v[132:135], v[44:47], v[32:35], v[132:135]
    ds_read_b64_tr_b16 v[68:69], v27 offset:0
    ds_read_b64_tr_b16 v[70:71], v27 offset:1280
    v_mfma_f32_16x16x32_bf16 v[152:155], v[44:47], v[36:39], v[152:155]
    ds_read_b64_tr_b16 v[72:73], v27 offset:32
    ds_read_b64_tr_b16 v[74:75], v27 offset:1312
    v_mfma_f32_16x16x32_bf16 v[136:139], v[48:51], v[32:35], v[136:139]
    ds_read_b64_tr_b16 v[76:77], v27 offset:64
    ds_read_b64_tr_b16 v[78:79], v27 offset:1344
    v_mfma_f32_16x16x32_bf16 v[156:159], v[48:51], v[36:39], v[156:159]
    ds_read_b64_tr_b16 v[80:81], v27 offset:96
    ds_read_b64_tr_b16 v[82:83], v27 offset:1376
    v_mfma_f32_16x16x32_bf16 v[140:143], v[52:55], v[32:35], v[140:143]
    ds_read_b64_tr_b16 v[84:85], v27 offset:128
    ds_read_b64_tr_b16 v[86:87], v27 offset:1408
    v_mfma_f32_16x16x32_bf16 v[160:163], v[52:55], v[36:39], v[160:163]
    v_mfma_f32_16x16x32_bf16 v[144:147], v[56:59], v[32:35], v[144:147]
    v_mfma_f32_16x16x32_bf16 v[164:167], v[56:59], v[36:39], v[164:167]
    s_waitcnt lgkmcnt(0)
    v_mfma_f32_16x16x32_bf16 v[128:131], v[68:71], v[60:63], v[128:131]
    v_mfma_f32_16x16x32_bf16 v[148:151], v[68:71], v[64:67], v[148:151]
    s_barrier
    ds_read_b128 v[32:35], v24 offset:32768
    ds_read_b128 v[36:39], v25 offset:32768
    v_mfma_f32_16x16x32_bf16 v[132:135], v[72:75], v[60:63], v[132:135]
    ds_read_b64_tr_b16 v[40:41], v27 offset:10240
    ds_read_b64_tr_b16 v[42:43], v27 offset:11520
    v_mfma_f32_16x16x32_bf16 v[152:155], v[72:75], v[64:67], v[152:155]
    ds_read_b64_tr_b16 v[44:45], v27 offset:10272
    ds_read_b64_tr_b16 v[46:47], v27 offset:11552
    v_mfma_f32_16x16x32_bf16 v[136:139], v[76:79], v[60:63], v[136:139]
    ds_read_b64_tr_b16 v[48:49], v27 offset:10304
    ds_read_b64_tr_b16 v[50:51], v27 offset:11584
    v_mfma_f32_16x16x32_bf16 v[156:159], v[76:79], v[64:67], v[156:159]
    ds_read_b64_tr_b16 v[52:53], v27 offset:10336
    ds_read_b64_tr_b16 v[54:55], v27 offset:11616
    v_mfma_f32_16x16x32_bf16 v[140:143], v[80:83], v[60:63], v[140:143]
    ds_read_b64_tr_b16 v[56:57], v27 offset:10368
    ds_read_b64_tr_b16 v[58:59], v27 offset:11648
    v_mfma_f32_16x16x32_bf16 v[160:163], v[80:83], v[64:67], v[160:163]
    v_mfma_f32_16x16x32_bf16 v[144:147], v[84:87], v[60:63], v[144:147]
    v_mfma_f32_16x16x32_bf16 v[164:167], v[84:87], v[64:67], v[164:167]
    s_waitcnt lgkmcnt(0)
    v_mfma_f32_16x16x32_bf16 v[128:131], v[40:43], v[32:35], v[128:131]
    v_mfma_f32_16x16x32_bf16 v[148:151], v[40:43], v[36:39], v[148:151]
    s_barrier
    ds_read_b128 v[60:63], v24 offset:40960
    ds_read_b128 v[64:67], v25 offset:40960
    v_mfma_f32_16x16x32_bf16 v[132:135], v[44:47], v[32:35], v[132:135]
    ds_read_b64_tr_b16 v[68:69], v27 offset:20480
    ds_read_b64_tr_b16 v[70:71], v27 offset:21760
    v_mfma_f32_16x16x32_bf16 v[152:155], v[44:47], v[36:39], v[152:155]
    ds_read_b64_tr_b16 v[72:73], v27 offset:20512
    ds_read_b64_tr_b16 v[74:75], v27 offset:21792
    v_mfma_f32_16x16x32_bf16 v[136:139], v[48:51], v[32:35], v[136:139]
    ds_read_b64_tr_b16 v[76:77], v27 offset:20544
    ds_read_b64_tr_b16 v[78:79], v27 offset:21824
    v_mfma_f32_16x16x32_bf16 v[156:159], v[48:51], v[36:39], v[156:159]
    ds_read_b64_tr_b16 v[80:81], v27 offset:20576
    ds_read_b64_tr_b16 v[82:83], v27 offset:21856
    v_mfma_f32_16x16x32_bf16 v[140:143], v[52:55], v[32:35], v[140:143]
    ds_read_b64_tr_b16 v[84:85], v27 offset:20608
    ds_read_b64_tr_b16 v[86:87], v27 offset:21888
    v_mfma_f32_16x16x32_bf16 v[160:163], v[52:55], v[36:39], v[160:163]
    v_mfma_f32_16x16x32_bf16 v[144:147], v[56:59], v[32:35], v[144:147]
    v_mfma_f32_16x16x32_bf16 v[164:167], v[56:59], v[36:39], v[164:167]
    s_waitcnt lgkmcnt(0)
    v_mfma_f32_16x16x32_bf16 v[128:131], v[68:71], v[60:63], v[128:131]
    v_mfma_f32_16x16x32_bf16 v[148:151], v[68:71], v[64:67], v[148:151]
    s_barrier
    ds_read_b128 v[32:35], v24 offset:49152
    ds_read_b128 v[36:39], v25 offset:49152
    v_mfma_f32_16x16x32_bf16 v[132:135], v[72:75], v[60:63], v[132:135]
    ds_read_b64_tr_b16 v[40:41], v27 offset:30720
    ds_read_b64_tr_b16 v[42:43], v27 offset:32000
    v_mfma_f32_16x16x32_bf16 v[152:155], v[72:75], v[64:67], v[152:155]
    ds_read_b64_tr_b16 v[44:45], v27 offset:30752
    ds_read_b64_tr_b16 v[46:47], v27 offset:32032
    v_mfma_f32_16x16x32_bf16 v[136:139], v[76:79], v[60:63], v[136:139]
    ds_read_b64_tr_b16 v[48:49], v27 offset:30784
    ds_read_b64_tr_b16 v[50:51], v27 offset:32064
    v_mfma_f32_16x16x32_bf16 v[156:159], v[76:79], v[64:67], v[156:159]
    ds_read_b64_tr_b16 v[52:53], v27 offset:30816
    ds_read_b64_tr_b16 v[54:55], v27 offset:32096
    v_mfma_f32_16x16x32_bf16 v[140:143], v[80:83], v[60:63], v[140:143]
    ds_read_b64_tr_b16 v[56:57], v27 offset:30848
    ds_read_b64_tr_b16 v[58:59], v27 offset:32128
    v_mfma_f32_16x16x32_bf16 v[160:163], v[80:83], v[64:67], v[160:163]
    v_mfma_f32_16x16x32_bf16 v[144:147], v[84:87], v[60:63], v[144:147]
    v_mfma_f32_16x16x32_bf16 v[164:167], v[84:87], v[64:67], v[164:167]
    s_waitcnt lgkmcnt(0)
    v_mfma_f32_16x16x32_bf16 v[128:131], v[40:43], v[32:35], v[128:131]
    v_mfma_f32_16x16x32_bf16 v[148:151], v[40:43], v[36:39], v[148:151]
    s_barrier
    ds_read_b128 v[60:63], v24 offset:0
    ds_read_b128 v[64:67], v25 offset:0
    v_mfma_f32_16x16x32_bf16 v[132:135], v[44:47], v[32:35], v[132:135]
    ds_read_b64_tr_b16 v[68:69], v26 offset:0
    ds_read_b64_tr_b16 v[70:71], v26 offset:1280
    v_mfma_f32_16x16x32_bf16 v[152:155], v[44:47], v[36:39], v[152:155]
    ds_read_b64_tr_b16 v[72:73], v26 offset:32
    ds_read_b64_tr_b16 v[74:75], v26 offset:1312
    v_mfma_f32_16x16x32_bf16 v[136:139], v[48:51], v[32:35], v[136:139]
    ds_read_b64_tr_b16 v[76:77], v26 offset:64
    ds_read_b64_tr_b16 v[78:79], v26 offset:1344
    v_mfma_f32_16x16x32_bf16 v[156:159], v[48:51], v[36:39], v[156:159]
    ds_read_b64_tr_b16 v[80:81], v26 offset:96
    ds_read_b64_tr_b16 v[82:83], v26 offset:1376
    v_mfma_f32_16x16x32_bf16 v[140:143], v[52:55], v[32:35], v[140:143]
    ds_read_b64_tr_b16 v[84:85], v26 offset:128
    ds_read_b64_tr_b16 v[86:87], v26 offset:1408
    v_mfma_f32_16x16x32_bf16 v[160:163], v[52:55], v[36:39], v[160:163]
    v_mfma_f32_16x16x32_bf16 v[144:147], v[56:59], v[32:35], v[144:147]
    v_mfma_f32_16x16x32_bf16 v[164:167], v[56:59], v[36:39], v[164:167]
    s_waitcnt lgkmcnt(0)
    v_mfma_f32_16x16x32_bf16 v[128:131], v[68:71], v[60:63], v[128:131]
    v_mfma_f32_16x16x32_bf16 v[148:151], v[68:71], v[64:67], v[148:151]
    s_barrier
    ds_read_b128 v[32:35], v24 offset:8192
    ds_read_b128 v[36:39], v25 offset:8192
    v_mfma_f32_16x16x32_bf16 v[132:135], v[72:75], v[60:63], v[132:135]
    ds_read_b64_tr_b16 v[40:41], v26 offset:10240
    ds_read_b64_tr_b16 v[42:43], v26 offset:11520
    v_mfma_f32_16x16x32_bf16 v[152:155], v[72:75], v[64:67], v[152:155]
    ds_read_b64_tr_b16 v[44:45], v26 offset:10272
    ds_read_b64_tr_b16 v[46:47], v26 offset:11552
    v_mfma_f32_16x16x32_bf16 v[136:139], v[76:79], v[60:63], v[136:139]
    ds_read_b64_tr_b16 v[48:49], v26 offset:10304
    ds_read_b64_tr_b16 v[50:51], v26 offset:11584
    v_mfma_f32_16x16x32_bf16 v[156:159], v[76:79], v[64:67], v[156:159]
    ds_read_b64_tr_b16 v[52:53], v26 offset:10336
    ds_read_b64_tr_b16 v[54:55], v26 offset:11616
    v_mfma_f32_16x16x32_bf16 v[140:143], v[80:83], v[60:63], v[140:143]
    ds_read_b64_tr_b16 v[56:57], v26 offset:10368
    ds_read_b64_tr_b16 v[58:59], v26 offset:11648
    v_mfma_f32_16x16x32_bf16 v[160:163], v[80:83], v[64:67], v[160:163]
    v_mfma_f32_16x16x32_bf16 v[144:147], v[84:87], v[60:63], v[144:147]
    v_mfma_f32_16x16x32_bf16 v[164:167], v[84:87], v[64:67], v[164:167]
    s_waitcnt lgkmcnt(0)
    v_mfma_f32_16x16x32_bf16 v[128:131], v[40:43], v[32:35], v[128:131]
    v_mfma_f32_16x16x32_bf16 v[148:151], v[40:43], v[36:39], v[148:151]
    s_barrier
    ds_read_b128 v[60:63], v24 offset:16384
    ds_read_b128 v[64:67], v25 offset:16384
    v_mfma_f32_16x16x32_bf16 v[132:135], v[44:47], v[32:35], v[132:135]
    ds_read_b64_tr_b16 v[68:69], v26 offset:20480
    ds_read_b64_tr_b16 v[70:71], v26 offset:21760
    v_mfma_f32_16x16x32_bf16 v[152:155], v[44:47], v[36:39], v[152:155]
    ds_read_b64_tr_b16 v[72:73], v26 offset:20512
    ds_read_b64_tr_b16 v[74:75], v26 offset:21792
    v_mfma_f32_16x16x32_bf16 v[136:139], v[48:51], v[32:35], v[136:139]
    ds_read_b64_tr_b16 v[76:77], v26 offset:20544
    ds_read_b64_tr_b16 v[78:79], v26 offset:21824
    v_mfma_f32_16x16x32_bf16 v[156:159], v[48:51], v[36:39], v[156:159]
    ds_read_b64_tr_b16 v[80:81], v26 offset:20576
    ds_read_b64_tr_b16 v[82:83], v26 offset:21856
    v_mfma_f32_16x16x32_bf16 v[140:143], v[52:55], v[32:35], v[140:143]
    ds_read_b64_tr_b16 v[84:85], v26 offset:20608
    ds_read_b64_tr_b16 v[86:87], v26 offset:21888
    v_mfma_f32_16x16x32_bf16 v[160:163], v[52:55], v[36:39], v[160:163]
    v_mfma_f32_16x16x32_bf16 v[144:147], v[56:59], v[32:35], v[144:147]
    v_mfma_f32_16x16x32_bf16 v[164:167], v[56:59], v[36:39], v[164:167]
    s_waitcnt lgkmcnt(0)
    v_mfma_f32_16x16x32_bf16 v[128:131], v[68:71], v[60:63], v[128:131]
    v_mfma_f32_16x16x32_bf16 v[148:151], v[68:71], v[64:67], v[148:151]
    s_barrier
    ds_read_b128 v[32:35], v24 offset:24576
    ds_read_b128 v[36:39], v25 offset:24576
    v_mfma_f32_16x16x32_bf16 v[132:135], v[72:75], v[60:63], v[132:135]
    ds_read_b64_tr_b16 v[40:41], v26 offset:30720
    ds_read_b64_tr_b16 v[42:43], v26 offset:32000
    v_mfma_f32_16x16x32_bf16 v[152:155], v[72:75], v[64:67], v[152:155]
    ds_read_b64_tr_b16 v[44:45], v26 offset:30752
    ds_read_b64_tr_b16 v[46:47], v26 offset:32032
    v_mfma_f32_16x16x32_bf16 v[136:139], v[76:79], v[60:63], v[136:139]
    ds_read_b64_tr_b16 v[48:49], v26 offset:30784
    ds_read_b64_tr_b16 v[50:51], v26 offset:32064
    v_mfma_f32_16x16x32_bf16 v[156:159], v[76:79], v[64:67], v[156:159]
    ds_read_b64_tr_b16 v[52:53], v26 offset:30816
    ds_read_b64_tr_b16 v[54:55], v26 offset:32096
    v_mfma_f32_16x16x32_bf16 v[140:143], v[80:83], v[60:63], v[140:143]
    ds_read_b64_tr_b16 v[56:57], v26 offset:30848
    ds_read_b64_tr_b16 v[58:59], v26 offset:32128
    v_mfma_f32_16x16x32_bf16 v[160:163], v[80:83], v[64:67], v[160:163]
    v_mfma_f32_16x16x32_bf16 v[144:147], v[84:87], v[60:63], v[144:147]
    v_mfma_f32_16x16x32_bf16 v[164:167], v[84:87], v[64:67], v[164:167]
    s_waitcnt lgkmcnt(0)
    v_mfma_f32_16x16x32_bf16 v[128:131], v[40:43], v[32:35], v[128:131]
    v_mfma_f32_16x16x32_bf16 v[148:151], v[40:43], v[36:39], v[148:151]
    s_barrier
    ds_read_b128 v[60:63], v24 offset:32768
    ds_read_b128 v[64:67], v25 offset:32768
    v_mfma_f32_16x16x32_bf16 v[132:135], v[44:47], v[32:35], v[132:135]
    ds_read_b64_tr_b16 v[68:69], v26 offset:40960
    ds_read_b64_tr_b16 v[70:71], v26 offset:42240
    v_mfma_f32_16x16x32_bf16 v[152:155], v[44:47], v[36:39], v[152:155]
    ds_read_b64_tr_b16 v[72:73], v26 offset:40992
    ds_read_b64_tr_b16 v[74:75], v26 offset:42272
    v_mfma_f32_16x16x32_bf16 v[136:139], v[48:51], v[32:35], v[136:139]
    ds_read_b64_tr_b16 v[76:77], v26 offset:41024
    ds_read_b64_tr_b16 v[78:79], v26 offset:42304
    v_mfma_f32_16x16x32_bf16 v[156:159], v[48:51], v[36:39], v[156:159]
    ds_read_b64_tr_b16 v[80:81], v26 offset:41056
    ds_read_b64_tr_b16 v[82:83], v26 offset:42336
    v_mfma_f32_16x16x32_bf16 v[140:143], v[52:55], v[32:35], v[140:143]
    ds_read_b64_tr_b16 v[84:85], v26 offset:41088
    ds_read_b64_tr_b16 v[86:87], v26 offset:42368
    v_mfma_f32_16x16x32_bf16 v[160:163], v[52:55], v[36:39], v[160:163]
    v_mfma_f32_16x16x32_bf16 v[144:147], v[56:59], v[32:35], v[144:147]
    v_mfma_f32_16x16x32_bf16 v[164:167], v[56:59], v[36:39], v[164:167]
    s_waitcnt lgkmcnt(0)
    v_mfma_f32_16x16x32_bf16 v[128:131], v[68:71], v[60:63], v[128:131]
    v_mfma_f32_16x16x32_bf16 v[148:151], v[68:71], v[64:67], v[148:151]
    s_barrier
    ds_read_b128 v[32:35], v24 offset:40960
    ds_read_b128 v[36:39], v25 offset:40960
    v_mfma_f32_16x16x32_bf16 v[132:135], v[72:75], v[60:63], v[132:135]
    ds_read_b64_tr_b16 v[40:41], v26 offset:51200
    ds_read_b64_tr_b16 v[42:43], v26 offset:52480
    v_mfma_f32_16x16x32_bf16 v[152:155], v[72:75], v[64:67], v[152:155]
    ds_read_b64_tr_b16 v[44:45], v26 offset:51232
    ds_read_b64_tr_b16 v[46:47], v26 offset:52512
    v_mfma_f32_16x16x32_bf16 v[136:139], v[76:79], v[60:63], v[136:139]
    ds_read_b64_tr_b16 v[48:49], v26 offset:51264
    ds_read_b64_tr_b16 v[50:51], v26 offset:52544
    v_mfma_f32_16x16x32_bf16 v[156:159], v[76:79], v[64:67], v[156:159]
    ds_read_b64_tr_b16 v[52:53], v26 offset:51296
    ds_read_b64_tr_b16 v[54:55], v26 offset:52576
    v_mfma_f32_16x16x32_bf16 v[140:143], v[80:83], v[60:63], v[140:143]
    ds_read_b64_tr_b16 v[56:57], v26 offset:51328
    ds_read_b64_tr_b16 v[58:59], v26 offset:52608
    v_mfma_f32_16x16x32_bf16 v[160:163], v[80:83], v[64:67], v[160:163]
    v_mfma_f32_16x16x32_bf16 v[144:147], v[84:87], v[60:63], v[144:147]
    v_mfma_f32_16x16x32_bf16 v[164:167], v[84:87], v[64:67], v[164:167]
    s_waitcnt lgkmcnt(0)
    v_mfma_f32_16x16x32_bf16 v[128:131], v[40:43], v[32:35], v[128:131]
    v_mfma_f32_16x16x32_bf16 v[148:151], v[40:43], v[36:39], v[148:151]
    s_barrier
    ds_read_b128 v[60:63], v24 offset:49152
    ds_read_b128 v[64:67], v25 offset:49152
    v_mfma_f32_16x16x32_bf16 v[132:135], v[44:47], v[32:35], v[132:135]
    ds_read_b64_tr_b16 v[68:69], v27 offset:0
    ds_read_b64_tr_b16 v[70:71], v27 offset:1280
    v_mfma_f32_16x16x32_bf16 v[152:155], v[44:47], v[36:39], v[152:155]
    ds_read_b64_tr_b16 v[72:73], v27 offset:32
    ds_read_b64_tr_b16 v[74:75], v27 offset:1312
    v_mfma_f32_16x16x32_bf16 v[136:139], v[48:51], v[32:35], v[136:139]
    ds_read_b64_tr_b16 v[76:77], v27 offset:64
    ds_read_b64_tr_b16 v[78:79], v27 offset:1344
    v_mfma_f32_16x16x32_bf16 v[156:159], v[48:51], v[36:39], v[156:159]
    ds_read_b64_tr_b16 v[80:81], v27 offset:96
    ds_read_b64_tr_b16 v[82:83], v27 offset:1376
    v_mfma_f32_16x16x32_bf16 v[140:143], v[52:55], v[32:35], v[140:143]
    ds_read_b64_tr_b16 v[84:85], v27 offset:128
    ds_read_b64_tr_b16 v[86:87], v27 offset:1408
    v_mfma_f32_16x16x32_bf16 v[160:163], v[52:55], v[36:39], v[160:163]
    v_mfma_f32_16x16x32_bf16 v[144:147], v[56:59], v[32:35], v[144:147]
    v_mfma_f32_16x16x32_bf16 v[164:167], v[56:59], v[36:39], v[164:167]
    s_waitcnt lgkmcnt(0)
    v_mfma_f32_16x16x32_bf16 v[128:131], v[68:71], v[60:63], v[128:131]
    v_mfma_f32_16x16x32_bf16 v[148:151], v[68:71], v[64:67], v[148:151]
    s_barrier
    ds_read_b128 v[32:35], v24 offset:0
    ds_read_b128 v[36:39], v25 offset:0
    v_mfma_f32_16x16x32_bf16 v[132:135], v[72:75], v[60:63], v[132:135]
    ds_read_b64_tr_b16 v[40:41], v27 offset:10240
    ds_read_b64_tr_b16 v[42:43], v27 offset:11520
    v_mfma_f32_16x16x32_bf16 v[152:155], v[72:75], v[64:67], v[152:155]
    ds_read_b64_tr_b16 v[44:45], v27 offset:10272
    ds_read_b64_tr_b16 v[46:47], v27 offset:11552
    v_mfma_f32_16x16x32_bf16 v[136:139], v[76:79], v[60:63], v[136:139]
    ds_read_b64_tr_b16 v[48:49], v27 offset:10304
    ds_read_b64_tr_b16 v[50:51], v27 offset:11584
    v_mfma_f32_16x16x32_bf16 v[156:159], v[76:79], v[64:67], v[156:159]
    ds_read_b64_tr_b16 v[52:53], v27 offset:10336
    ds_read_b64_tr_b16 v[54:55], v27 offset:11616
    v_mfma_f32_16x16x32_bf16 v[140:143], v[80:83], v[60:63], v[140:143]
    ds_read_b64_tr_b16 v[56:57], v27 offset:10368
    ds_read_b64_tr_b16 v[58:59], v27 offset:11648
    v_mfma_f32_16x16x32_bf16 v[160:163], v[80:83], v[64:67], v[160:163]
    v_mfma_f32_16x16x32_bf16 v[144:147], v[84:87], v[60:63], v[144:147]
    v_mfma_f32_16x16x32_bf16 v[164:167], v[84:87], v[64:67], v[164:167]
    s_waitcnt lgkmcnt(0)
    v_mfma_f32_16x16x32_bf16 v[128:131], v[40:43], v[32:35], v[128:131]
    v_mfma_f32_16x16x32_bf16 v[148:151], v[40:43], v[36:39], v[148:151]
    s_barrier
    ds_read_b128 v[60:63], v24 offset:8192
    ds_read_b128 v[64:67], v25 offset:8192
    v_mfma_f32_16x16x32_bf16 v[132:135], v[44:47], v[32:35], v[132:135]
    ds_read_b64_tr_b16 v[68:69], v27 offset:20480
    ds_read_b64_tr_b16 v[70:71], v27 offset:21760
    v_mfma_f32_16x16x32_bf16 v[152:155], v[44:47], v[36:39], v[152:155]
    ds_read_b64_tr_b16 v[72:73], v27 offset:20512
    ds_read_b64_tr_b16 v[74:75], v27 offset:21792
    v_mfma_f32_16x16x32_bf16 v[136:139], v[48:51], v[32:35], v[136:139]
    ds_read_b64_tr_b16 v[76:77], v27 offset:20544
    ds_read_b64_tr_b16 v[78:79], v27 offset:21824
    v_mfma_f32_16x16x32_bf16 v[156:159], v[48:51], v[36:39], v[156:159]
    ds_read_b64_tr_b16 v[80:81], v27 offset:20576
    ds_read_b64_tr_b16 v[82:83], v27 offset:21856
    v_mfma_f32_16x16x32_bf16 v[140:143], v[52:55], v[32:35], v[140:143]
    ds_read_b64_tr_b16 v[84:85], v27 offset:20608
    ds_read_b64_tr_b16 v[86:87], v27 offset:21888
    v_mfma_f32_16x16x32_bf16 v[160:163], v[52:55], v[36:39], v[160:163]
    v_mfma_f32_16x16x32_bf16 v[144:147], v[56:59], v[32:35], v[144:147]
    v_mfma_f32_16x16x32_bf16 v[164:167], v[56:59], v[36:39], v[164:167]
    s_waitcnt lgkmcnt(0)
    v_mfma_f32_16x16x32_bf16 v[128:131], v[68:71], v[60:63], v[128:131]
    v_mfma_f32_16x16x32_bf16 v[148:151], v[68:71], v[64:67], v[148:151]
    s_barrier
    ds_read_b128 v[32:35], v24 offset:16384
    ds_read_b128 v[36:39], v25 offset:16384
    v_mfma_f32_16x16x32_bf16 v[132:135], v[72:75], v[60:63], v[132:135]
    ds_read_b64_tr_b16 v[40:41], v27 offset:30720
    ds_read_b64_tr_b16 v[42:43], v27 offset:32000
    v_mfma_f32_16x16x32_bf16 v[152:155], v[72:75], v[64:67], v[152:155]
    ds_read_b64_tr_b16 v[44:45], v27 offset:30752
    ds_read_b64_tr_b16 v[46:47], v27 offset:32032
    v_mfma_f32_16x16x32_bf16 v[136:139], v[76:79], v[60:63], v[136:139]
    ds_read_b64_tr_b16 v[48:49], v27 offset:30784
    ds_read_b64_tr_b16 v[50:51], v27 offset:32064
    v_mfma_f32_16x16x32_bf16 v[156:159], v[76:79], v[64:67], v[156:159]
    ds_read_b64_tr_b16 v[52:53], v27 offset:30816
    ds_read_b64_tr_b16 v[54:55], v27 offset:32096
    v_mfma_f32_16x16x32_bf16 v[140:143], v[80:83], v[60:63], v[140:143]
    ds_read_b64_tr_b16 v[56:57], v27 offset:30848
    ds_read_b64_tr_b16 v[58:59], v27 offset:32128
    v_mfma_f32_16x16x32_bf16 v[160:163], v[80:83], v[64:67], v[160:163]
    v_mfma_f32_16x16x32_bf16 v[144:147], v[84:87], v[60:63], v[144:147]
    v_mfma_f32_16x16x32_bf16 v[164:167], v[84:87], v[64:67], v[164:167]
    s_waitcnt lgkmcnt(0)
    v_mfma_f32_16x16x32_bf16 v[128:131], v[40:43], v[32:35], v[128:131]
    v_mfma_f32_16x16x32_bf16 v[148:151], v[40:43], v[36:39], v[148:151]
    s_barrier
    ds_read_b128 v[60:63], v24 offset:24576
    ds_read_b128 v[64:67], v25 offset:24576
    v_mfma_f32_16x16x32_bf16 v[132:135], v[44:47], v[32:35], v[132:135]
    ds_read_b64_tr_b16 v[68:69], v26 offset:0
    ds_read_b64_tr_b16 v[70:71], v26 offset:1280
    v_mfma_f32_16x16x32_bf16 v[152:155], v[44:47], v[36:39], v[152:155]
    ds_read_b64_tr_b16 v[72:73], v26 offset:32
    ds_read_b64_tr_b16 v[74:75], v26 offset:1312
    v_mfma_f32_16x16x32_bf16 v[136:139], v[48:51], v[32:35], v[136:139]
    ds_read_b64_tr_b16 v[76:77], v26 offset:64
    ds_read_b64_tr_b16 v[78:79], v26 offset:1344
    v_mfma_f32_16x16x32_bf16 v[156:159], v[48:51], v[36:39], v[156:159]
    ds_read_b64_tr_b16 v[80:81], v26 offset:96
    ds_read_b64_tr_b16 v[82:83], v26 offset:1376
    v_mfma_f32_16x16x32_bf16 v[140:143], v[52:55], v[32:35], v[140:143]
    ds_read_b64_tr_b16 v[84:85], v26 offset:128
    ds_read_b64_tr_b16 v[86:87], v26 offset:1408
    v_mfma_f32_16x16x32_bf16 v[160:163], v[52:55], v[36:39], v[160:163]
    v_mfma_f32_16x16x32_bf16 v[144:147], v[56:59], v[32:35], v[144:147]
    v_mfma_f32_16x16x32_bf16 v[164:167], v[56:59], v[36:39], v[164:167]
    s_waitcnt lgkmcnt(0)
    v_mfma_f32_16x16x32_bf16 v[128:131], v[68:71], v[60:63], v[128:131]
    v_mfma_f32_16x16x32_bf16 v[148:151], v[68:71], v[64:67], v[148:151]
    s_barrier
    ds_read_b128 v[32:35], v24 offset:32768
    ds_read_b128 v[36:39], v25 offset:32768
    v_mfma_f32_16x16x32_bf16 v[132:135], v[72:75], v[60:63], v[132:135]
    ds_read_b64_tr_b16 v[40:41], v26 offset:10240
    ds_read_b64_tr_b16 v[42:43], v26 offset:11520
    v_mfma_f32_16x16x32_bf16 v[152:155], v[72:75], v[64:67], v[152:155]
    ds_read_b64_tr_b16 v[44:45], v26 offset:10272
    ds_read_b64_tr_b16 v[46:47], v26 offset:11552
    v_mfma_f32_16x16x32_bf16 v[136:139], v[76:79], v[60:63], v[136:139]
    ds_read_b64_tr_b16 v[48:49], v26 offset:10304
    ds_read_b64_tr_b16 v[50:51], v26 offset:11584
    v_mfma_f32_16x16x32_bf16 v[156:159], v[76:79], v[64:67], v[156:159]
    ds_read_b64_tr_b16 v[52:53], v26 offset:10336
    ds_read_b64_tr_b16 v[54:55], v26 offset:11616
    v_mfma_f32_16x16x32_bf16 v[140:143], v[80:83], v[60:63], v[140:143]
    ds_read_b64_tr_b16 v[56:57], v26 offset:10368
    ds_read_b64_tr_b16 v[58:59], v26 offset:11648
    v_mfma_f32_16x16x32_bf16 v[160:163], v[80:83], v[64:67], v[160:163]
    v_mfma_f32_16x16x32_bf16 v[144:147], v[84:87], v[60:63], v[144:147]
    v_mfma_f32_16x16x32_bf16 v[164:167], v[84:87], v[64:67], v[164:167]
    s_waitcnt lgkmcnt(0)
    v_mfma_f32_16x16x32_bf16 v[128:131], v[40:43], v[32:35], v[128:131]
    v_mfma_f32_16x16x32_bf16 v[148:151], v[40:43], v[36:39], v[148:151]
    s_barrier
    ds_read_b128 v[60:63], v24 offset:40960
    ds_read_b128 v[64:67], v25 offset:40960
    v_mfma_f32_16x16x32_bf16 v[132:135], v[44:47], v[32:35], v[132:135]
    ds_read_b64_tr_b16 v[68:69], v26 offset:20480
    ds_read_b64_tr_b16 v[70:71], v26 offset:21760
    v_mfma_f32_16x16x32_bf16 v[152:155], v[44:47], v[36:39], v[152:155]
    ds_read_b64_tr_b16 v[72:73], v26 offset:20512
    ds_read_b64_tr_b16 v[74:75], v26 offset:21792
    v_mfma_f32_16x16x32_bf16 v[136:139], v[48:51], v[32:35], v[136:139]
    ds_read_b64_tr_b16 v[76:77], v26 offset:20544
    ds_read_b64_tr_b16 v[78:79], v26 offset:21824
    v_mfma_f32_16x16x32_bf16 v[156:159], v[48:51], v[36:39], v[156:159]
    ds_read_b64_tr_b16 v[80:81], v26 offset:20576
    ds_read_b64_tr_b16 v[82:83], v26 offset:21856
    v_mfma_f32_16x16x32_bf16 v[140:143], v[52:55], v[32:35], v[140:143]
    ds_read_b64_tr_b16 v[84:85], v26 offset:20608
    ds_read_b64_tr_b16 v[86:87], v26 offset:21888
    v_mfma_f32_16x16x32_bf16 v[160:163], v[52:55], v[36:39], v[160:163]
    v_mfma_f32_16x16x32_bf16 v[144:147], v[56:59], v[32:35], v[144:147]
    v_mfma_f32_16x16x32_bf16 v[164:167], v[56:59], v[36:39], v[164:167]
    s_waitcnt lgkmcnt(0)
    v_mfma_f32_16x16x32_bf16 v[128:131], v[68:71], v[60:63], v[128:131]
    v_mfma_f32_16x16x32_bf16 v[148:151], v[68:71], v[64:67], v[148:151]
    s_barrier
    ds_read_b128 v[32:35], v24 offset:49152
    ds_read_b128 v[36:39], v25 offset:49152
    v_mfma_f32_16x16x32_bf16 v[132:135], v[72:75], v[60:63], v[132:135]
    ds_read_b64_tr_b16 v[40:41], v26 offset:30720
    ds_read_b64_tr_b16 v[42:43], v26 offset:32000
    v_mfma_f32_16x16x32_bf16 v[152:155], v[72:75], v[64:67], v[152:155]
    ds_read_b64_tr_b16 v[44:45], v26 offset:30752
    ds_read_b64_tr_b16 v[46:47], v26 offset:32032
    v_mfma_f32_16x16x32_bf16 v[136:139], v[76:79], v[60:63], v[136:139]
    ds_read_b64_tr_b16 v[48:49], v26 offset:30784
    ds_read_b64_tr_b16 v[50:51], v26 offset:32064
    v_mfma_f32_16x16x32_bf16 v[156:159], v[76:79], v[64:67], v[156:159]
    ds_read_b64_tr_b16 v[52:53], v26 offset:30816
    ds_read_b64_tr_b16 v[54:55], v26 offset:32096
    v_mfma_f32_16x16x32_bf16 v[140:143], v[80:83], v[60:63], v[140:143]
    ds_read_b64_tr_b16 v[56:57], v26 offset:30848
    ds_read_b64_tr_b16 v[58:59], v26 offset:32128
    v_mfma_f32_16x16x32_bf16 v[160:163], v[80:83], v[64:67], v[160:163]
    v_mfma_f32_16x16x32_bf16 v[144:147], v[84:87], v[60:63], v[144:147]
    v_mfma_f32_16x16x32_bf16 v[164:167], v[84:87], v[64:67], v[164:167]
    s_waitcnt lgkmcnt(0)
    v_mfma_f32_16x16x32_bf16 v[128:131], v[40:43], v[32:35], v[128:131]
    v_mfma_f32_16x16x32_bf16 v[148:151], v[40:43], v[36:39], v[148:151]
    s_barrier
    ds_read_b128 v[60:63], v24 offset:0
    ds_read_b128 v[64:67], v25 offset:0
    v_mfma_f32_16x16x32_bf16 v[132:135], v[44:47], v[32:35], v[132:135]
    ds_read_b64_tr_b16 v[68:69], v26 offset:40960
    ds_read_b64_tr_b16 v[70:71], v26 offset:42240
    v_mfma_f32_16x16x32_bf16 v[152:155], v[44:47], v[36:39], v[152:155]
    ds_read_b64_tr_b16 v[72:73], v26 offset:40992
    ds_read_b64_tr_b16 v[74:75], v26 offset:42272
    v_mfma_f32_16x16x32_bf16 v[136:139], v[48:51], v[32:35], v[136:139]
    ds_read_b64_tr_b16 v[76:77], v26 offset:41024
    ds_read_b64_tr_b16 v[78:79], v26 offset:42304
    v_mfma_f32_16x16x32_bf16 v[156:159], v[48:51], v[36:39], v[156:159]
    ds_read_b64_tr_b16 v[80:81], v26 offset:41056
    ds_read_b64_tr_b16 v[82:83], v26 offset:42336
    v_mfma_f32_16x16x32_bf16 v[140:143], v[52:55], v[32:35], v[140:143]
    ds_read_b64_tr_b16 v[84:85], v26 offset:41088
    ds_read_b64_tr_b16 v[86:87], v26 offset:42368
    v_mfma_f32_16x16x32_bf16 v[160:163], v[52:55], v[36:39], v[160:163]
    v_mfma_f32_16x16x32_bf16 v[144:147], v[56:59], v[32:35], v[144:147]
    v_mfma_f32_16x16x32_bf16 v[164:167], v[56:59], v[36:39], v[164:167]
    s_waitcnt lgkmcnt(0)
    v_mfma_f32_16x16x32_bf16 v[128:131], v[68:71], v[60:63], v[128:131]
    v_mfma_f32_16x16x32_bf16 v[148:151], v[68:71], v[64:67], v[148:151]
    s_barrier
    ds_read_b128 v[32:35], v24 offset:8192
    ds_read_b128 v[36:39], v25 offset:8192
    v_mfma_f32_16x16x32_bf16 v[132:135], v[72:75], v[60:63], v[132:135]
    ds_read_b64_tr_b16 v[40:41], v26 offset:51200
    ds_read_b64_tr_b16 v[42:43], v26 offset:52480
    v_mfma_f32_16x16x32_bf16 v[152:155], v[72:75], v[64:67], v[152:155]
    ds_read_b64_tr_b16 v[44:45], v26 offset:51232
    ds_read_b64_tr_b16 v[46:47], v26 offset:52512
    v_mfma_f32_16x16x32_bf16 v[136:139], v[76:79], v[60:63], v[136:139]
    ds_read_b64_tr_b16 v[48:49], v26 offset:51264
    ds_read_b64_tr_b16 v[50:51], v26 offset:52544
    v_mfma_f32_16x16x32_bf16 v[156:159], v[76:79], v[64:67], v[156:159]
    ds_read_b64_tr_b16 v[52:53], v26 offset:51296
    ds_read_b64_tr_b16 v[54:55], v26 offset:52576
    v_mfma_f32_16x16x32_bf16 v[140:143], v[80:83], v[60:63], v[140:143]
    ds_read_b64_tr_b16 v[56:57], v26 offset:51328
    ds_read_b64_tr_b16 v[58:59], v26 offset:52608
    v_mfma_f32_16x16x32_bf16 v[160:163], v[80:83], v[64:67], v[160:163]
    v_mfma_f32_16x16x32_bf16 v[144:147], v[84:87], v[60:63], v[144:147]
    v_mfma_f32_16x16x32_bf16 v[164:167], v[84:87], v[64:67], v[164:167]
    s_waitcnt lgkmcnt(0)
    v_mfma_f32_16x16x32_bf16 v[128:131], v[40:43], v[32:35], v[128:131]
    v_mfma_f32_16x16x32_bf16 v[148:151], v[40:43], v[36:39], v[148:151]
    s_barrier
    ds_read_b128 v[60:63], v24 offset:16384
    ds_read_b128 v[64:67], v25 offset:16384
    v_mfma_f32_16x16x32_bf16 v[132:135], v[44:47], v[32:35], v[132:135]
    ds_read_b64_tr_b16 v[68:69], v27 offset:0
    ds_read_b64_tr_b16 v[70:71], v27 offset:1280
    v_mfma_f32_16x16x32_bf16 v[152:155], v[44:47], v[36:39], v[152:155]
    ds_read_b64_tr_b16 v[72:73], v27 offset:32
    ds_read_b64_tr_b16 v[74:75], v27 offset:1312
    v_mfma_f32_16x16x32_bf16 v[136:139], v[48:51], v[32:35], v[136:139]
    ds_read_b64_tr_b16 v[76:77], v27 offset:64
    ds_read_b64_tr_b16 v[78:79], v27 offset:1344
    v_mfma_f32_16x16x32_bf16 v[156:159], v[48:51], v[36:39], v[156:159]
    ds_read_b64_tr_b16 v[80:81], v27 offset:96
    ds_read_b64_tr_b16 v[82:83], v27 offset:1376
    v_mfma_f32_16x16x32_bf16 v[140:143], v[52:55], v[32:35], v[140:143]
    ds_read_b64_tr_b16 v[84:85], v27 offset:128
    ds_read_b64_tr_b16 v[86:87], v27 offset:1408
    v_mfma_f32_16x16x32_bf16 v[160:163], v[52:55], v[36:39], v[160:163]
    v_mfma_f32_16x16x32_bf16 v[144:147], v[56:59], v[32:35], v[144:147]
    v_mfma_f32_16x16x32_bf16 v[164:167], v[56:59], v[36:39], v[164:167]
    s_waitcnt lgkmcnt(0)
    v_mfma_f32_16x16x32_bf16 v[128:131], v[68:71], v[60:63], v[128:131]
    v_mfma_f32_16x16x32_bf16 v[148:151], v[68:71], v[64:67], v[148:151]
    s_barrier
    ds_read_b128 v[32:35], v24 offset:24576
    ds_read_b128 v[36:39], v25 offset:24576
    v_mfma_f32_16x16x32_bf16 v[132:135], v[72:75], v[60:63], v[132:135]
    ds_read_b64_tr_b16 v[40:41], v27 offset:10240
    ds_read_b64_tr_b16 v[42:43], v27 offset:11520
    v_mfma_f32_16x16x32_bf16 v[152:155], v[72:75], v[64:67], v[152:155]
    ds_read_b64_tr_b16 v[44:45], v27 offset:10272
    ds_read_b64_tr_b16 v[46:47], v27 offset:11552
    v_mfma_f32_16x16x32_bf16 v[136:139], v[76:79], v[60:63], v[136:139]
    ds_read_b64_tr_b16 v[48:49], v27 offset:10304
    ds_read_b64_tr_b16 v[50:51], v27 offset:11584
    v_mfma_f32_16x16x32_bf16 v[156:159], v[76:79], v[64:67], v[156:159]
    ds_read_b64_tr_b16 v[52:53], v27 offset:10336
    ds_read_b64_tr_b16 v[54:55], v27 offset:11616
    v_mfma_f32_16x16x32_bf16 v[140:143], v[80:83], v[60:63], v[140:143]
    ds_read_b64_tr_b16 v[56:57], v27 offset:10368
    ds_read_b64_tr_b16 v[58:59], v27 offset:11648
    v_mfma_f32_16x16x32_bf16 v[160:163], v[80:83], v[64:67], v[160:163]
    v_mfma_f32_16x16x32_bf16 v[144:147], v[84:87], v[60:63], v[144:147]
    v_mfma_f32_16x16x32_bf16 v[164:167], v[84:87], v[64:67], v[164:167]
    s_waitcnt lgkmcnt(0)
    v_mfma_f32_16x16x32_bf16 v[128:131], v[40:43], v[32:35], v[128:131]
    v_mfma_f32_16x16x32_bf16 v[148:151], v[40:43], v[36:39], v[148:151]
    s_barrier
    ds_read_b128 v[60:63], v24 offset:32768
    ds_read_b128 v[64:67], v25 offset:32768
    v_mfma_f32_16x16x32_bf16 v[132:135], v[44:47], v[32:35], v[132:135]
    ds_read_b64_tr_b16 v[68:69], v27 offset:20480
    ds_read_b64_tr_b16 v[70:71], v27 offset:21760
    v_mfma_f32_16x16x32_bf16 v[152:155], v[44:47], v[36:39], v[152:155]
    ds_read_b64_tr_b16 v[72:73], v27 offset:20512
    ds_read_b64_tr_b16 v[74:75], v27 offset:21792
    v_mfma_f32_16x16x32_bf16 v[136:139], v[48:51], v[32:35], v[136:139]
    ds_read_b64_tr_b16 v[76:77], v27 offset:20544
    ds_read_b64_tr_b16 v[78:79], v27 offset:21824
    v_mfma_f32_16x16x32_bf16 v[156:159], v[48:51], v[36:39], v[156:159]
    ds_read_b64_tr_b16 v[80:81], v27 offset:20576
    ds_read_b64_tr_b16 v[82:83], v27 offset:21856
    v_mfma_f32_16x16x32_bf16 v[140:143], v[52:55], v[32:35], v[140:143]
    ds_read_b64_tr_b16 v[84:85], v27 offset:20608
    ds_read_b64_tr_b16 v[86:87], v27 offset:21888
    v_mfma_f32_16x16x32_bf16 v[160:163], v[52:55], v[36:39], v[160:163]
    v_mfma_f32_16x16x32_bf16 v[144:147], v[56:59], v[32:35], v[144:147]
    v_mfma_f32_16x16x32_bf16 v[164:167], v[56:59], v[36:39], v[164:167]
    s_waitcnt lgkmcnt(0)
    v_mfma_f32_16x16x32_bf16 v[128:131], v[68:71], v[60:63], v[128:131]
    v_mfma_f32_16x16x32_bf16 v[148:151], v[68:71], v[64:67], v[148:151]
    s_barrier
    ds_read_b128 v[32:35], v24 offset:40960
    ds_read_b128 v[36:39], v25 offset:40960
    v_mfma_f32_16x16x32_bf16 v[132:135], v[72:75], v[60:63], v[132:135]
    ds_read_b64_tr_b16 v[40:41], v27 offset:30720
    ds_read_b64_tr_b16 v[42:43], v27 offset:32000
    v_mfma_f32_16x16x32_bf16 v[152:155], v[72:75], v[64:67], v[152:155]
    ds_read_b64_tr_b16 v[44:45], v27 offset:30752
    ds_read_b64_tr_b16 v[46:47], v27 offset:32032
    v_mfma_f32_16x16x32_bf16 v[136:139], v[76:79], v[60:63], v[136:139]
    ds_read_b64_tr_b16 v[48:49], v27 offset:30784
    ds_read_b64_tr_b16 v[50:51], v27 offset:32064
    v_mfma_f32_16x16x32_bf16 v[156:159], v[76:79], v[64:67], v[156:159]
    ds_read_b64_tr_b16 v[52:53], v27 offset:30816
    ds_read_b64_tr_b16 v[54:55], v27 offset:32096
    v_mfma_f32_16x16x32_bf16 v[140:143], v[80:83], v[60:63], v[140:143]
    ds_read_b64_tr_b16 v[56:57], v27 offset:30848
    ds_read_b64_tr_b16 v[58:59], v27 offset:32128
    v_mfma_f32_16x16x32_bf16 v[160:163], v[80:83], v[64:67], v[160:163]
    v_mfma_f32_16x16x32_bf16 v[144:147], v[84:87], v[60:63], v[144:147]
    v_mfma_f32_16x16x32_bf16 v[164:167], v[84:87], v[64:67], v[164:167]
    s_waitcnt lgkmcnt(0)
    v_mfma_f32_16x16x32_bf16 v[128:131], v[40:43], v[32:35], v[128:131]
    v_mfma_f32_16x16x32_bf16 v[148:151], v[40:43], v[36:39], v[148:151]
    s_barrier
    v_mfma_f32_16x16x32_bf16 v[132:135], v[44:47], v[32:35], v[132:135]
    v_mfma_f32_16x16x32_bf16 v[152:155], v[44:47], v[36:39], v[152:155]
    v_mfma_f32_16x16x32_bf16 v[136:139], v[48:51], v[32:35], v[136:139]
    v_mfma_f32_16x16x32_bf16 v[156:159], v[48:51], v[36:39], v[156:159]
    v_mfma_f32_16x16x32_bf16 v[140:143], v[52:55], v[32:35], v[140:143]
    v_mfma_f32_16x16x32_bf16 v[160:163], v[52:55], v[36:39], v[160:163]
    v_mfma_f32_16x16x32_bf16 v[144:147], v[56:59], v[32:35], v[144:147]
    v_mfma_f32_16x16x32_bf16 v[164:167], v[56:59], v[36:39], v[164:167]
    s_waitcnt lgkmcnt(0)
    s_nop 4
    ds_write_b128 v102, v[148:151] offset:0
    ds_write_b128 v102, v[152:155] offset:1024
    ds_write_b128 v102, v[156:159] offset:2048
    ds_write_b128 v102, v[160:163] offset:3072
    ds_write_b128 v102, v[164:167] offset:4096
    v_pk_add_f32 v[128:129], v[128:129], v[2:3]
    v_pk_add_f32 v[130:131], v[130:131], v[4:5]
    v_pk_add_f32 v[132:133], v[132:133], v[6:7]
    v_pk_add_f32 v[134:135], v[134:135], v[8:9]
    v_pk_add_f32 v[136:137], v[136:137], v[10:11]
    v_pk_add_f32 v[138:139], v[138:139], v[12:13]
    v_pk_add_f32 v[140:141], v[140:141], v[14:15]
    v_pk_add_f32 v[142:143], v[142:143], v[16:17]
    v_pk_add_f32 v[144:145], v[144:145], v[18:19]
    v_pk_add_f32 v[146:147], v[146:147], v[20:21]
    s_waitcnt lgkmcnt(0)
    s_barrier
    ds_read_b128 v[32:35], v103 offset:0
    ds_read_b128 v[36:39], v103 offset:1024
    ds_read_b128 v[40:43], v103 offset:2048
    ds_read_b128 v[44:47], v103 offset:3072
    ds_read_b128 v[48:51], v103 offset:4096
    s_waitcnt lgkmcnt(4)
    v_pk_add_f32 v[128:129], v[128:129], v[32:33]
    v_pk_add_f32 v[130:131], v[130:131], v[34:35]
    v_cvt_pk_bf16_f32 v64, v128, v129
    v_cvt_pk_bf16_f32 v65, v130, v131
    s_waitcnt lgkmcnt(3)
    v_pk_add_f32 v[132:133], v[132:133], v[36:37]
    v_pk_add_f32 v[134:135], v[134:135], v[38:39]
    v_cvt_pk_bf16_f32 v66, v132, v133
    v_cvt_pk_bf16_f32 v67, v134, v135
    s_waitcnt lgkmcnt(2)
    v_pk_add_f32 v[136:137], v[136:137], v[40:41]
    v_pk_add_f32 v[138:139], v[138:139], v[42:43]
    v_cvt_pk_bf16_f32 v68, v136, v137
    v_cvt_pk_bf16_f32 v69, v138, v139
    s_waitcnt lgkmcnt(1)
    v_pk_add_f32 v[140:141], v[140:141], v[44:45]
    v_pk_add_f32 v[142:143], v[142:143], v[46:47]
    v_cvt_pk_bf16_f32 v70, v140, v141
    v_cvt_pk_bf16_f32 v71, v142, v143
    s_waitcnt lgkmcnt(0)
    v_pk_add_f32 v[144:145], v[144:145], v[48:49]
    v_pk_add_f32 v[146:147], v[146:147], v[50:51]
    v_cvt_pk_bf16_f32 v72, v144, v145
    v_cvt_pk_bf16_f32 v73, v146, v147
    v_lshlrev_b32 v2, 16, v64
    v_and_b32 v3, 0xffff0000, v64
    v_lshlrev_b32 v4, 16, v65
    v_and_b32 v5, 0xffff0000, v65
    v_lshlrev_b32 v6, 16, v66
    v_and_b32 v7, 0xffff0000, v66
    v_lshlrev_b32 v8, 16, v67
    v_and_b32 v9, 0xffff0000, v67
    v_lshlrev_b32 v10, 16, v68
    v_and_b32 v11, 0xffff0000, v68
    v_lshlrev_b32 v12, 16, v69
    v_and_b32 v13, 0xffff0000, v69
    v_lshlrev_b32 v14, 16, v70
    v_and_b32 v15, 0xffff0000, v70
    v_lshlrev_b32 v16, 16, v71
    v_and_b32 v17, 0xffff0000, v71
    v_lshlrev_b32 v18, 16, v72
    v_and_b32 v19, 0xffff0000, v72
    v_lshlrev_b32 v20, 16, v73
    v_and_b32 v21, 0xffff0000, v73
    v_permlane16_swap_b32 v64, v66
    v_permlane16_swap_b32 v65, v67
    v_permlane16_swap_b32 v68, v70
    v_permlane16_swap_b32 v69, v71
    s_cmp_eq_u32 s47, 0
    s_cbranch_scc1 L_nf
    buffer_store_dwordx2 v[72:73], v91, s[40:43], s58 offen
    buffer_store_dwordx4 v[64:67], v90, s[40:43], s58 offen
    buffer_store_dwordx4 v[68:71], v90, s[40:43], s59 offen
    s_endpgm
L_nf:
    buffer_store_dwordx2 v[72:73], v91, s[40:43], s58 offen sc1
    buffer_store_dwordx4 v[64:67], v90, s[40:43], s58 offen sc1
    buffer_store_dwordx4 v[68:71], v90, s[40:43], s59 offen sc1
    v_pk_add_f32 v[32:33], v[2:3], v[4:5]
    v_pk_mul_f32 v[34:35], v[2:3], v[2:3]
    v_pk_fma_f32 v[34:35], v[4:5], v[4:5], v[34:35]
    v_pk_add_f32 v[32:33], v[32:33], v[6:7]
    v_pk_fma_f32 v[34:35], v[6:7], v[6:7], v[34:35]
    v_pk_add_f32 v[32:33], v[32:33], v[8:9]
    v_pk_fma_f32 v[34:35], v[8:9], v[8:9], v[34:35]
    v_pk_add_f32 v[32:33], v[32:33], v[10:11]
    v_pk_fma_f32 v[34:35], v[10:11], v[10:11], v[34:35]
    v_pk_add_f32 v[32:33], v[32:33], v[12:13]
    v_pk_fma_f32 v[34:35], v[12:13], v[12:13], v[34:35]
    v_pk_add_f32 v[32:33], v[32:33], v[14:15]
    v_pk_fma_f32 v[34:35], v[14:15], v[14:15], v[34:35]
    v_pk_add_f32 v[32:33], v[32:33], v[16:17]
    v_pk_fma_f32 v[34:35], v[16:17], v[16:17], v[34:35]
    v_pk_add_f32 v[32:33], v[32:33], v[18:19]
    v_pk_fma_f32 v[34:35], v[18:19], v[18:19], v[34:35]
    v_pk_add_f32 v[32:33], v[32:33], v[20:21]
    v_pk_fma_f32 v[34:35], v[20:21], v[20:21], v[34:35]
    v_add_f32 v32, v32, v33
    v_add_f32 v34, v34, v35
    s_nop 1
    v_permlane32_swap_b32 v32, v34
    s_nop 1
    v_add_f32 v32, v32, v34
    v_mov_b32 v34, v32
    s_nop 1
    v_permlane16_swap_b32 v32, v34
    s_nop 1
    v_add_f32 v32, v32, v34
    buffer_store_dword v32, v96, s[4:7], s101 offen sc1
    s_waitcnt vmcnt(0)
    s_barrier
    s_cmp_lg_u32 s47, 0
    s_cbranch_scc1 L_end
    s_mov_b32 s47, 0x1
    s_mov_b32 s49, 0x2000000
    s_add_u32 s50, s50, 5
    s_branch L_c
L_a:
    s_setprio 3
L_a0:
    s_cmp_lg_u32 s45, 15
    s_cbranch_scc1 L_a01
    s_barrier
    s_branch L_a1
L_a01:
    s_and_b32 s57, s46, 1
    s_lshl_b32 s52, s57, 13
    v_lshl_add_u32 v34, v0, 4, s52
    v_mov_b32 v35, v34
    s_lshl_b32 s52, s57, 6
    v_add_u32 v100, s52, v0
    s_mul_i32 s99, s44, 163840
    s_mov_b32 s100, 0x400
    s_mov_b32 s101, 0x2000
    s_mov_b32 s40, s4
    s_mov_b32 s41, s5
    s_mov_b32 s42, s6
    s_mov_b32 s43, s7
    s_cmp_eq_u32 s47, 0
    s_cbranch_scc0 .pl21
    s_mov_b32 s40, s8
    s_mov_b32 s41, s9
    s_mov_b32 s42, s10
    s_mov_b32 s43, s11
    s_mov_b32 s100, 0x2800
    s_mov_b32 s101, -81792
    v_lshrrev_b32 v101, 3, v0
    v_add_u32 v101, s52, v101
    v_mul_u32_u24 v101, 1280, v101
    v_lshrrev_b32 v102, 4, v0
    v_and_b32 v103, 7, v0
    v_xor_b32 v102, v102, v103
    v_lshl_add_u32 v34, v102, 4, v101
    v_xor_b32 v35, 64, v34
    s_branch .jn22
.pl21:
    s_add_u32 s99, s99, 0x1700000
    v_and_b32 v30, 15, v0
    s_lshl_b32 s53, s44, 4
    s_add_u32 s53, s53, s45
    s_mul_i32 s53, s53, 128
    s_add_u32 s53, s53, 0x5000000
    v_lshl_add_u32 v30, v30, 2, s53
    s_add_u32 s53, s50, 0x9e3779b0
    s_mov_b32 s57, 0x10000
.poll23:
    buffer_load_dword v23, v30, s[4:7], s57 offen sc1
    s_sub_u32 s48, s48, 1
    s_cbranch_scc1 .pd24t
    s_and_b32 s57, s48, 63
    s_cselect_b32 s57, 0x10000, 0
    s_waitcnt vmcnt(0)
    v_subrev_u32 v32, s53, v23
    v_cmp_lt_u32 vcc, 11, v32
    s_cmp_eq_u64 vcc, 0
    s_cbranch_scc1 .pd24
    s_branch .poll23
.pd24t:
    s_mov_b32 s48, 0x0
    s_waitcnt vmcnt(0)
.pd24:
.jn22:
    s_and_b32 s57, s46, 1
    s_lshl_b32 s57, s57, 13
    s_mov_b32 s97, 0x17000
    s_mov_b32 s98, 0x17000
    s_mov_b32 s96, 0x2
.ai25:
    s_add_u32 m0, s97, s57
    s_nop 0
    buffer_load_dwordx4 v34, s[40:43], s99 offen sc1 lds
    s_add_u32 m0, m0, 0x400
    s_add_u32 s99, s99, s100
    buffer_load_dwordx4 v35, s[40:43], s99 offen sc1 lds
    s_add_u32 m0, m0, 0x400
    s_add_u32 s99, s99, s100
    buffer_load_dwordx4 v34, s[40:43], s99 offen sc1 lds
    s_add_u32 m0, m0, 0x400
    s_add_u32 s99, s99, s100
    buffer_load_dwordx4 v35, s[40:43], s99 offen sc1 lds
    s_add_u32 m0, m0, 0x400
    s_add_u32 s99, s99, s100
    buffer_load_dwordx4 v34, s[40:43], s99 offen sc1 lds
    s_add_u32 m0, m0, 0x400
    s_add_u32 s99, s99, s100
    buffer_load_dwordx4 v35, s[40:43], s99 offen sc1 lds
    s_add_u32 m0, m0, 0x400
    s_add_u32 s99, s99, s100
    buffer_load_dwordx4 v34, s[40:43], s99 offen sc1 lds
    s_add_u32 m0, m0, 0x400
    s_add_u32 s99, s99, s100
    buffer_load_dwordx4 v35, s[40:43], s99 offen sc1 lds
    s_add_u32 s99, s99, s100
    s_add_u32 s99, s99, s101
    s_add_u32 s97, s97, 0x4000
    s_cmp_eq_u32 s97, 0x27000
    s_cselect_b32 s97, 0x17000, s97
    s_sub_u32 s96, s96, 1
    s_cmp_lg_u32 s96, 0
    s_cbranch_scc1 .ai25
    s_waitcnt vmcnt(8)
    s_barrier
    s_mov_b32 s96, 0x2
.ai26:
    s_add_u32 m0, s97, s57
    s_nop 0
    buffer_load_dwordx4 v34, s[40:43], s99 offen sc1 lds
    s_add_u32 m0, m0, 0x400
    s_add_u32 s99, s99, s100
    buffer_load_dwordx4 v35, s[40:43], s99 offen sc1 lds
    s_add_u32 m0, m0, 0x400
    s_add_u32 s99, s99, s100
    buffer_load_dwordx4 v34, s[40:43], s99 offen sc1 lds
    s_add_u32 m0, m0, 0x400
    s_add_u32 s99, s99, s100
    buffer_load_dwordx4 v35, s[40:43], s99 offen sc1 lds
    s_add_u32 m0, m0, 0x400
    s_add_u32 s99, s99, s100
    buffer_load_dwordx4 v34, s[40:43], s99 offen sc1 lds
    s_add_u32 m0, m0, 0x400
    s_add_u32 s99, s99, s100
    buffer_load_dwordx4 v35, s[40:43], s99 offen sc1 lds
    s_add_u32 m0, m0, 0x400
    s_add_u32 s99, s99, s100
    buffer_load_dwordx4 v34, s[40:43], s99 offen sc1 lds
    s_add_u32 m0, m0, 0x400
    s_add_u32 s99, s99, s100
    buffer_load_dwordx4 v35, s[40:43], s99 offen sc1 lds
    s_add_u32 s99, s99, s100
    s_add_u32 s99, s99, s101
    s_add_u32 s97, s97, 0x4000
    s_cmp_eq_u32 s97, 0x27000
    s_cselect_b32 s97, 0x17000, s97
    s_sub_u32 s96, s96, 1
    s_cmp_lg_u32 s96, 0
    s_cbranch_scc1 .ai26
    s_branch .hs28
.hl27:
    s_barrier
    s_cmp_gt_u32 s96, 6
    s_cbranch_scc1 .hs28
    s_add_u32 m0, s97, s57
    s_nop 0
    buffer_load_dwordx4 v34, s[40:43], s99 offen sc1 lds
    s_add_u32 m0, m0, 0x400
    s_add_u32 s99, s99, s100
    buffer_load_dwordx4 v35, s[40:43], s99 offen sc1 lds
    s_add_u32 m0, m0, 0x400
    s_add_u32 s99, s99, s100
    buffer_load_dwordx4 v34, s[40:43], s99 offen sc1 lds
    s_add_u32 m0, m0, 0x400
    s_add_u32 s99, s99, s100
    buffer_load_dwordx4 v35, s[40:43], s99 offen sc1 lds
    s_add_u32 m0, m0, 0x400
    s_add_u32 s99, s99, s100
    buffer_load_dwordx4 v34, s[40:43], s99 offen sc1 lds
    s_add_u32 m0, m0, 0x400
    s_add_u32 s99, s99, s100
    buffer_load_dwordx4 v35, s[40:43], s99 offen sc1 lds
    s_add_u32 m0, m0, 0x400
    s_add_u32 s99, s99, s100
    buffer_load_dwordx4 v34, s[40:43], s99 offen sc1 lds
    s_add_u32 m0, m0, 0x400
    s_add_u32 s99, s99, s100
    buffer_load_dwordx4 v35, s[40:43], s99 offen sc1 lds
    s_add_u32 s99, s99, s100
    s_add_u32 s99, s99, s101
    s_add_u32 s97, s97, 0x4000
    s_cmp_eq_u32 s97, 0x27000
    s_cselect_b32 s97, 0x17000, s97
.hs28:
    s_add_u32 s96, s96, 1
    s_waitcnt vmcnt(16)
    s_cmp_lt_u32 s96, 8
    s_cbranch_scc1 .hl27
    s_waitcnt vmcnt(8)
    s_cmp_lt_u32 s96, 9
    s_cbranch_scc1 .hl27
    s_waitcnt vmcnt(0)
    s_cmp_lt_u32 s96, 10
    s_cbranch_scc1 .hl27
    s_barrier
L_a1:
    v_mov_b32 v2, 0
    v_mov_b32 v3, 0
    v_mov_b32 v4, 0
    v_mov_b32 v5, 0
    v_mov_b32 v6, 0
    v_mov_b32 v7, 0
    v_mov_b32 v8, 0
    v_mov_b32 v9, 0
    v_mov_b32 v10, 0
    v_mov_b32 v11, 0
    v_mov_b32 v12, 0
    v_mov_b32 v13, 0
    v_mov_b32 v14, 0
    v_mov_b32 v15, 0
    v_mov_b32 v16, 0
    v_mov_b32 v17, 0
    v_mov_b32 v18, 0
    v_mov_b32 v19, 0
    v_mov_b32 v20, 0
    v_mov_b32 v21, 0
    v_mov_b32 v22, 0
    s_waitcnt lgkmcnt(0)
    s_mul_i32 s52, s44, 512
    s_add_u32 s52, s52, s45
    s_lshl_b32 s52, s52, 2
    s_add_u32 s52, s52, 0x5000000
    s_add_u32 s53, s50, 0x9e3779b1
    v_mul_u32_u24 v30, 128, v0
    v_mov_b32 v31, s53
    s_barrier
    s_cmp_lg_u32 s46, 4
    s_cbranch_scc1 .np29
    s_mov_b64 exec, 0xffff
    s_add_u32 s53, s52, 0x10000
    buffer_store_dword v31, v30, s[4:7], s53 offen
    buffer_store_dword v31, v30, s[4:7], s52 offen sc1
    s_mov_b64 exec, -1
.np29:
L_attl:
    s_sub_u32 s54, s46, 4
    s_min_u32 s55, s54, 2
    s_add_u32 s52, s44, s55
    s_sub_i32 s52, s52, 2
    s_cmp_lt_i32 s52, 0
    s_cselect_b32 s53, 0x20000000, 0
    s_cselect_b32 s52, s44, s52
    v_lshl_add_u32 v34, v0, 4, s53
    s_cmp_lg_u32 s47, 0
    s_cbranch_scc1 .hs30
    v_and_b32 v30, 31, v0
    v_lshrrev_b32 v31, 5, v0
    v_lshlrev_b32 v31, 2, v31
    v_sub_u32 v30, v30, v31
    v_cmp_gt_i32 s[64:65], 0, v30
    v_cmp_gt_i32 s[66:67], 1, v30
    v_cmp_gt_i32 s[68:69], 2, v30
    v_cmp_gt_i32 s[70:71], 3, v30
    v_cmp_gt_i32 s[72:73], 8, v30
    v_cmp_gt_i32 s[74:75], 9, v30
    v_cmp_gt_i32 s[76:77], 10, v30
    v_cmp_gt_i32 s[78:79], 11, v30
    v_cmp_gt_i32 s[80:81], 16, v30
    v_cmp_gt_i32 s[82:83], 17, v30
    v_cmp_gt_i32 s[84:85], 18, v30
    v_cmp_gt_i32 s[86:87], 19, v30
    v_cmp_gt_i32 s[88:89], 24, v30
    v_cmp_gt_i32 s[90:91], 25, v30
    v_cmp_gt_i32 s[92:93], 26, v30
    v_cmp_gt_i32 s[94:95], 27, v30
    v_mov_b32 v30, 0x3f803f80
    v_mov_b32 v31, v30
    v_lshlrev_b32 v32, 3, v0
    v_add_u32 v32, 0x27800, v32
    ds_write_b64 v32, v[30:31]
    s_waitcnt lgkmcnt(0)
.hs30:
    s_mov_b32 s56, s52
    s_mul_i32 s52, s52, 491520
    s_mul_i32 s53, s45, 10240
    s_add_u32 s52, s52, s53
    s_add_u32 s52, s52, s49
    s_add_u32 s52, s52, 0x100000
    v_and_b32 v30, 15, v0
    s_lshl_b32 s53, s56, 4
    s_add_u32 s53, s53, s45
    s_mul_i32 s53, s53, 128
    s_add_u32 s53, s53, 0x5000000
    v_lshl_add_u32 v30, v30, 2, s53
    s_add_u32 s53, s50, 0x9e3779b1
    s_xor_b32 s57, s56, s44
    s_cmp_lt_u32 s57, 2
    s_cselect_b32 s58, 63, 0
    s_cselect_b32 s57, 0x10000, 0
.poll33:
    buffer_load_dword v23, v30, s[4:7], s57 offen sc1
    s_sub_u32 s48, s48, 1
    s_cbranch_scc1 .pd34t
    s_and_b32 s57, s48, s58
    s_cselect_b32 s57, 0x10000, 0
    s_waitcnt vmcnt(0)
    v_subrev_u32 v32, s53, v23
    v_cmp_lt_u32 vcc, 11, v32
    s_cmp_eq_u64 vcc, 0
    s_cbranch_scc1 .pd34
    s_branch .poll33
.pd34t:
    s_mov_b32 s48, 0x0
    s_waitcnt vmcnt(0)
.pd34:
    s_cmp_eq_u32 s54, 3
    s_cbranch_scc1 .lq31
    s_lshl_b32 s55, s55, 11
    s_add_u32 m0, s55, 0x15580
    s_add_u32 s52, s52, 163840
    buffer_load_dwordx4 v34, s[4:7], s52 offen sc1 lds
    buffer_load_dwordx4 v34, s[4:7], s52 offen offset:1024 sc1 lds
    s_add_u32 m0, m0, 6208
    s_add_u32 s52, s52, 2048
    buffer_load_dwordx4 v34, s[4:7], s52 offen sc1 lds
    buffer_load_dwordx4 v34, s[4:7], s52 offen offset:1024 sc1 lds
    s_add_u32 m0, m0, 6208
    s_add_u32 s52, s52, 2048
    buffer_load_dwordx4 v34, s[4:7], s52 offen sc1 lds
    buffer_load_dwordx4 v34, s[4:7], s52 offen offset:1024 sc1 lds
    s_add_u32 m0, m0, 6208
    s_add_u32 s52, s52, 2048
    buffer_load_dwordx4 v34, s[4:7], s52 offen sc1 lds
    buffer_load_dwordx4 v34, s[4:7], s52 offen offset:1024 sc1 lds
    s_add_u32 m0, m0, 6208
    s_add_u32 s52, s52, 2048
    buffer_load_dwordx4 v34, s[4:7], s52 offen sc1 lds
    buffer_load_dwordx4 v34, s[4:7], s52 offen offset:1024 sc1 lds
    s_add_u32 m0, m0, 6208
    s_add_u32 s52, s52, 155648
    buffer_load_dwordx4 v34, s[4:7], s52 offen sc1 lds
    buffer_load_dwordx4 v34, s[4:7], s52 offen offset:1024 sc1 lds
    s_add_u32 m0, m0, 6208
    s_add_u32 s52, s52, 2048
    buffer_load_dwordx4 v34, s[4:7], s52 offen sc1 lds
    buffer_load_dwordx4 v34, s[4:7], s52 offen offset:1024 sc1 lds
    s_add_u32 m0, m0, 6208
    s_add_u32 s52, s52, 2048
    buffer_load_dwordx4 v34, s[4:7], s52 offen sc1 lds
    buffer_load_dwordx4 v34, s[4:7], s52 offen offset:1024 sc1 lds
    s_add_u32 m0, m0, 6208
    s_add_u32 s52, s52, 2048
    buffer_load_dwordx4 v34, s[4:7], s52 offen sc1 lds
    buffer_load_dwordx4 v34, s[4:7], s52 offen offset:1024 sc1 lds
    s_add_u32 m0, m0, 6208
    s_add_u32 s52, s52, 2048
    buffer_load_dwordx4 v34, s[4:7], s52 offen sc1 lds
    buffer_load_dwordx4 v34, s[4:7], s52 offen offset:1024 sc1 lds
    s_branch .ld32
.lq31:
    s_mov_b32 m0, 0x24800
    s_add_u32 s52, s52, 0
    buffer_load_dwordx4 v34, s[4:7], s52 offen sc1 lds
    buffer_load_dwordx4 v34, s[4:7], s52 offen offset:1024 sc1 lds
    s_mov_b32 m0, 0x25000
    s_add_u32 s52, s52, 2048
    buffer_load_dwordx4 v34, s[4:7], s52 offen sc1 lds
    buffer_load_dwordx4 v34, s[4:7], s52 offen offset:1024 sc1 lds
    s_mov_b32 m0, 0x25800
    s_add_u32 s52, s52, 2048
    buffer_load_dwordx4 v34, s[4:7], s52 offen sc1 lds
    buffer_load_dwordx4 v34, s[4:7], s52 offen offset:1024 sc1 lds
    s_mov_b32 m0, 0x26000
    s_add_u32 s52, s52, 2048
    buffer_load_dwordx4 v34, s[4:7], s52 offen sc1 lds
    buffer_load_dwordx4 v34, s[4:7], s52 offen offset:1024 sc1 lds
    s_mov_b32 m0, 0x26800
    s_add_u32 s52, s52, 2048
    buffer_load_dwordx4 v34, s[4:7], s52 offen sc1 lds
    buffer_load_dwordx4 v34, s[4:7], s52 offen offset:1024 sc1 lds
    s_waitcnt vmcnt(0)
.ld32:
    s_branch L_att
L_a2:
    s_setprio 3
    s_cmp_lg_u32 s46, 4
    s_cbranch_scc1 .np35
    s_mov_b64 exec, 0xffff
    s_add_u32 s53, s52, 0x10000
    buffer_store_dword v31, v30, s[4:7], s53 offen
    buffer_store_dword v31, v30, s[4:7], s52 offen sc1
    s_mov_b64 exec, -1
.np35:
    v_lshlrev_b32 v34, 4, v0
    s_mul_i32 s99, s44, 163840
    s_add_u32 s99, s99, 0x900000
    s_add_u32 s99, s99, s49
    s_lshr_b32 s52, s45, 3
    s_lshl_b32 s52, s52, 10
    s_add_u32 s99, s99, s52
    s_and_b32 s100, s46, 1
    s_lshl_b32 s52, s100, 13
    s_add_u32 s99, s99, s52
    s_lshl_b32 s100, s100, 12
    s_mov_b32 s97, 0x19000
    v_and_b32 v30, 15, v0
    s_lshl_b32 s53, s44, 4
    s_add_u32 s53, s53, s45
    s_mul_i32 s53, s53, 128
    s_add_u32 s53, s53, 0x5000000
    v_lshl_add_u32 v30, v30, 2, s53
    s_add_u32 s53, s50, 0x9e3779b2
    s_mov_b32 s57, 0x10000
.poll36:
    buffer_load_dword v23, v30, s[4:7], s57 offen sc1
    s_sub_u32 s48, s48, 1
    s_cbranch_scc1 .pd37t
    s_and_b32 s57, s48, 63
    s_cselect_b32 s57, 0x10000, 0
    s_waitcnt vmcnt(0)
    v_subrev_u32 v32, s53, v23
    v_cmp_lt_u32 vcc, 11, v32
    s_cmp_eq_u64 vcc, 0
    s_cbranch_scc1 .pd37
    s_branch .poll36
.pd37t:
    s_mov_b32 s48, 0x0
    s_waitcnt vmcnt(0)
.pd37:
    s_mov_b32 s96, 0x2
.ai38:
    s_add_u32 m0, s97, s100
    s_nop 0
    buffer_load_dwordx4 v34, s[4:7], s99 offen sc1 lds
    s_add_u32 m0, m0, 0x400
    s_add_u32 s99, s99, 2048
    buffer_load_dwordx4 v34, s[4:7], s99 offen sc1 lds
    s_add_u32 m0, m0, 0x400
    s_add_u32 s99, s99, 2048
    buffer_load_dwordx4 v34, s[4:7], s99 offen sc1 lds
    s_add_u32 m0, m0, 0x400
    s_add_u32 s99, s99, 2048
    buffer_load_dwordx4 v34, s[4:7], s99 offen sc1 lds
    s_add_u32 s99, s99, 10240
    s_add_u32 s97, s97, 0x2000
    s_cmp_eq_u32 s97, 0x27000
    s_cselect_b32 s97, 0x19000, s97
    s_sub_u32 s96, s96, 1
    s_cmp_lg_u32 s96, 0
    s_cbranch_scc1 .ai38
    s_waitcnt vmcnt(4)
    s_barrier
    s_mov_b32 s96, 0x5
.ai39:
    s_add_u32 m0, s97, s100
    s_nop 0
    buffer_load_dwordx4 v34, s[4:7], s99 offen sc1 lds
    s_add_u32 m0, m0, 0x400
    s_add_u32 s99, s99, 2048
    buffer_load_dwordx4 v34, s[4:7], s99 offen sc1 lds
    s_add_u32 m0, m0, 0x400
    s_add_u32 s99, s99, 2048
    buffer_load_dwordx4 v34, s[4:7], s99 offen sc1 lds
    s_add_u32 m0, m0, 0x400
    s_add_u32 s99, s99, 2048
    buffer_load_dwordx4 v34, s[4:7], s99 offen sc1 lds
    s_add_u32 s99, s99, 10240
    s_add_u32 s97, s97, 0x2000
    s_cmp_eq_u32 s97, 0x27000
    s_cselect_b32 s97, 0x19000, s97
    s_sub_u32 s96, s96, 1
    s_cmp_lg_u32 s96, 0
    s_cbranch_scc1 .ai39
    s_branch .hs41
.hl40:
    s_barrier
    s_cmp_gt_u32 s96, 3
    s_cbranch_scc1 .hs41
    s_add_u32 m0, s97, s100
    s_nop 0
    buffer_load_dwordx4 v34, s[4:7], s99 offen sc1 lds
    s_add_u32 m0, m0, 0x400
    s_add_u32 s99, s99, 2048
    buffer_load_dwordx4 v34, s[4:7], s99 offen sc1 lds
    s_add_u32 m0, m0, 0x400
    s_add_u32 s99, s99, 2048
    buffer_load_dwordx4 v34, s[4:7], s99 offen sc1 lds
    s_add_u32 m0, m0, 0x400
    s_add_u32 s99, s99, 2048
    buffer_load_dwordx4 v34, s[4:7], s99 offen sc1 lds
    s_add_u32 s99, s99, 10240
    s_add_u32 s97, s97, 0x2000
    s_cmp_eq_u32 s97, 0x27000
    s_cselect_b32 s97, 0x19000, s97
.hs41:
    s_add_u32 s96, s96, 1
    s_waitcnt vmcnt(20)
    s_cmp_lt_u32 s96, 5
    s_cbranch_scc1 .hl40
    s_waitcnt vmcnt(16)
    s_cmp_lt_u32 s96, 6
    s_cbranch_scc1 .hl40
    s_waitcnt vmcnt(12)
    s_cmp_lt_u32 s96, 7
    s_cbranch_scc1 .hl40
    s_waitcnt vmcnt(8)
    s_cmp_lt_u32 s96, 8
    s_cbranch_scc1 .hl40
    s_waitcnt vmcnt(4)
    s_cmp_lt_u32 s96, 9
    s_cbranch_scc1 .hl40
    s_waitcnt vmcnt(0)
    s_cmp_lt_u32 s96, 10
    s_cbranch_scc1 .hl40
    s_barrier
    s_barrier
    s_mul_i32 s52, s44, 512
    s_add_u32 s52, s52, s45
    s_lshl_b32 s52, s52, 2
    s_add_u32 s52, s52, 0x5000000
    s_add_u32 s53, s50, 0x9e3779b3
    v_mul_u32_u24 v30, 128, v0
    v_mov_b32 v31, s53
    s_barrier
    s_cmp_lg_u32 s46, 4
    s_cbranch_scc1 .np42
    s_mov_b64 exec, 0xffff
    s_add_u32 s53, s52, 0x10000
    buffer_store_dword v31, v30, s[4:7], s53 offen
    buffer_store_dword v31, v30, s[4:7], s52 offen sc1
    s_mov_b64 exec, -1
.np42:
    s_and_b32 s57, s46, 1
    s_lshl_b32 s52, s57, 13
    v_lshl_add_u32 v34, v0, 4, s52
    v_mov_b32 v35, v34
    s_lshl_b32 s52, s57, 6
    v_add_u32 v100, s52, v0
    s_mul_i32 s99, s44, 163840
    s_mov_b32 s100, 0x400
    s_mov_b32 s101, 0x2000
    s_mov_b32 s40, s4
    s_mov_b32 s41, s5
    s_mov_b32 s42, s6
    s_mov_b32 s43, s7
    s_add_u32 s99, s99, 0xc00000
    s_add_u32 s99, s99, s49
    v_and_b32 v30, 15, v0
    s_lshl_b32 s53, s44, 4
    s_add_u32 s53, s53, s45
    s_mul_i32 s53, s53, 128
    s_add_u32 s53, s53, 0x5000000
    v_lshl_add_u32 v30, v30, 2, s53
    s_add_u32 s53, s50, 0x9e3779b3
    s_mov_b32 s57, 0x10000
.poll43:
    buffer_load_dword v23, v30, s[4:7], s57 offen sc1
    s_sub_u32 s48, s48, 1
    s_cbranch_scc1 .pd44t
    s_and_b32 s57, s48, 63
    s_cselect_b32 s57, 0x10000, 0
    s_waitcnt vmcnt(0)
    v_subrev_u32 v32, s53, v23
    v_cmp_lt_u32 vcc, 11, v32
    s_cmp_eq_u64 vcc, 0
    s_cbranch_scc1 .pd44
    s_branch .poll43
.pd44t:
    s_mov_b32 s48, 0x0
    s_waitcnt vmcnt(0)
.pd44:
    s_and_b32 s57, s46, 1
    s_lshl_b32 s57, s57, 13
    s_mov_b32 s97, 0x17000
    s_mov_b32 s98, 0x17000
    s_mov_b32 s96, 0x2
.ai45:
    s_add_u32 m0, s97, s57
    s_nop 0
    buffer_load_dwordx4 v34, s[40:43], s99 offen sc1 lds
    s_add_u32 m0, m0, 0x400
    s_add_u32 s99, s99, s100
    buffer_load_dwordx4 v35, s[40:43], s99 offen sc1 lds
    s_add_u32 m0, m0, 0x400
    s_add_u32 s99, s99, s100
    buffer_load_dwordx4 v34, s[40:43], s99 offen sc1 lds
    s_add_u32 m0, m0, 0x400
    s_add_u32 s99, s99, s100
    buffer_load_dwordx4 v35, s[40:43], s99 offen sc1 lds
    s_add_u32 m0, m0, 0x400
    s_add_u32 s99, s99, s100
    buffer_load_dwordx4 v34, s[40:43], s99 offen sc1 lds
    s_add_u32 m0, m0, 0x400
    s_add_u32 s99, s99, s100
    buffer_load_dwordx4 v35, s[40:43], s99 offen sc1 lds
    s_add_u32 m0, m0, 0x400
    s_add_u32 s99, s99, s100
    buffer_load_dwordx4 v34, s[40:43], s99 offen sc1 lds
    s_add_u32 m0, m0, 0x400
    s_add_u32 s99, s99, s100
    buffer_load_dwordx4 v35, s[40:43], s99 offen sc1 lds
    s_add_u32 s99, s99, s100
    s_add_u32 s99, s99, s101
    s_add_u32 s97, s97, 0x4000
    s_cmp_eq_u32 s97, 0x27000
    s_cselect_b32 s97, 0x17000, s97
    s_sub_u32 s96, s96, 1
    s_cmp_lg_u32 s96, 0
    s_cbranch_scc1 .ai45
    s_waitcnt vmcnt(8)
    s_barrier
    s_mov_b32 s96, 0x2
.ai46:
    s_add_u32 m0, s97, s57
    s_nop 0
    buffer_load_dwordx4 v34, s[40:43], s99 offen sc1 lds
    s_add_u32 m0, m0, 0x400
    s_add_u32 s99, s99, s100
    buffer_load_dwordx4 v35, s[40:43], s99 offen sc1 lds
    s_add_u32 m0, m0, 0x400
    s_add_u32 s99, s99, s100
    buffer_load_dwordx4 v34, s[40:43], s99 offen sc1 lds
    s_add_u32 m0, m0, 0x400
    s_add_u32 s99, s99, s100
    buffer_load_dwordx4 v35, s[40:43], s99 offen sc1 lds
    s_add_u32 m0, m0, 0x400
    s_add_u32 s99, s99, s100
    buffer_load_dwordx4 v34, s[40:43], s99 offen sc1 lds
    s_add_u32 m0, m0, 0x400
    s_add_u32 s99, s99, s100
    buffer_load_dwordx4 v35, s[40:43], s99 offen sc1 lds
    s_add_u32 m0, m0, 0x400
    s_add_u32 s99, s99, s100
    buffer_load_dwordx4 v34, s[40:43], s99 offen sc1 lds
    s_add_u32 m0, m0, 0x400
    s_add_u32 s99, s99, s100
    buffer_load_dwordx4 v35, s[40:43], s99 offen sc1 lds
    s_add_u32 s99, s99, s100
    s_add_u32 s99, s99, s101
    s_add_u32 s97, s97, 0x4000
    s_cmp_eq_u32 s97, 0x27000
    s_cselect_b32 s97, 0x17000, s97
    s_sub_u32 s96, s96, 1
    s_cmp_lg_u32 s96, 0
    s_cbranch_scc1 .ai46
    s_branch .hs48
.hl47:
    s_barrier
    s_cmp_gt_u32 s96, 6
    s_cbranch_scc1 .hs48
    s_add_u32 m0, s97, s57
    s_nop 0
    buffer_load_dwordx4 v34, s[40:43], s99 offen sc1 lds
    s_add_u32 m0, m0, 0x400
    s_add_u32 s99, s99, s100
    buffer_load_dwordx4 v35, s[40:43], s99 offen sc1 lds
    s_add_u32 m0, m0, 0x400
    s_add_u32 s99, s99, s100
    buffer_load_dwordx4 v34, s[40:43], s99 offen sc1 lds
    s_add_u32 m0, m0, 0x400
    s_add_u32 s99, s99, s100
    buffer_load_dwordx4 v35, s[40:43], s99 offen sc1 lds
    s_add_u32 m0, m0, 0x400
    s_add_u32 s99, s99, s100
    buffer_load_dwordx4 v34, s[40:43], s99 offen sc1 lds
    s_add_u32 m0, m0, 0x400
    s_add_u32 s99, s99, s100
    buffer_load_dwordx4 v35, s[40:43], s99 offen sc1 lds
    s_add_u32 m0, m0, 0x400
    s_add_u32 s99, s99, s100
    buffer_load_dwordx4 v34, s[40:43], s99 offen sc1 lds
    s_add_u32 m0, m0, 0x400
    s_add_u32 s99, s99, s100
    buffer_load_dwordx4 v35, s[40:43], s99 offen sc1 lds
    s_add_u32 s99, s99, s100
    s_add_u32 s99, s99, s101
    s_add_u32 s97, s97, 0x4000
    s_cmp_eq_u32 s97, 0x27000
    s_cselect_b32 s97, 0x17000, s97
.hs48:
    s_add_u32 s96, s96, 1
    s_waitcnt vmcnt(16)
    s_cmp_lt_u32 s96, 8
    s_cbranch_scc1 .hl47
    s_waitcnt vmcnt(8)
    s_cmp_lt_u32 s96, 9
    s_cbranch_scc1 .hl47
    s_waitcnt vmcnt(0)
    s_cmp_lt_u32 s96, 10
    s_cbranch_scc1 .hl47
    s_barrier
    s_mul_i32 s52, s44, 512
    s_add_u32 s52, s52, s45
    s_lshl_b32 s52, s52, 2
    s_add_u32 s52, s52, 0x5000000
    s_add_u32 s53, s50, 0x9e3779b4
    v_mul_u32_u24 v30, 128, v0
    v_mov_b32 v31, s53
    s_barrier
    s_cmp_lg_u32 s46, 4
    s_cbranch_scc1 .np49
    s_mov_b64 exec, 0xffff
    s_add_u32 s53, s52, 0x10000
    buffer_store_dword v31, v30, s[4:7], s53 offen
    buffer_store_dword v31, v30, s[4:7], s52 offen sc1
    s_mov_b64 exec, -1
.np49:
    v_lshlrev_b32 v34, 4, v0
    s_mul_i32 s99, s44, 442368
    s_add_u32 s99, s99, 0xf00000
    s_add_u32 s99, s99, s49
    s_lshr_b32 s52, s45, 3
    s_lshl_b32 s52, s52, 10
    s_add_u32 s99, s99, s52
    s_and_b32 s100, s46, 1
    s_lshl_b32 s52, s100, 13
    s_add_u32 s99, s99, s52
    s_lshl_b32 s100, s100, 12
    s_mov_b32 s97, 0x19000
    v_and_b32 v30, 15, v0
    s_lshl_b32 s53, s44, 4
    s_add_u32 s53, s53, s45
    s_mul_i32 s53, s53, 128
    s_add_u32 s53, s53, 0x5000000
    v_lshl_add_u32 v30, v30, 2, s53
    s_add_u32 s53, s50, 0x9e3779b4
    s_mov_b32 s57, 0x10000
.poll50:
    buffer_load_dword v23, v30, s[4:7], s57 offen sc1
    s_sub_u32 s48, s48, 1
    s_cbranch_scc1 .pd51t
    s_and_b32 s57, s48, 63
    s_cselect_b32 s57, 0x10000, 0
    s_waitcnt vmcnt(0)
    v_subrev_u32 v32, s53, v23
    v_cmp_lt_u32 vcc, 11, v32
    s_cmp_eq_u64 vcc, 0
    s_cbranch_scc1 .pd51
    s_branch .poll50
.pd51t:
    s_mov_b32 s48, 0x0
    s_waitcnt vmcnt(0)
.pd51:
    s_mov_b32 s96, 0x2
.ai52:
    s_add_u32 m0, s97, s100
    s_nop 0
    buffer_load_dwordx4 v34, s[4:7], s99 offen sc1 lds
    s_add_u32 m0, m0, 0x400
    s_add_u32 s99, s99, 2048
    buffer_load_dwordx4 v34, s[4:7], s99 offen sc1 lds
    s_add_u32 m0, m0, 0x400
    s_add_u32 s99, s99, 2048
    buffer_load_dwordx4 v34, s[4:7], s99 offen sc1 lds
    s_add_u32 m0, m0, 0x400
    s_add_u32 s99, s99, 2048
    buffer_load_dwordx4 v34, s[4:7], s99 offen sc1 lds
    s_add_u32 s99, s99, 10240
    s_add_u32 s97, s97, 0x2000
    s_cmp_eq_u32 s97, 0x27000
    s_cselect_b32 s97, 0x19000, s97
    s_sub_u32 s96, s96, 1
    s_cmp_lg_u32 s96, 0
    s_cbranch_scc1 .ai52
    s_waitcnt vmcnt(4)
    s_barrier
    s_mov_b32 s96, 0x5
.ai53:
    s_add_u32 m0, s97, s100
    s_nop 0
    buffer_load_dwordx4 v34, s[4:7], s99 offen sc1 lds
    s_add_u32 m0, m0, 0x400
    s_add_u32 s99, s99, 2048
    buffer_load_dwordx4 v34, s[4:7], s99 offen sc1 lds
    s_add_u32 m0, m0, 0x400
    s_add_u32 s99, s99, 2048
    buffer_load_dwordx4 v34, s[4:7], s99 offen sc1 lds
    s_add_u32 m0, m0, 0x400
    s_add_u32 s99, s99, 2048
    buffer_load_dwordx4 v34, s[4:7], s99 offen sc1 lds
    s_add_u32 s99, s99, 10240
    s_add_u32 s97, s97, 0x2000
    s_cmp_eq_u32 s97, 0x27000
    s_cselect_b32 s97, 0x19000, s97
    s_sub_u32 s96, s96, 1
    s_cmp_lg_u32 s96, 0
    s_cbranch_scc1 .ai53
    s_branch .hs55
.hl54:
    s_barrier
    s_cmp_gt_u32 s96, 20
    s_cbranch_scc1 .hs55
    s_add_u32 m0, s97, s100
    s_nop 0
    buffer_load_dwordx4 v34, s[4:7], s99 offen sc1 lds
    s_add_u32 m0, m0, 0x400
    s_add_u32 s99, s99, 2048
    buffer_load_dwordx4 v34, s[4:7], s99 offen sc1 lds
    s_add_u32 m0, m0, 0x400
    s_add_u32 s99, s99, 2048
    buffer_load_dwordx4 v34, s[4:7], s99 offen sc1 lds
    s_add_u32 m0, m0, 0x400
    s_add_u32 s99, s99, 2048
    buffer_load_dwordx4 v34, s[4:7], s99 offen sc1 lds
    s_add_u32 s99, s99, 10240
    s_add_u32 s97, s97, 0x2000
    s_cmp_eq_u32 s97, 0x27000
    s_cselect_b32 s97, 0x19000, s97
.hs55:
    s_add_u32 s96, s96, 1
    s_waitcnt vmcnt(20)
    s_cmp_lt_u32 s96, 22
    s_cbranch_scc1 .hl54
    s_waitcnt vmcnt(16)
    s_cmp_lt_u32 s96, 23
    s_cbranch_scc1 .hl54
    s_waitcnt vmcnt(12)
    s_cmp_lt_u32 s96, 24
    s_cbranch_scc1 .hl54
    s_waitcnt vmcnt(8)
    s_cmp_lt_u32 s96, 25
    s_cbranch_scc1 .hl54
    s_waitcnt vmcnt(4)
    s_cmp_lt_u32 s96, 26
    s_cbranch_scc1 .hl54
    s_waitcnt vmcnt(0)
    s_cmp_lt_u32 s96, 27
    s_cbranch_scc1 .hl54
    s_barrier
    s_barrier
    s_cmp_lg_u32 s47, 0
    s_cbranch_scc1 L_tag
    s_mul_i32 s52, s44, 512
    s_add_u32 s52, s52, s45
    s_lshl_b32 s52, s52, 2
    s_add_u32 s52, s52, 0x5000000
    s_add_u32 s53, s50, 0x9e3779b5
    v_mul_u32_u24 v30, 128, v0
    v_mov_b32 v31, s53
    s_barrier
    s_cmp_lg_u32 s46, 4
    s_cbranch_scc1 .np56
    s_mov_b64 exec, 0xffff
    s_add_u32 s53, s52, 0x10000
    buffer_store_dword v31, v30, s[4:7], s53 offen
    buffer_store_dword v31, v30, s[4:7], s52 offen sc1
    s_mov_b64 exec, -1
.np56:
    s_cmp_lg_u32 s47, 0
    s_cbranch_scc1 L_end
    s_mov_b32 s47, 0x1
    s_mov_b32 s49, 0x2000000
    s_add_u32 s50, s50, 5
    s_branch L_a0
L_winit:
    s_setprio 3
    s_and_b32 s57, s46, 1
    v_lshrrev_b32 v100, 4, v0
    v_and_b32 v101, 15, v0
    v_lshlrev_b32 v102, 2, v100
    v_xor_b32 v101, v101, v102
    v_mul_u32_u24 v100, 3840, v100
    v_lshl_add_u32 v2, v101, 4, v100
    s_mul_i32 s40, s57, 122880
    s_lshl_b32 s52, s45, 8
    s_lshl_b32 s99, s57, 13
    s_cmp_eq_u32 s45, 15
    s_cselect_b32 s14, 0, s14
    s_add_u32 s40, s40, s52
    s_mov_b32 s96, s40
    s_add_u32 m0, s99, 0x0
    s_nop 0
    buffer_load_dwordx4 v2, s[12:15], s96 offen lds
    s_add_u32 m0, s99, 0x400
    s_add_u32 s96, s96, 15360
    buffer_load_dwordx4 v2, s[12:15], s96 offen lds
    s_add_u32 m0, s99, 0x800
    s_add_u32 s96, s96, 15360
    buffer_load_dwordx4 v2, s[12:15], s96 offen lds
    s_add_u32 m0, s99, 0xc00
    s_add_u32 s96, s96, 15360
    buffer_load_dwordx4 v2, s[12:15], s96 offen lds
    s_add_u32 m0, s99, 0x1000
    s_add_u32 s96, s96, 15360
    buffer_load_dwordx4 v2, s[12:15], s96 offen lds
    s_add_u32 m0, s99, 0x1400
    s_add_u32 s96, s96, 15360
    buffer_load_dwordx4 v2, s[12:15], s96 offen lds
    s_add_u32 m0, s99, 0x1800
    s_add_u32 s96, s96, 15360
    buffer_load_dwordx4 v2, s[12:15], s96 offen lds
    s_add_u32 m0, s99, 0x1c00
    s_add_u32 s96, s96, 15360
    buffer_load_dwordx4 v2, s[12:15], s96 offen lds
    s_add_u32 m0, s99, 0x4000
    s_add_u32 s96, s96, 138240
    buffer_load_dwordx4 v2, s[12:15], s96 offen lds
    s_add_u32 m0, s99, 0x4400
    s_add_u32 s96, s96, 15360
    buffer_load_dwordx4 v2, s[12:15], s96 offen lds
    s_add_u32 m0, s99, 0x4800
    s_add_u32 s96, s96, 15360
    buffer_load_dwordx4 v2, s[12:15], s96 offen lds
    s_add_u32 m0, s99, 0x4c00
    s_add_u32 s96, s96, 15360
    buffer_load_dwordx4 v2, s[12:15], s96 offen lds
    s_add_u32 m0, s99, 0x5000
    s_add_u32 s96, s96, 15360
    buffer_load_dwordx4 v2, s[12:15], s96 offen lds
    s_add_u32 m0, s99, 0x5400
    s_add_u32 s96, s96, 15360
    buffer_load_dwordx4 v2, s[12:15], s96 offen lds
    s_add_u32 m0, s99, 0x5800
    s_add_u32 s96, s96, 15360
    buffer_load_dwordx4 v2, s[12:15], s96 offen lds
    s_add_u32 m0, s99, 0x5c00
    s_add_u32 s96, s96, 15360
    buffer_load_dwordx4 v2, s[12:15], s96 offen lds
    s_and_b32 s57, s46, 1
    v_lshlrev_b32 v15, 4, v0
    s_and_b32 s52, s45, 7
    s_mul_i32 s52, s52, 276480
    s_mul_i32 s43, s57, 5120
    s_add_u32 s43, s43, s52
    s_add_u32 s43, s43, 0x4100000
    s_cmp_eq_u32 s57, 0
    s_cselect_b32 s20, s20, s24
    s_cselect_b32 s21, s21, s25
    s_cselect_b32 s22, s22, s26
    s_cselect_b32 s23, s23, s27
    v_add_u32 v100, 0, v0
    v_mul_u32_u24 v101, 4682, v100
    v_lshrrev_b32 v101, 16, v101
    v_mul_u32_u24 v102, 14, v101
    v_sub_u32 v100, v100, v102
    v_mul_u32_u24 v101, 3456, v101
    v_lshl_add_u32 v3, v100, 4, v101
    v_add_u32 v100, 64, v0
    v_mul_u32_u24 v101, 4682, v100
    v_lshrrev_b32 v101, 16, v101
    v_mul_u32_u24 v102, 14, v101
    v_sub_u32 v100, v100, v102
    v_mul_u32_u24 v101, 3456, v101
    v_lshl_add_u32 v4, v100, 4, v101
    v_add_u32 v100, 128, v0
    v_mul_u32_u24 v101, 4682, v100
    v_lshrrev_b32 v101, 16, v101
    v_mul_u32_u24 v102, 14, v101
    v_sub_u32 v100, v100, v102
    v_mul_u32_u24 v101, 3456, v101
    v_lshl_add_u32 v5, v100, 4, v101
    v_add_u32 v100, 192, v0
    v_mul_u32_u24 v101, 4682, v100
    v_lshrrev_b32 v101, 16, v101
    v_mul_u32_u24 v102, 14, v101
    v_sub_u32 v100, v100, v102
    v_mul_u32_u24 v101, 3456, v101
    v_lshl_add_u32 v6, v100, 4, v101
    v_add_u32 v100, 256, v0
    v_mul_u32_u24 v101, 4682, v100
    v_lshrrev_b32 v101, 16, v101
    v_mul_u32_u24 v102, 14, v101
    v_sub_u32 v100, v100, v102
    v_mul_u32_u24 v101, 3456, v101
    v_lshl_add_u32 v7, v100, 4, v101
    v_add_u32 v100, 320, v0
    v_mul_u32_u24 v101, 4682, v100
    v_lshrrev_b32 v101, 16, v101
    v_mul_u32_u24 v102, 14, v101
    v_sub_u32 v100, v100, v102
    v_mul_u32_u24 v101, 3456, v101
    v_lshl_add_u32 v8, v100, 4, v101
    v_add_u32 v100, 384, v0
    v_mul_u32_u24 v101, 4682, v100
    v_lshrrev_b32 v101, 16, v101
    v_mul_u32_u24 v102, 14, v101
    v_sub_u32 v100, v100, v102
    v_mul_u32_u24 v101, 3456, v101
    v_lshl_add_u32 v9, v100, 4, v101
    s_mov_b32 s41, 0x0
    s_mul_i32 s52, s45, 224
    s_mul_i32 s100, s57, 14464
    s_add_u32 s41, s41, s52
    s_and_b32 s57, s46, 1
    v_add_u32 v100, 0, v0
    v_mul_u32_u24 v101, 6554, v100
    v_lshrrev_b32 v101, 16, v101
    v_mul_u32_u24 v102, 10, v101
    v_sub_u32 v100, v100, v102
    v_and_b32 v102, 0x13, v101
    v_bfe_u32 v103, v101, 2, 1
    v_lshl_add_u32 v102, v103, 3, v102
    v_bfe_u32 v103, v101, 3, 1
    v_lshl_add_u32 v102, v103, 2, v102
    v_mul_u32_u24 v102, 1280, v102
    v_lshl_add_u32 v10, v100, 4, v102
    v_add_u32 v100, 64, v0
    v_mul_u32_u24 v101, 6554, v100
    v_lshrrev_b32 v101, 16, v101
    v_mul_u32_u24 v102, 10, v101
    v_sub_u32 v100, v100, v102
    v_and_b32 v102, 0x13, v101
    v_bfe_u32 v103, v101, 2, 1
    v_lshl_add_u32 v102, v103, 3, v102
    v_bfe_u32 v103, v101, 3, 1
    v_lshl_add_u32 v102, v103, 2, v102
    v_mul_u32_u24 v102, 1280, v102
    v_lshl_add_u32 v11, v100, 4, v102
    v_add_u32 v100, 128, v0
    v_mul_u32_u24 v101, 6554, v100
    v_lshrrev_b32 v101, 16, v101
    v_mul_u32_u24 v102, 10, v101
    v_sub_u32 v100, v100, v102
    v_and_b32 v102, 0x13, v101
    v_bfe_u32 v103, v101, 2, 1
    v_lshl_add_u32 v102, v103, 3, v102
    v_bfe_u32 v103, v101, 3, 1
    v_lshl_add_u32 v102, v103, 2, v102
    v_mul_u32_u24 v102, 1280, v102
    v_lshl_add_u32 v12, v100, 4, v102
    v_add_u32 v100, 192, v0
    v_mul_u32_u24 v101, 6554, v100
    v_lshrrev_b32 v101, 16, v101
    v_mul_u32_u24 v102, 10, v101
    v_sub_u32 v100, v100, v102
    v_and_b32 v102, 0x13, v101
    v_bfe_u32 v103, v101, 2, 1
    v_lshl_add_u32 v102, v103, 3, v102
    v_bfe_u32 v103, v101, 3, 1
    v_lshl_add_u32 v102, v103, 2, v102
    v_mul_u32_u24 v102, 1280, v102
    v_lshl_add_u32 v13, v100, 4, v102
    v_add_u32 v100, 256, v0
    v_mul_u32_u24 v101, 6554, v100
    v_lshrrev_b32 v101, 16, v101
    v_mul_u32_u24 v102, 10, v101
    v_sub_u32 v100, v100, v102
    v_and_b32 v102, 0x13, v101
    v_bfe_u32 v103, v101, 2, 1
    v_lshl_add_u32 v102, v103, 3, v102
    v_bfe_u32 v103, v101, 3, 1
    v_lshl_add_u32 v102, v103, 2, v102
    v_mul_u32_u24 v102, 1280, v102
    v_lshl_add_u32 v14, v100, 4, v102
    s_mul_i32 s42, s57, 40960
    s_and_b32 s52, s45, 7
    s_mul_i32 s52, s52, 160
    s_mul_i32 s101, s57, 5120
    s_add_u32 s42, s42, s52
    s_waitcnt lgkmcnt(0)
    v_mov_b32 v22, 0
    s_cmp_eq_u32 s45, 15
    s_cbranch_scc1 L_w
    s_waitcnt vmcnt(8)
    s_barrier
    s_add_u32 m0, s99, 0x8000
    s_add_u32 s96, s96, 138240
    buffer_load_dwordx4 v2, s[12:15], s96 offen lds
    s_add_u32 m0, s99, 0x8400
    s_add_u32 s96, s96, 15360
    buffer_load_dwordx4 v2, s[12:15], s96 offen lds
    s_add_u32 m0, s99, 0x8800
    s_add_u32 s96, s96, 15360
    buffer_load_dwordx4 v2, s[12:15], s96 offen lds
    s_add_u32 m0, s99, 0x8c00
    s_add_u32 s96, s96, 15360
    buffer_load_dwordx4 v2, s[12:15], s96 offen lds
    s_add_u32 m0, s99, 0x9000
    s_add_u32 s96, s96, 15360
    buffer_load_dwordx4 v2, s[12:15], s96 offen lds
    s_add_u32 m0, s99, 0x9400
    s_add_u32 s96, s96, 15360
    buffer_load_dwordx4 v2, s[12:15], s96 offen lds
    s_add_u32 m0, s99, 0x9800
    s_add_u32 s96, s96, 15360
    buffer_load_dwordx4 v2, s[12:15], s96 offen lds
    s_add_u32 m0, s99, 0x9c00
    s_add_u32 s96, s96, 15360
    buffer_load_dwordx4 v2, s[12:15], s96 offen lds
    s_add_u32 m0, s99, 0xc000
    s_add_u32 s96, s96, 138240
    buffer_load_dwordx4 v2, s[12:15], s96 offen lds
    s_add_u32 m0, s99, 0xc400
    s_add_u32 s96, s96, 15360
    buffer_load_dwordx4 v2, s[12:15], s96 offen lds
    s_add_u32 m0, s99, 0xc800
    s_add_u32 s96, s96, 15360
    buffer_load_dwordx4 v2, s[12:15], s96 offen lds
    s_add_u32 m0, s99, 0xcc00
    s_add_u32 s96, s96, 15360
    buffer_load_dwordx4 v2, s[12:15], s96 offen lds
    s_add_u32 m0, s99, 0xd000
    s_add_u32 s96, s96, 15360
    buffer_load_dwordx4 v2, s[12:15], s96 offen lds
    s_add_u32 m0, s99, 0xd400
    s_add_u32 s96, s96, 15360
    buffer_load_dwordx4 v2, s[12:15], s96 offen lds
    s_add_u32 m0, s99, 0xd800
    s_add_u32 s96, s96, 15360
    buffer_load_dwordx4 v2, s[12:15], s96 offen lds
    s_add_u32 m0, s99, 0xdc00
    s_add_u32 s96, s96, 15360
    buffer_load_dwordx4 v2, s[12:15], s96 offen lds
    s_add_u32 m0, s99, 0x10000
    s_add_u32 s96, s96, 138240
    buffer_load_dwordx4 v2, s[12:15], s96 offen lds
    s_add_u32 m0, s99, 0x10400
    s_add_u32 s96, s96, 15360
    buffer_load_dwordx4 v2, s[12:15], s96 offen lds
    s_add_u32 m0, s99, 0x10800
    s_add_u32 s96, s96, 15360
    buffer_load_dwordx4 v2, s[12:15], s96 offen lds
    s_add_u32 m0, s99, 0x10c00
    s_add_u32 s96, s96, 15360
    buffer_load_dwordx4 v2, s[12:15], s96 offen lds
    s_add_u32 m0, s99, 0x11000
    s_add_u32 s96, s96, 15360
    buffer_load_dwordx4 v2, s[12:15], s96 offen lds
    s_add_u32 m0, s99, 0x11400
    s_add_u32 s96, s96, 15360
    buffer_load_dwordx4 v2, s[12:15], s96 offen lds
    s_add_u32 m0, s99, 0x11800
    s_add_u32 s96, s96, 15360
    buffer_load_dwordx4 v2, s[12:15], s96 offen lds
    s_add_u32 m0, s99, 0x11c00
    s_add_u32 s96, s96, 15360
    buffer_load_dwordx4 v2, s[12:15], s96 offen lds
    s_branch L_wb0
L_w:
    s_cmp_lg_u32 s45, 15
    s_cbranch_scc1 L_w01
    s_barrier
    s_waitcnt vmcnt(0)
    s_mov_b32 s97, s42
    s_add_u32 m0, s101, 0x0
    s_nop 0
    buffer_load_dwordx4 v10, s[16:19], s97 offen lds
    s_add_u32 m0, s101, 0x400
    s_nop 0
    buffer_load_dwordx4 v11, s[16:19], s97 offen lds
    s_add_u32 m0, s101, 0x800
    s_nop 0
    buffer_load_dwordx4 v12, s[16:19], s97 offen lds
    s_add_u32 m0, s101, 0xc00
    s_nop 0
    buffer_load_dwordx4 v13, s[16:19], s97 offen lds
    s_add_u32 m0, s101, 0x1000
    s_nop 0
    buffer_load_dwordx4 v14, s[16:19], s97 offen lds
    s_add_u32 m0, s101, 0x2800
    s_add_u32 s97, s97, 81920
    buffer_load_dwordx4 v10, s[16:19], s97 offen lds
    s_add_u32 m0, s101, 0x2c00
    s_nop 0
    buffer_load_dwordx4 v11, s[16:19], s97 offen lds
    s_add_u32 m0, s101, 0x3000
    s_nop 0
    buffer_load_dwordx4 v12, s[16:19], s97 offen lds
    s_add_u32 m0, s101, 0x3400
    s_nop 0
    buffer_load_dwordx4 v13, s[16:19], s97 offen lds
    s_add_u32 m0, s101, 0x3800
    s_nop 0
    buffer_load_dwordx4 v14, s[16:19], s97 offen lds
    s_add_u32 m0, s101, 0x5000
    s_add_u32 s97, s97, 81920
    buffer_load_dwordx4 v10, s[16:19], s97 offen lds
    s_add_u32 m0, s101, 0x5400
    s_nop 0
    buffer_load_dwordx4 v11, s[16:19], s97 offen lds
    s_add_u32 m0, s101, 0x5800
    s_nop 0
    buffer_load_dwordx4 v12, s[16:19], s97 offen lds
    s_add_u32 m0, s101, 0x5c00
    s_nop 0
    buffer_load_dwordx4 v13, s[16:19], s97 offen lds
    s_add_u32 m0, s101, 0x6000
    s_nop 0
    buffer_load_dwordx4 v14, s[16:19], s97 offen lds
    s_add_u32 m0, s101, 0x7800
    s_add_u32 s97, s97, 81920
    buffer_load_dwordx4 v10, s[16:19], s97 offen lds
    s_add_u32 m0, s101, 0x7c00
    s_nop 0
    buffer_load_dwordx4 v11, s[16:19], s97 offen lds
    s_add_u32 m0, s101, 0x8000
    s_nop 0
    buffer_load_dwordx4 v12, s[16:19], s97 offen lds
    s_add_u32 m0, s101, 0x8400
    s_nop 0
    buffer_load_dwordx4 v13, s[16:19], s97 offen lds
    s_add_u32 m0, s101, 0x8800
    s_nop 0
    buffer_load_dwordx4 v14, s[16:19], s97 offen lds
    s_add_u32 m0, s101, 0xa000
    s_add_u32 s97, s97, 81920
    buffer_load_dwordx4 v10, s[16:19], s97 offen lds
    s_add_u32 m0, s101, 0xa400
    s_nop 0
    buffer_load_dwordx4 v11, s[16:19], s97 offen lds
    s_add_u32 m0, s101, 0xa800
    s_nop 0
    buffer_load_dwordx4 v12, s[16:19], s97 offen lds
    s_add_u32 m0, s101, 0xac00
    s_nop 0
    buffer_load_dwordx4 v13, s[16:19], s97 offen lds
    s_add_u32 m0, s101, 0xb000
    s_nop 0
    buffer_load_dwordx4 v14, s[16:19], s97 offen lds
    s_add_u32 m0, s101, 0xc800
    s_add_u32 s97, s97, 81920
    buffer_load_dwordx4 v10, s[16:19], s97 offen lds
    s_add_u32 m0, s101, 0xcc00
    s_nop 0
    buffer_load_dwordx4 v11, s[16:19], s97 offen lds
    s_add_u32 m0, s101, 0xd000
    s_nop 0
    buffer_load_dwordx4 v12, s[16:19], s97 offen lds
    s_add_u32 m0, s101, 0xd400
    s_nop 0
    buffer_load_dwordx4 v13, s[16:19], s97 offen lds
    s_add_u32 m0, s101, 0xd800
    s_nop 0
    buffer_load_dwordx4 v14, s[16:19], s97 offen lds
    s_branch L_w1
L_w01:
    s_waitcnt vmcnt(32)
    s_barrier
L_wb0:
    s_waitcnt vmcnt(24)
    s_barrier
    s_add_u32 m0, s99, 0x0
    s_add_u32 s96, s96, 138240
    buffer_load_dwordx4 v2, s[12:15], s96 offen lds
    s_add_u32 m0, s99, 0x400
    s_add_u32 s96, s96, 15360
    buffer_load_dwordx4 v2, s[12:15], s96 offen lds
    s_add_u32 m0, s99, 0x800
    s_add_u32 s96, s96, 15360
    buffer_load_dwordx4 v2, s[12:15], s96 offen lds
    s_add_u32 m0, s99, 0xc00
    s_add_u32 s96, s96, 15360
    buffer_load_dwordx4 v2, s[12:15], s96 offen lds
    s_add_u32 m0, s99, 0x1000
    s_add_u32 s96, s96, 15360
    buffer_load_dwordx4 v2, s[12:15], s96 offen lds
    s_add_u32 m0, s99, 0x1400
    s_add_u32 s96, s96, 15360
    buffer_load_dwordx4 v2, s[12:15], s96 offen lds
    s_add_u32 m0, s99, 0x1800
    s_add_u32 s96, s96, 15360
    buffer_load_dwordx4 v2, s[12:15], s96 offen lds
    s_add_u32 m0, s99, 0x1c00
    s_add_u32 s96, s96, 15360
    buffer_load_dwordx4 v2, s[12:15], s96 offen lds
    s_waitcnt vmcnt(24)
    s_barrier
    s_add_u32 m0, s99, 0x4000
    s_add_u32 s96, s96, 138240
    buffer_load_dwordx4 v2, s[12:15], s96 offen lds
    s_add_u32 m0, s99, 0x4400
    s_add_u32 s96, s96, 15360
    buffer_load_dwordx4 v2, s[12:15], s96 offen lds
    s_add_u32 m0, s99, 0x4800
    s_add_u32 s96, s96, 15360
    buffer_load_dwordx4 v2, s[12:15], s96 offen lds
    s_add_u32 m0, s99, 0x4c00
    s_add_u32 s96, s96, 15360
    buffer_load_dwordx4 v2, s[12:15], s96 offen lds
    s_add_u32 m0, s99, 0x5000
    s_add_u32 s96, s96, 15360
    buffer_load_dwordx4 v2, s[12:15], s96 offen lds
    s_add_u32 m0, s99, 0x5400
    s_add_u32 s96, s96, 15360
    buffer_load_dwordx4 v2, s[12:15], s96 offen lds
    s_add_u32 m0, s99, 0x5800
    s_add_u32 s96, s96, 15360
    buffer_load_dwordx4 v2, s[12:15], s96 offen lds
    s_add_u32 m0, s99, 0x5c00
    s_add_u32 s96, s96, 15360
    buffer_load_dwordx4 v2, s[12:15], s96 offen lds
    s_waitcnt vmcnt(24)
    s_barrier
    s_add_u32 m0, s99, 0x8000
    s_add_u32 s96, s96, 138240
    buffer_load_dwordx4 v2, s[12:15], s96 offen lds
    s_add_u32 m0, s99, 0x8400
    s_add_u32 s96, s96, 15360
    buffer_load_dwordx4 v2, s[12:15], s96 offen lds
    s_add_u32 m0, s99, 0x8800
    s_add_u32 s96, s96, 15360
    buffer_load_dwordx4 v2, s[12:15], s96 offen lds
    s_add_u32 m0, s99, 0x8c00
    s_add_u32 s96, s96, 15360
    buffer_load_dwordx4 v2, s[12:15], s96 offen lds
    s_add_u32 m0, s99, 0x9000
    s_add_u32 s96, s96, 15360
    buffer_load_dwordx4 v2, s[12:15], s96 offen lds
    s_add_u32 m0, s99, 0x9400
    s_add_u32 s96, s96, 15360
    buffer_load_dwordx4 v2, s[12:15], s96 offen lds
    s_add_u32 m0, s99, 0x9800
    s_add_u32 s96, s96, 15360
    buffer_load_dwordx4 v2, s[12:15], s96 offen lds
    s_add_u32 m0, s99, 0x9c00
    s_add_u32 s96, s96, 15360
    buffer_load_dwordx4 v2, s[12:15], s96 offen lds
    s_waitcnt vmcnt(24)
    s_barrier
    s_add_u32 m0, s99, 0xc000
    s_add_u32 s96, s96, 138240
    buffer_load_dwordx4 v2, s[12:15], s96 offen lds
    s_add_u32 m0, s99, 0xc400
    s_add_u32 s96, s96, 15360
    buffer_load_dwordx4 v2, s[12:15], s96 offen lds
    s_add_u32 m0, s99, 0xc800
    s_add_u32 s96, s96, 15360
    buffer_load_dwordx4 v2, s[12:15], s96 offen lds
    s_add_u32 m0, s99, 0xcc00
    s_add_u32 s96, s96, 15360
    buffer_load_dwordx4 v2, s[12:15], s96 offen lds
    s_add_u32 m0, s99, 0xd000
    s_add_u32 s96, s96, 15360
    buffer_load_dwordx4 v2, s[12:15], s96 offen lds
    s_add_u32 m0, s99, 0xd400
    s_add_u32 s96, s96, 15360
    buffer_load_dwordx4 v2, s[12:15], s96 offen lds
    s_add_u32 m0, s99, 0xd800
    s_add_u32 s96, s96, 15360
    buffer_load_dwordx4 v2, s[12:15], s96 offen lds
    s_add_u32 m0, s99, 0xdc00
    s_add_u32 s96, s96, 15360
    buffer_load_dwordx4 v2, s[12:15], s96 offen lds
    s_waitcnt vmcnt(24)
    s_barrier
    s_add_u32 m0, s99, 0x10000
    s_add_u32 s96, s96, 138240
    buffer_load_dwordx4 v2, s[12:15], s96 offen lds
    s_add_u32 m0, s99, 0x10400
    s_add_u32 s96, s96, 15360
    buffer_load_dwordx4 v2, s[12:15], s96 offen lds
    s_add_u32 m0, s99, 0x10800
    s_add_u32 s96, s96, 15360
    buffer_load_dwordx4 v2, s[12:15], s96 offen lds
    s_add_u32 m0, s99, 0x10c00
    s_add_u32 s96, s96, 15360
    buffer_load_dwordx4 v2, s[12:15], s96 offen lds
    s_add_u32 m0, s99, 0x11000
    s_add_u32 s96, s96, 15360
    buffer_load_dwordx4 v2, s[12:15], s96 offen lds
    s_add_u32 m0, s99, 0x11400
    s_add_u32 s96, s96, 15360
    buffer_load_dwordx4 v2, s[12:15], s96 offen lds
    s_add_u32 m0, s99, 0x11800
    s_add_u32 s96, s96, 15360
    buffer_load_dwordx4 v2, s[12:15], s96 offen lds
    s_add_u32 m0, s99, 0x11c00
    s_add_u32 s96, s96, 15360
    buffer_load_dwordx4 v2, s[12:15], s96 offen lds
    s_waitcnt vmcnt(24)
    s_barrier
    v_and_b32 v30, 15, v0
    s_lshl_b32 s52, s44, 4
    s_add_u32 s52, s52, s45
    s_mul_i32 s52, s52, 128
    v_lshl_add_u32 v31, v30, 2, s52
    s_mul_i32 s52, s44, 32
    s_add_u32 s52, s52, s45
    s_lshl_b32 s52, s52, 2
    v_mul_u32_u24 v30, 2048, v30
    v_add_u32 v30, s52, v30
    v_cmp_gt_u32 vcc, 32, v0
    s_nop 1
    v_cndmask_b32 v30, v30, v31, vcc
    v_add_u32 v30, 0x5000000, v30
    buffer_load_dword v32, v30, s[4:7], 0 offen sc1
    s_mov_b32 s97, s42
    s_add_u32 m0, s101, 0x0
    s_nop 0
    buffer_load_dwordx4 v10, s[16:19], s97 offen lds
    s_add_u32 m0, s101, 0x400
    s_nop 0
    buffer_load_dwordx4 v11, s[16:19], s97 offen lds
    s_add_u32 m0, s101, 0x800
    s_nop 0
    buffer_load_dwordx4 v12, s[16:19], s97 offen lds
    s_add_u32 m0, s101, 0xc00
    s_nop 0
    buffer_load_dwordx4 v13, s[16:19], s97 offen lds
    s_add_u32 m0, s101, 0x1000
    s_nop 0
    buffer_load_dwordx4 v14, s[16:19], s97 offen lds
    s_waitcnt vmcnt(22)
    s_barrier
    s_cmp_lg_u32 s47, 0
    s_cbranch_scc1 .ok57x
    s_waitcnt vmcnt(5)
    s_add_u32 s53, s50, 0x9e3779b0
    v_subrev_u32 v32, s53, v32
    v_cmp_lt_u32 vcc, 11, v32
    s_cmp_eq_u64 vcc, 0
    s_cbranch_scc1 .ok57
.poll58:
    buffer_load_dword v23, v30, s[4:7], 0 offen sc1
    s_waitcnt vmcnt(0)
    v_subrev_u32 v32, s53, v23
    v_cmp_lt_u32 vcc, 11, v32
    s_cmp_eq_u64 vcc, 0
    s_cbranch_scc1 .pd59
    s_sub_u32 s48, s48, 1
    s_cbranch_scc0 .poll58
    s_mov_b32 s48, 0x0
.pd59:
.ok57:
    s_sub_u32 s53, s46, 5
    s_mul_i32 s52, s45, 3
    s_add_u32 s52, s52, 0
    s_lshl_b32 s52, s52, 13
    s_add_u32 s52, s52, 0x4000000
    buffer_load_dwordx4 v[40:43], v15, s[4:7], s52 offen offset:0 sc1
    buffer_load_dwordx4 v[44:47], v15, s[4:7], s52 offen offset:1024 sc1
    buffer_load_dwordx4 v[48:51], v15, s[4:7], s52 offen offset:2048 sc1
    buffer_load_dwordx4 v[52:55], v15, s[4:7], s52 offen offset:3072 sc1
    s_add_u32 s52, s52, 4096
    buffer_load_dwordx4 v[56:59], v15, s[4:7], s52 offen offset:0 sc1
    buffer_load_dwordx4 v[60:63], v15, s[4:7], s52 offen offset:1024 sc1
    buffer_load_dwordx4 v[64:67], v15, s[4:7], s52 offen offset:2048 sc1
    buffer_load_dwordx4 v[68:71], v15, s[4:7], s52 offen offset:3072 sc1
.ok57x:
    s_add_u32 m0, s101, 0x2800
    s_add_u32 s97, s97, 81920
    buffer_load_dwordx4 v10, s[16:19], s97 offen lds
    s_add_u32 m0, s101, 0x2c00
    s_nop 0
    buffer_load_dwordx4 v11, s[16:19], s97 offen lds
    s_add_u32 m0, s101, 0x3000
    s_nop 0
    buffer_load_dwordx4 v12, s[16:19], s97 offen lds
    s_add_u32 m0, s101, 0x3400
    s_nop 0
    buffer_load_dwordx4 v13, s[16:19], s97 offen lds
    s_add_u32 m0, s101, 0x3800
    s_nop 0
    buffer_load_dwordx4 v14, s[16:19], s97 offen lds
    s_add_u32 m0, s101, 0x5000
    s_add_u32 s97, s97, 81920
    buffer_load_dwordx4 v10, s[16:19], s97 offen lds
    s_add_u32 m0, s101, 0x5400
    s_nop 0
    buffer_load_dwordx4 v11, s[16:19], s97 offen lds
    s_add_u32 m0, s101, 0x5800
    s_nop 0
    buffer_load_dwordx4 v12, s[16:19], s97 offen lds
    s_add_u32 m0, s101, 0x5c00
    s_nop 0
    buffer_load_dwordx4 v13, s[16:19], s97 offen lds
    s_add_u32 m0, s101, 0x6000
    s_nop 0
    buffer_load_dwordx4 v14, s[16:19], s97 offen lds
    s_waitcnt vmcnt(24)
    s_barrier
    s_add_u32 m0, s101, 0x7800
    s_add_u32 s97, s97, 81920
    buffer_load_dwordx4 v10, s[16:19], s97 offen lds
    s_add_u32 m0, s101, 0x7c00
    s_nop 0
    buffer_load_dwordx4 v11, s[16:19], s97 offen lds
    s_add_u32 m0, s101, 0x8000
    s_nop 0
    buffer_load_dwordx4 v12, s[16:19], s97 offen lds
    s_add_u32 m0, s101, 0x8400
    s_nop 0
    buffer_load_dwordx4 v13, s[16:19], s97 offen lds
    s_add_u32 m0, s101, 0x8800
    s_nop 0
    buffer_load_dwordx4 v14, s[16:19], s97 offen lds
    s_waitcnt vmcnt(21)
    s_barrier
    s_cmp_lg_u32 s47, 0
    s_cbranch_scc1 .ok60
    v_and_b32 v36, 0x1f0, v15
    v_add_u32 v36, 0x27000, v36
    s_waitcnt vmcnt(15)
    v_pk_add_f32 v[40:41], v[40:41], v[56:57]
    v_pk_add_f32 v[42:43], v[42:43], v[58:59]
    v_pk_add_f32 v[44:45], v[44:45], v[60:61]
    v_pk_add_f32 v[46:47], v[46:47], v[62:63]
    v_pk_add_f32 v[48:49], v[48:49], v[64:65]
    v_pk_add_f32 v[50:51], v[50:51], v[66:67]
    v_pk_add_f32 v[52:53], v[52:53], v[68:69]
    v_pk_add_f32 v[54:55], v[54:55], v[70:71]
    v_pk_add_f32 v[40:41], v[40:41], v[48:49]
    v_pk_add_f32 v[42:43], v[42:43], v[50:51]
    v_pk_add_f32 v[44:45], v[44:45], v[52:53]
    v_pk_add_f32 v[46:47], v[46:47], v[54:55]
    v_pk_add_f32 v[40:41], v[40:41], v[44:45]
    v_pk_add_f32 v[42:43], v[42:43], v[46:47]
    v_mov_b32 v44, v40
    v_mov_b32 v45, v41
    v_mov_b32 v46, v42
    v_mov_b32 v47, v43
    s_nop 1
    v_permlane32_swap_b32 v40, v44
    v_permlane32_swap_b32 v41, v45
    v_permlane32_swap_b32 v42, v46
    v_permlane32_swap_b32 v43, v47
    s_nop 1
    v_pk_add_f32 v[40:41], v[40:41], v[44:45]
    v_pk_add_f32 v[42:43], v[42:43], v[46:47]
    ds_write_b128 v36, v[40:43]
    s_waitcnt lgkmcnt(0)
.ok60:
    s_add_u32 m0, s101, 0xa000
    s_add_u32 s97, s97, 81920
    buffer_load_dwordx4 v10, s[16:19], s97 offen lds
    s_add_u32 m0, s101, 0xa400
    s_nop 0
    buffer_load_dwordx4 v11, s[16:19], s97 offen lds
    s_add_u32 m0, s101, 0xa800
    s_nop 0
    buffer_load_dwordx4 v12, s[16:19], s97 offen lds
    s_add_u32 m0, s101, 0xac00
    s_nop 0
    buffer_load_dwordx4 v13, s[16:19], s97 offen lds
    s_add_u32 m0, s101, 0xb000
    s_nop 0
    buffer_load_dwordx4 v14, s[16:19], s97 offen lds
    s_add_u32 m0, s101, 0xc800
    s_add_u32 s97, s97, 81920
    buffer_load_dwordx4 v10, s[16:19], s97 offen lds
    s_add_u32 m0, s101, 0xcc00
    s_nop 0
    buffer_load_dwordx4 v11, s[16:19], s97 offen lds
    s_add_u32 m0, s101, 0xd000
    s_nop 0
    buffer_load_dwordx4 v12, s[16:19], s97 offen lds
    s_add_u32 m0, s101, 0xd400
    s_nop 0
    buffer_load_dwordx4 v13, s[16:19], s97 offen lds
    s_add_u32 m0, s101, 0xd800
    s_nop 0
    buffer_load_dwordx4 v14, s[16:19], s97 offen lds
    s_barrier
L_w1:
    s_add_u32 m0, s101, 0xf000
    s_add_u32 s97, s97, 81920
    buffer_load_dwordx4 v10, s[16:19], s97 offen lds
    s_add_u32 m0, s101, 0xf400
    s_nop 0
    buffer_load_dwordx4 v11, s[16:19], s97 offen lds
    s_add_u32 m0, s101, 0xf800
    s_nop 0
    buffer_load_dwordx4 v12, s[16:19], s97 offen lds
    s_add_u32 m0, s101, 0xfc00
    s_nop 0
    buffer_load_dwordx4 v13, s[16:19], s97 offen lds
    s_add_u32 m0, s101, 0x10000
    s_nop 0
    buffer_load_dwordx4 v14, s[16:19], s97 offen lds
    s_add_u32 m0, s101, 0x11800
    s_add_u32 s97, s97, 81920
    buffer_load_dwordx4 v10, s[16:19], s97 offen lds
    s_add_u32 m0, s101, 0x11c00
    s_nop 0
    buffer_load_dwordx4 v11, s[16:19], s97 offen lds
    s_add_u32 m0, s101, 0x12000
    s_nop 0
    buffer_load_dwordx4 v12, s[16:19], s97 offen lds
    s_add_u32 m0, s101, 0x12400
    s_nop 0
    buffer_load_dwordx4 v13, s[16:19], s97 offen lds
    s_add_u32 m0, s101, 0x12800
    s_nop 0
    buffer_load_dwordx4 v14, s[16:19], s97 offen lds
    s_barrier
    s_branch L_attl
L_w2:
    s_setprio 3
    s_barrier
    s_add_u32 m0, s101, 0x14000
    s_add_u32 s97, s97, 81920
    buffer_load_dwordx4 v10, s[16:19], s97 offen lds
    s_add_u32 m0, s101, 0x14400
    s_nop 0
    buffer_load_dwordx4 v11, s[16:19], s97 offen lds
    s_add_u32 m0, s101, 0x14800
    s_nop 0
    buffer_load_dwordx4 v12, s[16:19], s97 offen lds
    s_add_u32 m0, s101, 0x14c00
    s_nop 0
    buffer_load_dwordx4 v13, s[16:19], s97 offen lds
    s_add_u32 m0, s101, 0x15000
    s_nop 0
    buffer_load_dwordx4 v14, s[16:19], s97 offen lds
    s_add_u32 m0, s101, 0x16800
    s_add_u32 s97, s97, 81920
    buffer_load_dwordx4 v10, s[16:19], s97 offen lds
    s_add_u32 m0, s101, 0x16c00
    s_nop 0
    buffer_load_dwordx4 v11, s[16:19], s97 offen lds
    s_add_u32 m0, s101, 0x17000
    s_nop 0
    buffer_load_dwordx4 v12, s[16:19], s97 offen lds
    s_add_u32 m0, s101, 0x17400
    s_nop 0
    buffer_load_dwordx4 v13, s[16:19], s97 offen lds
    s_add_u32 m0, s101, 0x17800
    s_nop 0
    buffer_load_dwordx4 v14, s[16:19], s97 offen lds
    s_barrier
    s_barrier
    s_barrier
    s_barrier
    s_mov_b32 s98, s41
    s_add_u32 m0, s100, 0x0
    s_nop 0
    buffer_load_dwordx4 v3, s[20:23], s98 offen lds
    s_add_u32 m0, s100, 0x400
    s_nop 0
    buffer_load_dwordx4 v4, s[20:23], s98 offen lds
    s_add_u32 m0, s100, 0x800
    s_nop 0
    buffer_load_dwordx4 v5, s[20:23], s98 offen lds
    s_add_u32 m0, s100, 0xc00
    s_nop 0
    buffer_load_dwordx4 v6, s[20:23], s98 offen lds
    s_add_u32 m0, s100, 0x1000
    s_nop 0
    buffer_load_dwordx4 v7, s[20:23], s98 offen lds
    s_add_u32 m0, s100, 0x1400
    s_nop 0
    buffer_load_dwordx4 v8, s[20:23], s98 offen lds
    s_add_u32 m0, s100, 0x1800
    s_nop 0
    buffer_load_dwordx4 v9, s[20:23], s98 offen lds
    s_add_u32 m0, s100, 0x1c00
    s_add_u32 s98, s98, 110592
    buffer_load_dwordx4 v3, s[20:23], s98 offen lds
    s_add_u32 m0, s100, 0x2000
    s_nop 0
    buffer_load_dwordx4 v4, s[20:23], s98 offen lds
    s_add_u32 m0, s100, 0x2400
    s_nop 0
    buffer_load_dwordx4 v5, s[20:23], s98 offen lds
    s_add_u32 m0, s100, 0x2800
    s_nop 0
    buffer_load_dwordx4 v6, s[20:23], s98 offen lds
    s_add_u32 m0, s100, 0x2c00
    s_nop 0
    buffer_load_dwordx4 v7, s[20:23], s98 offen lds
    s_add_u32 m0, s100, 0x3000
    s_nop 0
    buffer_load_dwordx4 v8, s[20:23], s98 offen lds
    s_add_u32 m0, s100, 0x3400
    s_nop 0
    buffer_load_dwordx4 v9, s[20:23], s98 offen lds
    s_barrier
    s_barrier
    s_add_u32 m0, s100, 0x7100
    s_add_u32 s98, s98, 110592
    buffer_load_dwordx4 v3, s[20:23], s98 offen lds
    s_add_u32 m0, s100, 0x7500
    s_nop 0
    buffer_load_dwordx4 v4, s[20:23], s98 offen lds
    s_add_u32 m0, s100, 0x7900
    s_nop 0
    buffer_load_dwordx4 v5, s[20:23], s98 offen lds
    s_add_u32 m0, s100, 0x7d00
    s_nop 0
    buffer_load_dwordx4 v6, s[20:23], s98 offen lds
    s_add_u32 m0, s100, 0x8100
    s_nop 0
    buffer_load_dwordx4 v7, s[20:23], s98 offen lds
    s_add_u32 m0, s100, 0x8500
    s_nop 0
    buffer_load_dwordx4 v8, s[20:23], s98 offen lds
    s_add_u32 m0, s100, 0x8900
    s_nop 0
    buffer_load_dwordx4 v9, s[20:23], s98 offen lds
    s_add_u32 m0, s100, 0x8d00
    s_add_u32 s98, s98, 110592
    buffer_load_dwordx4 v3, s[20:23], s98 offen lds
    s_add_u32 m0, s100, 0x9100
    s_nop 0
    buffer_load_dwordx4 v4, s[20:23], s98 offen lds
    s_add_u32 m0, s100, 0x9500
    s_nop 0
    buffer_load_dwordx4 v5, s[20:23], s98 offen lds
    s_add_u32 m0, s100, 0x9900
    s_nop 0
    buffer_load_dwordx4 v6, s[20:23], s98 offen lds
    s_add_u32 m0, s100, 0x9d00
    s_nop 0
    buffer_load_dwordx4 v7, s[20:23], s98 offen lds
    s_add_u32 m0, s100, 0xa100
    s_nop 0
    buffer_load_dwordx4 v8, s[20:23], s98 offen lds
    s_add_u32 m0, s100, 0xa500
    s_nop 0
    buffer_load_dwordx4 v9, s[20:23], s98 offen lds
    s_barrier
    s_waitcnt vmcnt(33)
    s_barrier
    s_waitcnt vmcnt(28)
    s_barrier
    s_add_u32 m0, s100, 0xe200
    s_add_u32 s98, s98, 110592
    buffer_load_dwordx4 v3, s[20:23], s98 offen lds
    s_add_u32 m0, s100, 0xe600
    s_nop 0
    buffer_load_dwordx4 v4, s[20:23], s98 offen lds
    s_add_u32 m0, s100, 0xea00
    s_nop 0
    buffer_load_dwordx4 v5, s[20:23], s98 offen lds
    s_add_u32 m0, s100, 0xee00
    s_nop 0
    buffer_load_dwordx4 v6, s[20:23], s98 offen lds
    s_add_u32 m0, s100, 0xf200
    s_nop 0
    buffer_load_dwordx4 v7, s[20:23], s98 offen lds
    s_add_u32 m0, s100, 0xf600
    s_nop 0
    buffer_load_dwordx4 v8, s[20:23], s98 offen lds
    s_add_u32 m0, s100, 0xfa00
    s_nop 0
    buffer_load_dwordx4 v9, s[20:23], s98 offen lds
    s_add_u32 m0, s100, 0xfe00
    s_add_u32 s98, s98, 110592
    buffer_load_dwordx4 v3, s[20:23], s98 offen lds
    s_add_u32 m0, s100, 0x10200
    s_nop 0
    buffer_load_dwordx4 v4, s[20:23], s98 offen lds
    s_add_u32 m0, s100, 0x10600
    s_nop 0
    buffer_load_dwordx4 v5, s[20:23], s98 offen lds
    s_add_u32 m0, s100, 0x10a00
    s_nop 0
    buffer_load_dwordx4 v6, s[20:23], s98 offen lds
    s_add_u32 m0, s100, 0x10e00
    s_nop 0
    buffer_load_dwordx4 v7, s[20:23], s98 offen lds
    s_add_u32 m0, s100, 0x11200
    s_nop 0
    buffer_load_dwordx4 v8, s[20:23], s98 offen lds
    s_add_u32 m0, s100, 0x11600
    s_nop 0
    buffer_load_dwordx4 v9, s[20:23], s98 offen lds
    s_barrier
    s_barrier
    s_barrier
    s_waitcnt vmcnt(28)
    s_barrier
    s_waitcnt vmcnt(14)
    s_barrier
    s_add_u32 m0, s100, 0x0
    s_add_u32 s98, s98, 110592
    buffer_load_dwordx4 v3, s[20:23], s98 offen lds
    s_add_u32 m0, s100, 0x400
    s_nop 0
    buffer_load_dwordx4 v4, s[20:23], s98 offen lds
    s_add_u32 m0, s100, 0x800
    s_nop 0
    buffer_load_dwordx4 v5, s[20:23], s98 offen lds
    s_add_u32 m0, s100, 0xc00
    s_nop 0
    buffer_load_dwordx4 v6, s[20:23], s98 offen lds
    s_add_u32 m0, s100, 0x1000
    s_nop 0
    buffer_load_dwordx4 v7, s[20:23], s98 offen lds
    s_add_u32 m0, s100, 0x1400
    s_nop 0
    buffer_load_dwordx4 v8, s[20:23], s98 offen lds
    s_add_u32 m0, s100, 0x1800
    s_nop 0
    buffer_load_dwordx4 v9, s[20:23], s98 offen lds
    s_add_u32 m0, s100, 0x1c00
    s_add_u32 s98, s98, 110592
    buffer_load_dwordx4 v3, s[20:23], s98 offen lds
    s_add_u32 m0, s100, 0x2000
    s_nop 0
    buffer_load_dwordx4 v4, s[20:23], s98 offen lds
    s_add_u32 m0, s100, 0x2400
    s_nop 0
    buffer_load_dwordx4 v5, s[20:23], s98 offen lds
    s_add_u32 m0, s100, 0x2800
    s_nop 0
    buffer_load_dwordx4 v6, s[20:23], s98 offen lds
    s_add_u32 m0, s100, 0x2c00
    s_nop 0
    buffer_load_dwordx4 v7, s[20:23], s98 offen lds
    s_add_u32 m0, s100, 0x3000
    s_nop 0
    buffer_load_dwordx4 v8, s[20:23], s98 offen lds
    s_add_u32 m0, s100, 0x3400
    s_nop 0
    buffer_load_dwordx4 v9, s[20:23], s98 offen lds
    s_waitcnt vmcnt(14)
    s_barrier
    s_add_u32 m0, s100, 0x7100
    s_add_u32 s98, s98, 110592
    buffer_load_dwordx4 v3, s[20:23], s98 offen lds
    s_add_u32 m0, s100, 0x7500
    s_nop 0
    buffer_load_dwordx4 v4, s[20:23], s98 offen lds
    s_add_u32 m0, s100, 0x7900
    s_nop 0
    buffer_load_dwordx4 v5, s[20:23], s98 offen lds
    s_add_u32 m0, s100, 0x7d00
    s_nop 0
    buffer_load_dwordx4 v6, s[20:23], s98 offen lds
    s_add_u32 m0, s100, 0x8100
    s_nop 0
    buffer_load_dwordx4 v7, s[20:23], s98 offen lds
    s_add_u32 m0, s100, 0x8500
    s_nop 0
    buffer_load_dwordx4 v8, s[20:23], s98 offen lds
    s_add_u32 m0, s100, 0x8900
    s_nop 0
    buffer_load_dwordx4 v9, s[20:23], s98 offen lds
    s_add_u32 m0, s100, 0x8d00
    s_add_u32 s98, s98, 110592
    buffer_load_dwordx4 v3, s[20:23], s98 offen lds
    s_add_u32 m0, s100, 0x9100
    s_nop 0
    buffer_load_dwordx4 v4, s[20:23], s98 offen lds
    s_add_u32 m0, s100, 0x9500
    s_nop 0
    buffer_load_dwordx4 v5, s[20:23], s98 offen lds
    s_add_u32 m0, s100, 0x9900
    s_nop 0
    buffer_load_dwordx4 v6, s[20:23], s98 offen lds
    s_add_u32 m0, s100, 0x9d00
    s_nop 0
    buffer_load_dwordx4 v7, s[20:23], s98 offen lds
    s_add_u32 m0, s100, 0xa100
    s_nop 0
    buffer_load_dwordx4 v8, s[20:23], s98 offen lds
    s_add_u32 m0, s100, 0xa500
    s_nop 0
    buffer_load_dwordx4 v9, s[20:23], s98 offen lds
    s_waitcnt vmcnt(14)
    s_barrier
    s_add_u32 m0, s100, 0xe200
    s_add_u32 s98, s98, 110592
    buffer_load_dwordx4 v3, s[20:23], s98 offen lds
    s_add_u32 m0, s100, 0xe600
    s_nop 0
    buffer_load_dwordx4 v4, s[20:23], s98 offen lds
    s_add_u32 m0, s100, 0xea00
    s_nop 0
    buffer_load_dwordx4 v5, s[20:23], s98 offen lds
    s_add_u32 m0, s100, 0xee00
    s_nop 0
    buffer_load_dwordx4 v6, s[20:23], s98 offen lds
    s_add_u32 m0, s100, 0xf200
    s_nop 0
    buffer_load_dwordx4 v7, s[20:23], s98 offen lds
    s_add_u32 m0, s100, 0xf600
    s_nop 0
    buffer_load_dwordx4 v8, s[20:23], s98 offen lds
    s_add_u32 m0, s100, 0xfa00
    s_nop 0
    buffer_load_dwordx4 v9, s[20:23], s98 offen lds
    s_add_u32 m0, s100, 0xfe00
    s_add_u32 s98, s98, 110592
    buffer_load_dwordx4 v3, s[20:23], s98 offen lds
    s_add_u32 m0, s100, 0x10200
    s_nop 0
    buffer_load_dwordx4 v4, s[20:23], s98 offen lds
    s_add_u32 m0, s100, 0x10600
    s_nop 0
    buffer_load_dwordx4 v5, s[20:23], s98 offen lds
    s_add_u32 m0, s100, 0x10a00
    s_nop 0
    buffer_load_dwordx4 v6, s[20:23], s98 offen lds
    s_add_u32 m0, s100, 0x10e00
    s_nop 0
    buffer_load_dwordx4 v7, s[20:23], s98 offen lds
    s_add_u32 m0, s100, 0x11200
    s_nop 0
    buffer_load_dwordx4 v8, s[20:23], s98 offen lds
    s_add_u32 m0, s100, 0x11600
    s_nop 0
    buffer_load_dwordx4 v9, s[20:23], s98 offen lds
    s_waitcnt vmcnt(14)
    s_barrier
    s_add_u32 m0, s100, 0x0
    s_add_u32 s98, s98, 110592
    buffer_load_dwordx4 v3, s[20:23], s98 offen lds
    s_add_u32 m0, s100, 0x400
    s_nop 0
    buffer_load_dwordx4 v4, s[20:23], s98 offen lds
    s_add_u32 m0, s100, 0x800
    s_nop 0
    buffer_load_dwordx4 v5, s[20:23], s98 offen lds
    s_add_u32 m0, s100, 0xc00
    s_nop 0
    buffer_load_dwordx4 v6, s[20:23], s98 offen lds
    s_add_u32 m0, s100, 0x1000
    s_nop 0
    buffer_load_dwordx4 v7, s[20:23], s98 offen lds
    s_add_u32 m0, s100, 0x1400
    s_nop 0
    buffer_load_dwordx4 v8, s[20:23], s98 offen lds
    s_add_u32 m0, s100, 0x1800
    s_nop 0
    buffer_load_dwordx4 v9, s[20:23], s98 offen lds
    s_add_u32 m0, s100, 0x1c00
    s_add_u32 s98, s98, 110592
    buffer_load_dwordx4 v3, s[20:23], s98 offen lds
    s_add_u32 m0, s100, 0x2000
    s_nop 0
    buffer_load_dwordx4 v4, s[20:23], s98 offen lds
    s_add_u32 m0, s100, 0x2400
    s_nop 0
    buffer_load_dwordx4 v5, s[20:23], s98 offen lds
    s_add_u32 m0, s100, 0x2800
    s_nop 0
    buffer_load_dwordx4 v6, s[20:23], s98 offen lds
    s_add_u32 m0, s100, 0x2c00
    s_nop 0
    buffer_load_dwordx4 v7, s[20:23], s98 offen lds
    s_add_u32 m0, s100, 0x3000
    s_nop 0
    buffer_load_dwordx4 v8, s[20:23], s98 offen lds
    s_add_u32 m0, s100, 0x3400
    s_nop 0
    buffer_load_dwordx4 v9, s[20:23], s98 offen lds
    v_and_b32 v30, 15, v0
    v_mul_u32_u24 v30, 2048, v30
    v_and_b32 v31, 32, v0
    s_lshl_b32 s52, s45, 2
    v_xor_b32 v31, s52, v31
    s_mul_i32 s52, s44, 128
    s_add_u32 s52, s52, 0x5000000
    v_add3_u32 v30, v30, v31, s52
    buffer_load_dword v32, v30, s[4:7], 0 offen sc1
    s_waitcnt vmcnt(15)
    s_barrier
    s_add_u32 m0, s100, 0x7100
    s_add_u32 s98, s98, 110592
    buffer_load_dwordx4 v3, s[20:23], s98 offen lds
    s_add_u32 m0, s100, 0x7500
    s_nop 0
    buffer_load_dwordx4 v4, s[20:23], s98 offen lds
    s_add_u32 m0, s100, 0x7900
    s_nop 0
    buffer_load_dwordx4 v5, s[20:23], s98 offen lds
    s_add_u32 m0, s100, 0x7d00
    s_nop 0
    buffer_load_dwordx4 v6, s[20:23], s98 offen lds
    s_add_u32 m0, s100, 0x8100
    s_nop 0
    buffer_load_dwordx4 v7, s[20:23], s98 offen lds
    s_add_u32 m0, s100, 0x8500
    s_nop 0
    buffer_load_dwordx4 v8, s[20:23], s98 offen lds
    s_add_u32 m0, s100, 0x8900
    s_nop 0
    buffer_load_dwordx4 v9, s[20:23], s98 offen lds
    s_add_u32 m0, s100, 0x8d00
    s_add_u32 s98, s98, 110592
    buffer_load_dwordx4 v3, s[20:23], s98 offen lds
    s_add_u32 m0, s100, 0x9100
    s_nop 0
    buffer_load_dwordx4 v4, s[20:23], s98 offen lds
    s_add_u32 m0, s100, 0x9500
    s_nop 0
    buffer_load_dwordx4 v5, s[20:23], s98 offen lds
    s_add_u32 m0, s100, 0x9900
    s_nop 0
    buffer_load_dwordx4 v6, s[20:23], s98 offen lds
    s_add_u32 m0, s100, 0x9d00
    s_nop 0
    buffer_load_dwordx4 v7, s[20:23], s98 offen lds
    s_add_u32 m0, s100, 0xa100
    s_nop 0
    buffer_load_dwordx4 v8, s[20:23], s98 offen lds
    s_add_u32 m0, s100, 0xa500
    s_nop 0
    buffer_load_dwordx4 v9, s[20:23], s98 offen lds
    s_cmp_lg_u32 s47, 0
    s_cbranch_scc1 .ok61x
    s_waitcnt vmcnt(14)
    s_add_u32 s53, s50, 0x9e3779b3
    v_subrev_u32 v32, s53, v32
    v_cmp_lt_u32 vcc, 11, v32
    s_cmp_eq_u64 vcc, 0
    s_cbranch_scc1 .ok61
.poll62:
    buffer_load_dword v23, v30, s[4:7], 0 offen sc1
    s_waitcnt vmcnt(0)
    v_subrev_u32 v32, s53, v23
    v_cmp_lt_u32 vcc, 11, v32
    s_cmp_eq_u64 vcc, 0
    s_cbranch_scc1 .pd63
    s_sub_u32 s48, s48, 1
    s_cbranch_scc0 .poll62
    s_mov_b32 s48, 0x0
.pd63:
.ok61:
    s_sub_u32 s53, s46, 5
    s_mul_i32 s52, s45, 3
    s_add_u32 s52, s52, s53
    s_lshl_b32 s52, s52, 13
    s_add_u32 s52, s52, 0x4000000
    buffer_load_dwordx4 v[40:43], v15, s[4:7], s52 offen offset:0 sc1
    buffer_load_dwordx4 v[44:47], v15, s[4:7], s52 offen offset:1024 sc1
    buffer_load_dwordx4 v[48:51], v15, s[4:7], s52 offen offset:2048 sc1
    buffer_load_dwordx4 v[52:55], v15, s[4:7], s52 offen offset:3072 sc1
    s_add_u32 s52, s52, 4096
    buffer_load_dwordx4 v[56:59], v15, s[4:7], s52 offen offset:0 sc1
    buffer_load_dwordx4 v[60:63], v15, s[4:7], s52 offen offset:1024 sc1
    buffer_load_dwordx4 v[64:67], v15, s[4:7], s52 offen offset:2048 sc1
    buffer_load_dwordx4 v[68:71], v15, s[4:7], s52 offen offset:3072 sc1
.ok61x:
    s_waitcnt vmcnt(15)
    s_barrier
    s_add_u32 m0, s100, 0xe200
    s_add_u32 s98, s98, 110592
    buffer_load_dwordx4 v3, s[20:23], s98 offen lds
    s_add_u32 m0, s100, 0xe600
    s_nop 0
    buffer_load_dwordx4 v4, s[20:23], s98 offen lds
    s_add_u32 m0, s100, 0xea00
    s_nop 0
    buffer_load_dwordx4 v5, s[20:23], s98 offen lds
    s_add_u32 m0, s100, 0xee00
    s_nop 0
    buffer_load_dwordx4 v6, s[20:23], s98 offen lds
    s_add_u32 m0, s100, 0xf200
    s_nop 0
    buffer_load_dwordx4 v7, s[20:23], s98 offen lds
    s_add_u32 m0, s100, 0xf600
    s_nop 0
    buffer_load_dwordx4 v8, s[20:23], s98 offen lds
    s_add_u32 m0, s100, 0xfa00
    s_nop 0
    buffer_load_dwordx4 v9, s[20:23], s98 offen lds
    s_add_u32 m0, s100, 0xfe00
    s_add_u32 s98, s98, 110592
    buffer_load_dwordx4 v3, s[20:23], s98 offen lds
    s_add_u32 m0, s100, 0x10200
    s_nop 0
    buffer_load_dwordx4 v4, s[20:23], s98 offen lds
    s_add_u32 m0, s100, 0x10600
    s_nop 0
    buffer_load_dwordx4 v5, s[20:23], s98 offen lds
    s_add_u32 m0, s100, 0x10a00
    s_nop 0
    buffer_load_dwordx4 v6, s[20:23], s98 offen lds
    s_add_u32 m0, s100, 0x10e00
    s_nop 0
    buffer_load_dwordx4 v7, s[20:23], s98 offen lds
    s_add_u32 m0, s100, 0x11200
    s_nop 0
    buffer_load_dwordx4 v8, s[20:23], s98 offen lds
    s_add_u32 m0, s100, 0x11600
    s_nop 0
    buffer_load_dwordx4 v9, s[20:23], s98 offen lds
    s_waitcnt vmcnt(14)
    s_barrier
    s_add_u32 m0, s100, 0x0
    s_add_u32 s98, s98, 110592
    buffer_load_dwordx4 v3, s[20:23], s98 offen lds
    s_add_u32 m0, s100, 0x400
    s_nop 0
    buffer_load_dwordx4 v4, s[20:23], s98 offen lds
    s_add_u32 m0, s100, 0x800
    s_nop 0
    buffer_load_dwordx4 v5, s[20:23], s98 offen lds
    s_add_u32 m0, s100, 0xc00
    s_nop 0
    buffer_load_dwordx4 v6, s[20:23], s98 offen lds
    s_add_u32 m0, s100, 0x1000
    s_nop 0
    buffer_load_dwordx4 v7, s[20:23], s98 offen lds
    s_add_u32 m0, s100, 0x1400
    s_nop 0
    buffer_load_dwordx4 v8, s[20:23], s98 offen lds
    s_add_u32 m0, s100, 0x1800
    s_nop 0
    buffer_load_dwordx4 v9, s[20:23], s98 offen lds
    s_add_u32 m0, s100, 0x1c00
    s_add_u32 s98, s98, 110592
    buffer_load_dwordx4 v3, s[20:23], s98 offen lds
    s_add_u32 m0, s100, 0x2000
    s_nop 0
    buffer_load_dwordx4 v4, s[20:23], s98 offen lds
    s_add_u32 m0, s100, 0x2400
    s_nop 0
    buffer_load_dwordx4 v5, s[20:23], s98 offen lds
    s_add_u32 m0, s100, 0x2800
    s_nop 0
    buffer_load_dwordx4 v6, s[20:23], s98 offen lds
    s_add_u32 m0, s100, 0x2c00
    s_nop 0
    buffer_load_dwordx4 v7, s[20:23], s98 offen lds
    s_add_u32 m0, s100, 0x3000
    s_nop 0
    buffer_load_dwordx4 v8, s[20:23], s98 offen lds
    s_add_u32 m0, s100, 0x3400
    s_nop 0
    buffer_load_dwordx4 v9, s[20:23], s98 offen lds
    s_cmp_lg_u32 s47, 0
    s_cbranch_scc1 .ok64
    s_lshl_b32 s53, s46, 9
    s_add_u32 s53, s53, 0x26800
    v_and_b32 v36, 0x1f0, v15
    v_add_u32 v36, s53, v36
    s_waitcnt vmcnt(28)
    v_pk_add_f32 v[40:41], v[40:41], v[56:57]
    v_pk_add_f32 v[42:43], v[42:43], v[58:59]
    v_pk_add_f32 v[44:45], v[44:45], v[60:61]
    v_pk_add_f32 v[46:47], v[46:47], v[62:63]
    v_pk_add_f32 v[48:49], v[48:49], v[64:65]
    v_pk_add_f32 v[50:51], v[50:51], v[66:67]
    v_pk_add_f32 v[52:53], v[52:53], v[68:69]
    v_pk_add_f32 v[54:55], v[54:55], v[70:71]
    v_pk_add_f32 v[40:41], v[40:41], v[48:49]
    v_pk_add_f32 v[42:43], v[42:43], v[50:51]
    v_pk_add_f32 v[44:45], v[44:45], v[52:53]
    v_pk_add_f32 v[46:47], v[46:47], v[54:55]
    v_pk_add_f32 v[40:41], v[40:41], v[44:45]
    v_pk_add_f32 v[42:43], v[42:43], v[46:47]
    v_mov_b32 v44, v40
    v_mov_b32 v45, v41
    v_mov_b32 v46, v42
    v_mov_b32 v47, v43
    s_nop 1
    v_permlane32_swap_b32 v40, v44
    v_permlane32_swap_b32 v41, v45
    v_permlane32_swap_b32 v42, v46
    v_permlane32_swap_b32 v43, v47
    s_nop 1
    v_pk_add_f32 v[40:41], v[40:41], v[44:45]
    v_pk_add_f32 v[42:43], v[42:43], v[46:47]
    ds_write_b128 v36, v[40:43]
    s_waitcnt lgkmcnt(0)
.ok64:
    s_waitcnt vmcnt(14)
    s_barrier
    s_add_u32 m0, s101, 0x7800
    s_add_u32 s97, s43, 0x0
    buffer_load_dwordx4 v15, s[4:7], s97 offen sc1 lds
    buffer_load_dwordx4 v15, s[4:7], s97 offen offset:1024 sc1 lds
    buffer_load_dwordx4 v15, s[4:7], s97 offen offset:2048 sc1 lds
    buffer_load_dwordx4 v15, s[4:7], s97 offen offset:3072 sc1 lds
    s_add_u32 m0, s101, 0x8800
    s_add_u32 s97, s43, 0x1000
    buffer_load_dwordx4 v15, s[4:7], s97 offen sc1 lds
    s_add_u32 m0, s101, 0xa000
    s_add_u32 s97, s43, 0x2800
    buffer_load_dwordx4 v15, s[4:7], s97 offen sc1 lds
    buffer_load_dwordx4 v15, s[4:7], s97 offen offset:1024 sc1 lds
    buffer_load_dwordx4 v15, s[4:7], s97 offen offset:2048 sc1 lds
    buffer_load_dwordx4 v15, s[4:7], s97 offen offset:3072 sc1 lds
    s_add_u32 m0, s101, 0xb000
    s_add_u32 s97, s43, 0x3800
    buffer_load_dwordx4 v15, s[4:7], s97 offen sc1 lds
    s_waitcnt vmcnt(10)
    s_barrier
    s_add_u32 m0, s101, 0xc800
    s_add_u32 s97, s43, 0x5000
    buffer_load_dwordx4 v15, s[4:7], s97 offen sc1 lds
    buffer_load_dwordx4 v15, s[4:7], s97 offen offset:1024 sc1 lds
    buffer_load_dwordx4 v15, s[4:7], s97 offen offset:2048 sc1 lds
    buffer_load_dwordx4 v15, s[4:7], s97 offen offset:3072 sc1 lds
    s_add_u32 m0, s101, 0xd800
    s_add_u32 s97, s43, 0x6000
    buffer_load_dwordx4 v15, s[4:7], s97 offen sc1 lds
    s_add_u32 m0, s101, 0xf000
    s_add_u32 s97, s43, 0x7800
    buffer_load_dwordx4 v15, s[4:7], s97 offen sc1 lds
    buffer_load_dwordx4 v15, s[4:7], s97 offen offset:1024 sc1 lds
    buffer_load_dwordx4 v15, s[4:7], s97 offen offset:2048 sc1 lds
    buffer_load_dwordx4 v15, s[4:7], s97 offen offset:3072 sc1 lds
    s_add_u32 m0, s101, 0x10000
    s_add_u32 s97, s43, 0x8800
    buffer_load_dwordx4 v15, s[4:7], s97 offen sc1 lds
    s_add_u32 m0, s101, 0x11800
    s_add_u32 s97, s43, 0xa000
    buffer_load_dwordx4 v15, s[4:7], s97 offen sc1 lds
    buffer_load_dwordx4 v15, s[4:7], s97 offen offset:1024 sc1 lds
    buffer_load_dwordx4 v15, s[4:7], s97 offen offset:2048 sc1 lds
    buffer_load_dwordx4 v15, s[4:7], s97 offen offset:3072 sc1 lds
    s_add_u32 m0, s101, 0x12800
    s_add_u32 s97, s43, 0xb000
    buffer_load_dwordx4 v15, s[4:7], s97 offen sc1 lds
    s_add_u32 m0, s101, 0x14000
    s_add_u32 s97, s43, 0xc800
    buffer_load_dwordx4 v15, s[4:7], s97 offen sc1 lds
    buffer_load_dwordx4 v15, s[4:7], s97 offen offset:1024 sc1 lds
    buffer_load_dwordx4 v15, s[4:7], s97 offen offset:2048 sc1 lds
    buffer_load_dwordx4 v15, s[4:7], s97 offen offset:3072 sc1 lds
    s_add_u32 m0, s101, 0x15000
    s_add_u32 s97, s43, 0xd800
    buffer_load_dwordx4 v15, s[4:7], s97 offen sc1 lds
    s_barrier
    s_add_u32 m0, s101, 0x16800
    s_add_u32 s97, s43, 0xf000
    buffer_load_dwordx4 v15, s[4:7], s97 offen sc1 lds
    buffer_load_dwordx4 v15, s[4:7], s97 offen offset:1024 sc1 lds
    buffer_load_dwordx4 v15, s[4:7], s97 offen offset:2048 sc1 lds
    buffer_load_dwordx4 v15, s[4:7], s97 offen offset:3072 sc1 lds
    s_add_u32 m0, s101, 0x17800
    s_add_u32 s97, s43, 0x10000
    buffer_load_dwordx4 v15, s[4:7], s97 offen sc1 lds
    s_add_u32 m0, s101, 0x0
    s_add_u32 s97, s43, 0x11800
    buffer_load_dwordx4 v15, s[4:7], s97 offen sc1 lds
    buffer_load_dwordx4 v15, s[4:7], s97 offen offset:1024 sc1 lds
    buffer_load_dwordx4 v15, s[4:7], s97 offen offset:2048 sc1 lds
    buffer_load_dwordx4 v15, s[4:7], s97 offen offset:3072 sc1 lds
    s_add_u32 m0, s101, 0x1000
    s_add_u32 s97, s43, 0x12800
    buffer_load_dwordx4 v15, s[4:7], s97 offen sc1 lds
    s_add_u32 m0, s101, 0x2800
    s_add_u32 s97, s43, 0x14000
    buffer_load_dwordx4 v15, s[4:7], s97 offen sc1 lds
    buffer_load_dwordx4 v15, s[4:7], s97 offen offset:1024 sc1 lds
    buffer_load_dwordx4 v15, s[4:7], s97 offen offset:2048 sc1 lds
    buffer_load_dwordx4 v15, s[4:7], s97 offen offset:3072 sc1 lds
    s_add_u32 m0, s101, 0x3800
    s_add_u32 s97, s43, 0x15000
    buffer_load_dwordx4 v15, s[4:7], s97 offen sc1 lds
    s_add_u32 m0, s101, 0x5000
    s_add_u32 s97, s43, 0x16800
    buffer_load_dwordx4 v15, s[4:7], s97 offen sc1 lds
    buffer_load_dwordx4 v15, s[4:7], s97 offen offset:1024 sc1 lds
    buffer_load_dwordx4 v15, s[4:7], s97 offen offset:2048 sc1 lds
    buffer_load_dwordx4 v15, s[4:7], s97 offen offset:3072 sc1 lds
    s_add_u32 m0, s101, 0x6000
    s_add_u32 s97, s43, 0x17800
    buffer_load_dwordx4 v15, s[4:7], s97 offen sc1 lds
    s_barrier
    s_cmp_lg_u32 s47, 0
    s_cselect_b32 s14, 0, s14
    s_waitcnt vmcnt(45)
    s_barrier
    s_waitcnt vmcnt(40)
    s_barrier
    s_add_u32 m0, s101, 0x7800
    s_add_u32 s97, s43, 0x19000
    buffer_load_dwordx4 v15, s[4:7], s97 offen sc1 lds
    buffer_load_dwordx4 v15, s[4:7], s97 offen offset:1024 sc1 lds
    buffer_load_dwordx4 v15, s[4:7], s97 offen offset:2048 sc1 lds
    buffer_load_dwordx4 v15, s[4:7], s97 offen offset:3072 sc1 lds
    s_add_u32 m0, s101, 0x8800
    s_add_u32 s97, s43, 0x1a000
    buffer_load_dwordx4 v15, s[4:7], s97 offen sc1 lds
    s_waitcnt vmcnt(40)
    s_barrier
    s_add_u32 m0, s101, 0xa000
    s_add_u32 s97, s43, 0x1b800
    buffer_load_dwordx4 v15, s[4:7], s97 offen sc1 lds
    buffer_load_dwordx4 v15, s[4:7], s97 offen offset:1024 sc1 lds
    buffer_load_dwordx4 v15, s[4:7], s97 offen offset:2048 sc1 lds
    buffer_load_dwordx4 v15, s[4:7], s97 offen offset:3072 sc1 lds
    s_add_u32 m0, s101, 0xb000
    s_add_u32 s97, s43, 0x1c800
    buffer_load_dwordx4 v15, s[4:7], s97 offen sc1 lds
    s_waitcnt vmcnt(40)
    s_barrier
    s_add_u32 m0, s101, 0xc800
    s_add_u32 s97, s43, 0x1e000
    buffer_load_dwordx4 v15, s[4:7], s97 offen sc1 lds
    buffer_load_dwordx4 v15, s[4:7], s97 offen offset:1024 sc1 lds
    buffer_load_dwordx4 v15, s[4:7], s97 offen offset:2048 sc1 lds
    buffer_load_dwordx4 v15, s[4:7], s97 offen offset:3072 sc1 lds
    s_add_u32 m0, s101, 0xd800
    s_add_u32 s97, s43, 0x1f000
    buffer_load_dwordx4 v15, s[4:7], s97 offen sc1 lds
    s_waitcnt vmcnt(40)
    s_barrier
    s_add_u32 m0, s101, 0xf000
    s_add_u32 s97, s43, 0x20800
    buffer_load_dwordx4 v15, s[4:7], s97 offen sc1 lds
    buffer_load_dwordx4 v15, s[4:7], s97 offen offset:1024 sc1 lds
    buffer_load_dwordx4 v15, s[4:7], s97 offen offset:2048 sc1 lds
    buffer_load_dwordx4 v15, s[4:7], s97 offen offset:3072 sc1 lds
    s_add_u32 m0, s101, 0x10000
    s_add_u32 s97, s43, 0x21800
    buffer_load_dwordx4 v15, s[4:7], s97 offen sc1 lds
    s_waitcnt vmcnt(40)
    s_barrier
    s_add_u32 m0, s101, 0x11800
    s_add_u32 s97, s43, 0x23000
    buffer_load_dwordx4 v15, s[4:7], s97 offen sc1 lds
    buffer_load_dwordx4 v15, s[4:7], s97 offen offset:1024 sc1 lds
    buffer_load_dwordx4 v15, s[4:7], s97 offen offset:2048 sc1 lds
    buffer_load_dwordx4 v15, s[4:7], s97 offen offset:3072 sc1 lds
    s_add_u32 m0, s101, 0x12800
    s_add_u32 s97, s43, 0x24000
    buffer_load_dwordx4 v15, s[4:7], s97 offen sc1 lds
    s_waitcnt vmcnt(40)
    s_barrier
    s_add_u32 m0, s101, 0x14000
    s_add_u32 s97, s43, 0x25800
    buffer_load_dwordx4 v15, s[4:7], s97 offen sc1 lds
    buffer_load_dwordx4 v15, s[4:7], s97 offen offset:1024 sc1 lds
    buffer_load_dwordx4 v15, s[4:7], s97 offen offset:2048 sc1 lds
    buffer_load_dwordx4 v15, s[4:7], s97 offen offset:3072 sc1 lds
    s_add_u32 m0, s101, 0x15000
    s_add_u32 s97, s43, 0x26800
    buffer_load_dwordx4 v15, s[4:7], s97 offen sc1 lds
    s_waitcnt vmcnt(40)
    s_barrier
    s_add_u32 m0, s101, 0x16800
    s_add_u32 s97, s43, 0x28000
    buffer_load_dwordx4 v15, s[4:7], s97 offen sc1 lds
    buffer_load_dwordx4 v15, s[4:7], s97 offen offset:1024 sc1 lds
    buffer_load_dwordx4 v15, s[4:7], s97 offen offset:2048 sc1 lds
    buffer_load_dwordx4 v15, s[4:7], s97 offen offset:3072 sc1 lds
    s_add_u32 m0, s101, 0x17800
    s_add_u32 s97, s43, 0x29000
    buffer_load_dwordx4 v15, s[4:7], s97 offen sc1 lds
    s_waitcnt vmcnt(40)
    s_barrier
    s_add_u32 m0, s101, 0x0
    s_add_u32 s97, s43, 0x2a800
    buffer_load_dwordx4 v15, s[4:7], s97 offen sc1 lds
    buffer_load_dwordx4 v15, s[4:7], s97 offen offset:1024 sc1 lds
    buffer_load_dwordx4 v15, s[4:7], s97 offen offset:2048 sc1 lds
    buffer_load_dwordx4 v15, s[4:7], s97 offen offset:3072 sc1 lds
    s_add_u32 m0, s101, 0x1000
    s_add_u32 s97, s43, 0x2b800
    buffer_load_dwordx4 v15, s[4:7], s97 offen sc1 lds
    s_waitcnt vmcnt(40)
    s_barrier
    s_add_u32 m0, s101, 0x2800
    s_add_u32 s97, s43, 0x2d000
    buffer_load_dwordx4 v15, s[4:7], s97 offen sc1 lds
    buffer_load_dwordx4 v15, s[4:7], s97 offen offset:1024 sc1 lds
    buffer_load_dwordx4 v15, s[4:7], s97 offen offset:2048 sc1 lds
    buffer_load_dwordx4 v15, s[4:7], s97 offen offset:3072 sc1 lds
    s_add_u32 m0, s101, 0x3800
    s_add_u32 s97, s43, 0x2e000
    buffer_load_dwordx4 v15, s[4:7], s97 offen sc1 lds
    s_waitcnt vmcnt(40)
    s_barrier
    s_add_u32 m0, s101, 0x5000
    s_add_u32 s97, s43, 0x2f800
    buffer_load_dwordx4 v15, s[4:7], s97 offen sc1 lds
    buffer_load_dwordx4 v15, s[4:7], s97 offen offset:1024 sc1 lds
    buffer_load_dwordx4 v15, s[4:7], s97 offen offset:2048 sc1 lds
    buffer_load_dwordx4 v15, s[4:7], s97 offen offset:3072 sc1 lds
    s_add_u32 m0, s101, 0x6000
    s_add_u32 s97, s43, 0x30800
    buffer_load_dwordx4 v15, s[4:7], s97 offen sc1 lds
    s_waitcnt vmcnt(40)
    s_barrier
    s_add_u32 m0, s101, 0x7800
    s_add_u32 s97, s43, 0x32000
    buffer_load_dwordx4 v15, s[4:7], s97 offen sc1 lds
    buffer_load_dwordx4 v15, s[4:7], s97 offen offset:1024 sc1 lds
    buffer_load_dwordx4 v15, s[4:7], s97 offen offset:2048 sc1 lds
    buffer_load_dwordx4 v15, s[4:7], s97 offen offset:3072 sc1 lds
    s_add_u32 m0, s101, 0x8800
    s_add_u32 s97, s43, 0x33000
    buffer_load_dwordx4 v15, s[4:7], s97 offen sc1 lds
    s_waitcnt vmcnt(40)
    s_barrier
    s_add_u32 m0, s101, 0xa000
    s_add_u32 s97, s43, 0x34800
    buffer_load_dwordx4 v15, s[4:7], s97 offen sc1 lds
    buffer_load_dwordx4 v15, s[4:7], s97 offen offset:1024 sc1 lds
    buffer_load_dwordx4 v15, s[4:7], s97 offen offset:2048 sc1 lds
    buffer_load_dwordx4 v15, s[4:7], s97 offen offset:3072 sc1 lds
    s_add_u32 m0, s101, 0xb000
    s_add_u32 s97, s43, 0x35800
    buffer_load_dwordx4 v15, s[4:7], s97 offen sc1 lds
    s_waitcnt vmcnt(40)
    s_barrier
    s_add_u32 m0, s101, 0xc800
    s_add_u32 s97, s43, 0x37000
    buffer_load_dwordx4 v15, s[4:7], s97 offen sc1 lds
    buffer_load_dwordx4 v15, s[4:7], s97 offen offset:1024 sc1 lds
    buffer_load_dwordx4 v15, s[4:7], s97 offen offset:2048 sc1 lds
    buffer_load_dwordx4 v15, s[4:7], s97 offen offset:3072 sc1 lds
    s_add_u32 m0, s101, 0xd800
    s_add_u32 s97, s43, 0x38000
    buffer_load_dwordx4 v15, s[4:7], s97 offen sc1 lds
    s_waitcnt vmcnt(40)
    s_barrier
    s_add_u32 m0, s101, 0xf000
    s_add_u32 s97, s43, 0x39800
    buffer_load_dwordx4 v15, s[4:7], s97 offen sc1 lds
    buffer_load_dwordx4 v15, s[4:7], s97 offen offset:1024 sc1 lds
    buffer_load_dwordx4 v15, s[4:7], s97 offen offset:2048 sc1 lds
    buffer_load_dwordx4 v15, s[4:7], s97 offen offset:3072 sc1 lds
    s_add_u32 m0, s101, 0x10000
    s_add_u32 s97, s43, 0x3a800
    buffer_load_dwordx4 v15, s[4:7], s97 offen sc1 lds
    s_waitcnt vmcnt(40)
    s_barrier
    s_add_u32 m0, s101, 0x11800
    s_add_u32 s97, s43, 0x3c000
    buffer_load_dwordx4 v15, s[4:7], s97 offen sc1 lds
    buffer_load_dwordx4 v15, s[4:7], s97 offen offset:1024 sc1 lds
    buffer_load_dwordx4 v15, s[4:7], s97 offen offset:2048 sc1 lds
    buffer_load_dwordx4 v15, s[4:7], s97 offen offset:3072 sc1 lds
    s_add_u32 m0, s101, 0x12800
    s_add_u32 s97, s43, 0x3d000
    buffer_load_dwordx4 v15, s[4:7], s97 offen sc1 lds
    s_waitcnt vmcnt(40)
    s_barrier
    s_add_u32 m0, s101, 0x14000
    s_add_u32 s97, s43, 0x3e800
    buffer_load_dwordx4 v15, s[4:7], s97 offen sc1 lds
    buffer_load_dwordx4 v15, s[4:7], s97 offen offset:1024 sc1 lds
    buffer_load_dwordx4 v15, s[4:7], s97 offen offset:2048 sc1 lds
    buffer_load_dwordx4 v15, s[4:7], s97 offen offset:3072 sc1 lds
    s_add_u32 m0, s101, 0x15000
    s_add_u32 s97, s43, 0x3f800
    buffer_load_dwordx4 v15, s[4:7], s97 offen sc1 lds
    s_waitcnt vmcnt(40)
    s_barrier
    s_add_u32 m0, s101, 0x16800
    s_add_u32 s97, s43, 0x41000
    buffer_load_dwordx4 v15, s[4:7], s97 offen sc1 lds
    buffer_load_dwordx4 v15, s[4:7], s97 offen offset:1024 sc1 lds
    buffer_load_dwordx4 v15, s[4:7], s97 offen offset:2048 sc1 lds
    buffer_load_dwordx4 v15, s[4:7], s97 offen offset:3072 sc1 lds
    s_add_u32 m0, s101, 0x17800
    s_add_u32 s97, s43, 0x42000
    buffer_load_dwordx4 v15, s[4:7], s97 offen sc1 lds
    s_waitcnt vmcnt(40)
    s_barrier
    s_waitcnt vmcnt(35)
    s_barrier
    s_mov_b32 s96, s40
    s_add_u32 m0, s99, 0x0
    s_nop 0
    buffer_load_dwordx4 v2, s[12:15], s96 offen lds
    s_add_u32 m0, s99, 0x400
    s_add_u32 s96, s96, 15360
    buffer_load_dwordx4 v2, s[12:15], s96 offen lds
    s_add_u32 m0, s99, 0x800
    s_add_u32 s96, s96, 15360
    buffer_load_dwordx4 v2, s[12:15], s96 offen lds
    s_add_u32 m0, s99, 0xc00
    s_add_u32 s96, s96, 15360
    buffer_load_dwordx4 v2, s[12:15], s96 offen lds
    s_add_u32 m0, s99, 0x1000
    s_add_u32 s96, s96, 15360
    buffer_load_dwordx4 v2, s[12:15], s96 offen lds
    s_add_u32 m0, s99, 0x1400
    s_add_u32 s96, s96, 15360
    buffer_load_dwordx4 v2, s[12:15], s96 offen lds
    s_add_u32 m0, s99, 0x1800
    s_add_u32 s96, s96, 15360
    buffer_load_dwordx4 v2, s[12:15], s96 offen lds
    s_add_u32 m0, s99, 0x1c00
    s_add_u32 s96, s96, 15360
    buffer_load_dwordx4 v2, s[12:15], s96 offen lds
    s_waitcnt vmcnt(38)
    s_barrier
    s_waitcnt vmcnt(33)
    s_barrier
    s_add_u32 m0, s99, 0x4000
    s_add_u32 s96, s96, 138240
    buffer_load_dwordx4 v2, s[12:15], s96 offen lds
    s_add_u32 m0, s99, 0x4400
    s_add_u32 s96, s96, 15360
    buffer_load_dwordx4 v2, s[12:15], s96 offen lds
    s_add_u32 m0, s99, 0x4800
    s_add_u32 s96, s96, 15360
    buffer_load_dwordx4 v2, s[12:15], s96 offen lds
    s_add_u32 m0, s99, 0x4c00
    s_add_u32 s96, s96, 15360
    buffer_load_dwordx4 v2, s[12:15], s96 offen lds
    s_add_u32 m0, s99, 0x5000
    s_add_u32 s96, s96, 15360
    buffer_load_dwordx4 v2, s[12:15], s96 offen lds
    s_add_u32 m0, s99, 0x5400
    s_add_u32 s96, s96, 15360
    buffer_load_dwordx4 v2, s[12:15], s96 offen lds
    s_add_u32 m0, s99, 0x5800
    s_add_u32 s96, s96, 15360
    buffer_load_dwordx4 v2, s[12:15], s96 offen lds
    s_add_u32 m0, s99, 0x5c00
    s_add_u32 s96, s96, 15360
    buffer_load_dwordx4 v2, s[12:15], s96 offen lds
    s_waitcnt vmcnt(36)
    s_barrier
    s_add_u32 m0, s99, 0x8000
    s_add_u32 s96, s96, 138240
    buffer_load_dwordx4 v2, s[12:15], s96 offen lds
    s_add_u32 m0, s99, 0x8400
    s_add_u32 s96, s96, 15360
    buffer_load_dwordx4 v2, s[12:15], s96 offen lds
    s_add_u32 m0, s99, 0x8800
    s_add_u32 s96, s96, 15360
    buffer_load_dwordx4 v2, s[12:15], s96 offen lds
    s_add_u32 m0, s99, 0x8c00
    s_add_u32 s96, s96, 15360
    buffer_load_dwordx4 v2, s[12:15], s96 offen lds
    s_add_u32 m0, s99, 0x9000
    s_add_u32 s96, s96, 15360
    buffer_load_dwordx4 v2, s[12:15], s96 offen lds
    s_add_u32 m0, s99, 0x9400
    s_add_u32 s96, s96, 15360
    buffer_load_dwordx4 v2, s[12:15], s96 offen lds
    s_add_u32 m0, s99, 0x9800
    s_add_u32 s96, s96, 15360
    buffer_load_dwordx4 v2, s[12:15], s96 offen lds
    s_add_u32 m0, s99, 0x9c00
    s_add_u32 s96, s96, 15360
    buffer_load_dwordx4 v2, s[12:15], s96 offen lds
    s_waitcnt vmcnt(39)
    s_barrier
    s_waitcnt vmcnt(34)
    s_barrier
    s_add_u32 m0, s99, 0xc000
    s_add_u32 s96, s96, 138240
    buffer_load_dwordx4 v2, s[12:15], s96 offen lds
    s_add_u32 m0, s99, 0xc400
    s_add_u32 s96, s96, 15360
    buffer_load_dwordx4 v2, s[12:15], s96 offen lds
    s_add_u32 m0, s99, 0xc800
    s_add_u32 s96, s96, 15360
    buffer_load_dwordx4 v2, s[12:15], s96 offen lds
    s_add_u32 m0, s99, 0xcc00
    s_add_u32 s96, s96, 15360
    buffer_load_dwordx4 v2, s[12:15], s96 offen lds
    s_add_u32 m0, s99, 0xd000
    s_add_u32 s96, s96, 15360
    buffer_load_dwordx4 v2, s[12:15], s96 offen lds
    s_add_u32 m0, s99, 0xd400
    s_add_u32 s96, s96, 15360
    buffer_load_dwordx4 v2, s[12:15], s96 offen lds
    s_add_u32 m0, s99, 0xd800
    s_add_u32 s96, s96, 15360
    buffer_load_dwordx4 v2, s[12:15], s96 offen lds
    s_add_u32 m0, s99, 0xdc00
    s_add_u32 s96, s96, 15360
    buffer_load_dwordx4 v2, s[12:15], s96 offen lds
    s_waitcnt vmcnt(37)
    s_barrier
    s_add_u32 m0, s99, 0x10000
    s_add_u32 s96, s96, 138240
    buffer_load_dwordx4 v2, s[12:15], s96 offen lds
    s_add_u32 m0, s99, 0x10400
    s_add_u32 s96, s96, 15360
    buffer_load_dwordx4 v2, s[12:15], s96 offen lds
    s_add_u32 m0, s99, 0x10800
    s_add_u32 s96, s96, 15360
    buffer_load_dwordx4 v2, s[12:15], s96 offen lds
    s_add_u32 m0, s99, 0x10c00
    s_add_u32 s96, s96, 15360
    buffer_load_dwordx4 v2, s[12:15], s96 offen lds
    s_add_u32 m0, s99, 0x11000
    s_add_u32 s96, s96, 15360
    buffer_load_dwordx4 v2, s[12:15], s96 offen lds
    s_add_u32 m0, s99, 0x11400
    s_add_u32 s96, s96, 15360
    buffer_load_dwordx4 v2, s[12:15], s96 offen lds
    s_add_u32 m0, s99, 0x11800
    s_add_u32 s96, s96, 15360
    buffer_load_dwordx4 v2, s[12:15], s96 offen lds
    s_add_u32 m0, s99, 0x11c00
    s_add_u32 s96, s96, 15360
    buffer_load_dwordx4 v2, s[12:15], s96 offen lds
    s_waitcnt vmcnt(40)
    s_barrier
    s_barrier
    s_barrier
    s_cmp_lg_u32 s47, 0
    s_cbranch_scc1 L_end
    s_barrier
    s_cmp_lg_u32 s47, 0
    s_cbranch_scc1 L_end
    s_mov_b32 s47, 0x1
    s_mov_b32 s49, 0x2000000
    s_add_u32 s50, s50, 5
    s_branch L_w
L_tag:
    s_xor_b32 s52, s46, 4
    s_or_b32 s52, s52, s2
    s_cbranch_scc1 L_end
    s_add_u32 s53, s50, 0x9e3779ab
    v_mov_b32 v30, 0x10000
    v_mov_b32 v31, s53
    buffer_store_dword v31, v30, s[4:7], 0 offen sc1
L_end:
    s_waitcnt vmcnt(0)
    s_endpgm
.section .rodata,"a"
.p2align 6
.amdhsa_kernel interleave_layers__sliding_block__glu_gated_swiglu__prompt_kernel
  .amdhsa_next_free_vgpr 256
  .amdhsa_next_free_sgpr 102
  .amdhsa_accum_offset 256
  .amdhsa_group_segment_fixed_size 0
  .amdhsa_kernarg_size 80
  .amdhsa_user_sgpr_count 2
  .amdhsa_user_sgpr_kernarg_segment_ptr 1
  .amdhsa_system_sgpr_workgroup_id_x 1
.end_amdhsa_kernel
```
